```python
import torch

def _softmax(x, axis=-1):
    return torch.softmax(x, dim=axis)
def _gelu(x):
    return torch.nn.functional.gelu(x, approximate="tanh")
def _silu(x):
    return torch.nn.functional.silu(x)
def _sigmoid(x):
    return torch.sigmoid(x)
def _layernorm(x, axis=-1, eps=1e-5):
    m = x.mean(dim=axis, keepdim=True)
    v = x.var(dim=axis, keepdim=True, unbiased=False)
    return (x - m) / torch.sqrt(v + eps)
def _scatter_add(tgt, idx, src, axis=0):
    return tgt.clone().index_add_(axis, idx, src)
def _segment_sum(src, seg, n):
    out = torch.zeros((n,) + src.shape[1:], dtype=src.dtype)
    return out.index_add_(0, seg, src)
def _pad(x, pw):
    flat = tuple(v for pair in reversed(pw) for v in pair)
    return torch.nn.functional.pad(x, flat)

kernel_name = 'recurrent_scan__gqa_block_cached__dense_activation_gelu__prompt'

def setup_inputs():

    _w = (lambda a: (lambda t: t.to(torch.bfloat16) if t.is_floating_point() else t)(torch.as_tensor(a)))
    def _A_setup():
        B, Sq, D = 1, 2048, 512
        Hq, Hkv, Sk, Dh = 32, 32, 2048, 128
        assert Hq % Hkv == 0, (Hq, Hkv)
        return {
            "x": _w((lambda *s: torch.randn(*s, dtype=torch.bfloat16) * 0.05)(B, Sq, D)),
            "k_cache": _w((lambda *s: torch.randn(*s, dtype=torch.bfloat16) * 3.2)(B, Hkv, Sk, Dh)),
            "v_cache": _w((lambda *s: torch.randn(*s, dtype=torch.bfloat16) * 3.2)(B, Hkv, Sk, Dh)),
            "wq": _w((lambda *s: torch.randn(*s, dtype=torch.bfloat16) * 3.2)(D, Hq * Dh) * (D ** -0.5)),
            "wo": _w((lambda *s: torch.randn(*s, dtype=torch.bfloat16) * 3.2)(Hq * Dh, D) * ((Hq * Dh) ** -0.5)),
        }
    _A_in = _A_setup()

    def _B_setup():
        B, S, D, F = 1, 2048, 512, 1376
        return {
            "x": _w((lambda *s: torch.randn(*s, dtype=torch.bfloat16) * 0.05)(B, S, D)),
            "w1": _w((lambda *s: torch.randn(*s, dtype=torch.bfloat16) * 3.2)(D, F) * (D ** -0.5)),
            "b1": _w((lambda *s: torch.randn(*s, dtype=torch.bfloat16) * 3.2)(F) * 0.01),
            "w2": _w((lambda *s: torch.randn(*s, dtype=torch.bfloat16) * 0.8)(F, D) * (F ** -0.5)),
            "b2": _w((lambda *s: torch.randn(*s, dtype=torch.bfloat16) * 0.8)(D) * 0.01),
        }
    _B_in = _B_setup()

    return {
        "A_x": _A_in["x"],
        "A_k_cache": _A_in["k_cache"],
        "A_v_cache": _A_in["v_cache"],
        "A_wq": _A_in["wq"],
        "A_wo": _A_in["wo"],
        "B_x": _B_in["x"],
        "B_w1": _B_in["w1"],
        "B_b1": _B_in["b1"],
        "B_w2": _B_in["w2"],
        "B_b2": _B_in["b2"],
    }

def reference(A_x, A_k_cache, A_v_cache, A_wq, A_wo, B_x, B_w1, B_b1, B_w2, B_b2):
    def _A_ref(x, k_cache, v_cache, wq, wo):
        B, Sq, D = x.shape
        Hq, Dh = 32, 128
        Hkv = k_cache.shape[1]
        rep = Hq // Hkv
        q = (lambda x, *d: x.permute(*d))((x @ wq).reshape(B, Sq, Hq, Dh), 0, 2, 1, 3)
        k = (lambda x, n, axis: torch.repeat_interleave(x, n, dim=axis))(k_cache, rep, axis=1)
        v = (lambda x, n, axis: torch.repeat_interleave(x, n, dim=axis))(v_cache, rep, axis=1)
        scores = torch.einsum("bhqd,bhkd->bhqk", q, k) * (Dh ** -0.5)
        p = _softmax(scores, axis=-1)
        o = torch.einsum("bhqk,bhkd->bhqd", p, v)
        return (lambda x, *d: x.permute(*d))(o, 0, 2, 1, 3).reshape(B, Sq, Hq * Dh) @ wo

    def _B_ref(x, w1, b1, w2, b2):
        h = torch.einsum("bsd,df->bsf", x, w1) + b1
        h = _gelu(h)
        return torch.einsum("bsf,fd->bsd", h, w2) + b2

    x = A_x
    xn = _layernorm(x, axis=-1)
    s = _A_ref(xn, A_k_cache, A_v_cache, A_wq, A_wo)
    g = _silu(_B_ref(xn, B_w1, B_b1, B_w2, B_b2))
    return x + s * g
```

```asm
; @launch grid=(256,1,1) block=(256,1,1) lds=157120
.amdgcn_target "amdgcn-amd-amdhsa--gfx950"
.text
.p2align 12
.globl recurrent_scan__gqa_block_cached__dense_activation_gelu__prompt_kernel
.p2align 8
.type recurrent_scan__gqa_block_cached__dense_activation_gelu__prompt_kernel,@function
recurrent_scan__gqa_block_cached__dense_activation_gelu__prompt_kernel:
    s_cmp_ge_u32 s2, 256
    s_cbranch_scc1 L_endA
    s_load_dwordx16 s[64:79], s[0:1], 0
    s_load_dwordx8 s[80:87], s[0:1], 64
    s_load_dwordx2 s[88:89], s[0:1], 96
    s_getpc_b64 s[90:91]
L_pc:
    s_lshr_b32 s52, s2, 3
    s_lshl_b32 s52, s52, 11
    v_lshrrev_b32_e64 v94, 4, v0
    v_lshl_add_u32 v94, v94, 7, s52
    v_min_u32 v94, L_last-L_pc, v94
    global_load_dword v255, v94, s[90:91]
    v_lshrrev_b32 v1, 6, v0
    v_and_b32 v0, 63, v0
    s_and_b32 s3, s2, 7
    v_readfirstlane_b32 s36, v1
    s_bfe_u32 s38, s2, 0x30003
    s_lshr_b32 s53, s2, 6
    s_lshl_b32 s37, s3, 2
    s_add_u32 s37, s37, s53
    s_and_b32 s39, s37, 1
    s_xor_b32 s44, s53, s38
    s_and_b32 s44, s44, 0
    s_and_b32 s52, s3, 7
    s_xor_b32 s44, s44, s52
    s_lshr_b32 s52, s37, 1
    s_mul_i32 s52, s52, 3
    s_add_u32 s49, s52, 1
    s_lshl_b32 s53, s39, 1
    s_add_u32 s48, s52, s53
    s_add_u32 s53, s37, 11
    s_cmp_lt_u32 s37, 22
    s_cselect_b32 s48, s48, s53
    s_cselect_b32 s49, s49, 0
    s_lshl_b32 s46, s36, 13
    s_add_u32 s46, s46, 16416
    s_mul_i32 s47, s36, 6176
    s_add_u32 s47, s47, 82176
    v_and_b32 v28, 3, v0
    v_bfe_u32 v29, v0, 2, 2
    v_lshrrev_b32 v30, 4, v0
    v_lshlrev_b32 v13, 4, v0
    s_lshl_b32 s54, s38, 8
    s_lshl_b32 s55, s37, 3
    s_add_u32 s54, s54, s55
    s_lshl_b32 s55, s36, 1
    s_add_u32 s45, s54, s55
    s_lshl_b32 s54, s45, 10
    v_add_u32 v91, s54, v13
    v_and_b32 v1, 1, v30
    v_lshlrev_b32 v1, 1, v1
    v_xor_b32 v1, v1, v28
    v_lshlrev_b32 v12, 4, v1
    v_lshrrev_b32 v31, 2, v0
    v_lshl_add_u32 v16, v31, 10, v12
    s_bfe_u32 s52, s37, 0x10001
    s_lshl_b32 s53, s52, 14
    v_add_u32 v16, s53, v16
    v_xor_b32 v17, 0x4000, v16
    s_lshl_b32 s52, s52, 11
    s_add_u32 s94, s46, s52
    s_xor_b32 s52, s52, 0x800
    s_add_u32 s95, s46, s52
    s_lshl_b32 s52, s36, 3
    v_add_u32 v1, s52, v29
    v_lshlrev_b32 v31, 4, v28
    v_lshl_add_u32 v4, v30, 6, v31
    v_lshl_add_u32 v19, v1, 13, v4
    v_lshrrev_b32 v20, 5, v0
    v_lshl_add_u32 v1, v20, 5, v1
    v_and_b32 v20, 1, v30
    v_lshl_add_u32 v1, v20, 2, v1
    v_mul_u32_u24 v1, 2752, v1
    v_add_u32_e64 v20, v1, v31
    s_lshl_b32 s52, s38, 2
    s_add_u32 s53, s52, s36
    s_lshl_b32 s52, s53, 16
    s_waitcnt lgkmcnt(0)
    s_add_u32 s16, s64, s52
    s_addc_u32 s17, s65, 0
    s_mov_b32 s18, 65536
    s_mov_b32 s19, 0x20000
    s_xor_b32 s54, s44, 0
    s_lshl_b32 s54, s54, 7
    s_lshl_b32 s55, s39, 15
    s_add_u32 s54, s54, s55
    s_xor_b32 s55, s54, 0x8000
    s_add_u32 m0, s94, 0
    s_nop 0
    buffer_load_dwordx4 v16, s[16:19], s54 offen offset:0 lds
    s_add_u32 m0, s94, 960
    s_nop 0
    buffer_load_dwordx4 v16, s[16:19], s54 offen offset:64 lds
    s_lshl_b32 s52, s37, 8
    s_add_u32 s20, s70, s52
    s_addc_u32 s21, s71, 0
    s_mov_b32 s22, 4186368
    s_mov_b32 s23, 0x20000
    s_lshl_b32 s52, s48, 6
    s_add_u32 s24, s76, s52
    s_addc_u32 s25, s77, 0
    s_mov_b32 s26, 1406336
    s_mov_b32 s27, 0x20000
    s_lshl_b32 s52, s49, 6
    s_add_u32 s28, s76, s52
    s_addc_u32 s29, s77, 0
    s_mov_b32 s30, 1406336
    s_mov_b32 s31, 0x20000
    s_cmp_lt_u32 s37, 22
    s_cselect_b32 s30, s30, 0
    s_mov_b64 s[98:99], s[64:65]
    s_xor_b32 s58, s44, 0
    s_lshl_b32 s56, s58, 19
    s_mul_i32 s58, s58, 176128
    s_add_u32 m0, s47, 0
    s_nop 0
    buffer_load_dwordx4 v19, s[20:23], s56 offen offset:0 lds
    s_add_u32 s57, s56, 31744
    buffer_load_dwordx4 v19, s[20:23], s57 offen offset:1024 lds
    s_add_u32 s57, s56, 260096
    buffer_load_dwordx4 v19, s[20:23], s57 offen offset:2048 lds
    s_add_u32 s57, s56, 291840
    buffer_load_dwordx4 v19, s[20:23], s57 offen offset:3072 lds
    s_add_u32 m0, s47, 4096
    s_nop 0
    buffer_load_dwordx4 v20, s[24:27], s58 offen lds
    s_add_u32 m0, s47, 5120
    s_nop 0
    buffer_load_dwordx4 v20, s[28:31], s58 offen lds
    s_lshl_b32 s52, s48, 6
    s_lshl_b32 s53, s49, 6
    v_lshl_add_u32 v88, v30, 3, s52
    v_lshl_add_u32 v89, v30, 3, s53
    s_mov_b64 s[92:93], s[78:79]
    s_lshl_b32 s52, s37, 19
    s_add_u32 s4, s66, s52
    s_addc_u32 s5, s67, 0
    s_mov_b32 s6, 524288
    s_mov_b32 s7, 0x20000
    s_add_u32 s8, s68, s52
    s_addc_u32 s9, s69, 0
    s_mov_b32 s10, 524288
    s_mov_b32 s11, 0x20000
    s_mov_b32 s12, s88
    s_mov_b32 s13, s89
    s_mov_b32 s14, 268435456
    s_mov_b32 s15, 0x20000
    s_mov_b32 s32, s86
    s_mov_b32 s33, s87
    s_mov_b32 s34, 256
    s_mov_b32 s35, 0x20000
    s_and_b32 s101, s37, 15
    s_lshl_b32 s101, s101, 1
    s_lshr_b32 s59, s37, 4
    s_add_u32 s101, s101, s59
    s_mov_b32 s59, s38
    s_lshr_b32 s3, s101, 2
    s_lshl_b32 s52, s59, 7
    s_add_u32 s60, s72, s52
    s_addc_u32 s61, s73, 0
    s_mov_b32 s62, 4193408
    s_mov_b32 s63, 0x20000
    s_add_u32 s68, s80, s52
    s_addc_u32 s69, s81, 0
    s_mov_b32 s70, 1408128
    s_mov_b32 s71, 0x20000
    s_add_u32 s76, s82, s52
    s_addc_u32 s77, s83, 0
    s_mov_b32 s78, 128
    s_mov_b32 s79, 0x20000
    s_lshl_b32 s53, s101, 16
    s_add_u32 s53, s53, s52
    s_add_u32 s64, s64, s53
    s_addc_u32 s65, s65, 0
    s_mov_b32 s66, 64640
    s_mov_b32 s67, 0x20000
    s_add_u32 s72, s84, s53
    s_addc_u32 s73, s85, 0
    s_mov_b32 s74, 64640
    s_mov_b32 s75, 0x20000
    s_lshr_b32 s80, s2, 6
    s_lshl_b32 s80, s80, 1
    s_xor_b32 s80, s80, s38
    s_and_b32 s80, s80, 5
    s_and_b32 s56, s36, 0
    s_xor_b32 s80, s80, s56
    s_lshl_b32 s82, s36, 4
    s_and_b32 s56, s101, 1
    s_xor_b32 s56, s56, 1
    s_lshl_b32 s56, s56, 6
    s_add_u32 s82, s82, s56
    s_lshl_b32 s56, s36, 10
    s_add_u32 s81, s56, 131712
    s_lshl_b32 s83, s36, 12
    s_add_u32 s80, s80, s82
    s_lshr_b32 s57, s80, 2
    s_lshl_b32 s57, s57, 14
    s_add_u32 s83, s83, s57
    s_and_b32 s57, s80, 3
    s_lshl_b32 s57, s57, 10
    s_add_u32 s83, s83, s57
    s_lshl_b32 s80, s80, 15
    s_lshl_b32 s100, s37, 1
    s_add_u32 s100, s100, s39
    s_lshl_b32 s100, s100, 13
    s_mul_i32 s84, s101, 176128
    s_add_u32 s84, s84, s56
    s_add_u32 s84, s84, 16777216
    s_lshl_b32 s56, s38, 2
    s_add_u32 s56, s56, s36
    s_mul_i32 s56, s56, 176128
    s_add_u32 s56, s56, 16777216
    s_lshl_b32 s87, s48, 12
    s_add_u32 s87, s87, s56
    s_lshl_b32 s88, s49, 12
    s_add_u32 s88, s88, s56
    s_lshl_b32 s89, s38, 10
    s_lshr_b32 s56, s37, 2
    s_lshl_b32 s56, s56, 7
    s_add_u32 s89, s89, s56
    s_and_b32 s56, s37, 3
    s_lshl_b32 s56, s56, 2
    s_add_u32 s89, s89, s56
    s_add_u32 s89, s89, 25165824
    s_lshr_b32 s56, s36, 1
    s_lshl_b32 s56, s56, 4
    s_lshl_b32 s40, s36, 12
    s_add_u32 s40, s40, s56
    s_mul_i32 s41, s36, 4128
    s_add_u32 s41, s41, 65664
    s_mov_b32 s50, 0
    s_mov_b32 s49, s59
    s_mov_b32 s51, 0x42cc0000
    v_lshl_add_u32 v4, v29, 8, v4
    s_lshl_b32 s56, s36, 12
    v_add_u32 v4, s56, v4
    v_and_b32 v1, 1, v29
    v_lshlrev_b32 v1, 1, v1
    v_xor_b32 v1, v1, v30
    v_lshlrev_b32 v1, 4, v1
    v_and_b32 v31, 15, v0
    v_lshl_add_u32 v1, v31, 6, v1
    v_add_u32_e64 v18, s46, v1
    s_lshl_b32 s56, s36, 7
    s_add_u32 s56, s56, 156288
    s_lshl_b32 s57, s36, 6
    s_add_u32 s57, s57, 156800
    v_lshl_add_u32 v24, v31, 2, s56
    v_lshl_add_u32 v25, v31, 2, s57
    v_lshlrev_b32 v26, 4, v30
    v_add_u32 v26, 156288, v26
    s_lshl_b32 s56, s39, 8
    v_lshl_add_u32 v92, v31, 3, s56
    v_xor_b32 v93, 0x100, v92
    v_lshlrev_b32 v1, 3, v28
    v_lshl_add_u32 v1, v29, 6, v1
    v_mul_u32_u24 v21, 6176, v30
    v_add_u32 v21, v21, v1
    v_add_u32 v21, 82176, v21
    v_mul_u32_u24 v3, 4128, v30
    v_add_u32 v3, v3, v1
    v_add_u32 v3, 65664, v3
    s_lshl_b32 s56, s36, 8
    v_add_u32 v22, s56, v21
    s_lshr_b32 s56, s36, 1
    s_lshl_b32 s56, s56, 10
    s_and_b32 s57, s36, 1
    s_lshl_b32 s57, s57, 5
    s_add_u32 s56, s56, s57
    v_add_u32 v23, s56, v21
    v_lshrrev_b32 v31, 1, v30
    v_lshl_add_u32 v1, v31, 10, v1
    v_lshl_add_u32 v12, v31, 6, v12
    v_and_b32 v31, 1, v30
    v_lshl_add_u32 v1, v31, 8, v1
    v_lshl_add_u32 v1, v31, 5, v1
    v_xor_b32 v31, 32, v1
    v_add_u32 v80, s40, v1
    v_add_u32 v81, s40, v31
    v_add_u32 v82, s41, v1
    v_add_u32 v83, s41, v31
    v_add_u32 v84, 66048, v82
    v_add_u32 v85, 66048, v83
    v_add_u32 v14, 131712, v1
    v_add_u32 v15, 131712, v31
    v_bfe_u32 v31, v0, 2, 3
    v_lshl_add_u32 v12, v31, 10, v12
    v_and_b32 v86, 3, v0
    v_lshlrev_b32 v86, 2, v86
    v_lshrrev_b32 v1, 1, v29
    v_lshlrev_b32 v1, 4, v1
    v_lshl_add_u32 v1, v29, 12, v1
    v_lshl_add_u32 v1, v28, 6, v1
    v_and_b32 v2, 1, v30
    v_lshl_add_u32 v1, v2, 5, v1
    v_lshrrev_b32 v2, 1, v30
    v_lshl_add_u32 v2, v2, 4, v1
    s_lshl_b32 s56, s39, 11
    v_add_u32 v6, s56, v13
    v_xor_b32 v7, 0x800, v6
    s_cmp_lt_u32 s37, 22
    s_cselect_b32 s56, 0, 0x10000000
    v_add_u32 v27, s56, v6
    v_or_b32_e64 v1, s36, v0
    v_cmp_eq_u32 vcc, 0, v1
    v_mov_b32 v1, 0x10000000
    s_nop 0
    v_cndmask_b32 v87, v1, 0, vcc
    v_cmp_gt_u32 vcc, 2, v28
    v_mov_b32 v1, 0x3f803f80
    v_mov_b32 v31, 0x44444444
    v_cndmask_b32 v8, 0, v1, vcc
    v_cndmask_b32 v9, 0, v1, vcc
    v_cndmask_b32 v10, 0, v1, vcc
    v_cndmask_b32 v11, 0, v1, vcc
    v_cmp_eq_u32 vcc, 1, v28
    v_mov_b32 v5, 0xeeeeeeee
    s_nop 0
    v_cndmask_b32 v5, v31, v5, vcc
    v_accvgpr_write_b32 a88, 0
    v_accvgpr_write_b32 a89, 0
    v_accvgpr_write_b32 a90, 0
    v_accvgpr_write_b32 a91, 0
    v_accvgpr_write_b32 a92, 0
    v_accvgpr_write_b32 a93, 0
    v_accvgpr_write_b32 a94, 0
    v_accvgpr_write_b32 a95, 0
    v_accvgpr_write_b32 a96, 0
    v_accvgpr_write_b32 a97, 0
    v_accvgpr_write_b32 a98, 0
    v_accvgpr_write_b32 a99, 0
    v_accvgpr_write_b32 a192, 0
    v_accvgpr_write_b32 a193, 0
    v_accvgpr_write_b32 a194, 0
    v_accvgpr_write_b32 a195, 0
    v_accvgpr_write_b32 a196, 0
    v_accvgpr_write_b32 a197, 0
    v_accvgpr_write_b32 a198, 0
    v_accvgpr_write_b32 a199, 0
    v_accvgpr_write_b32 a200, 0
    v_accvgpr_write_b32 a201, 0
    v_accvgpr_write_b32 a202, 0
    v_accvgpr_write_b32 a203, 0
    v_accvgpr_write_b32 a204, 0
    v_accvgpr_write_b32 a205, 0
    v_accvgpr_write_b32 a206, 0
    v_accvgpr_write_b32 a207, 0
    v_accvgpr_write_b32 a224, 0
    v_accvgpr_write_b32 a225, 0
    v_accvgpr_write_b32 a226, 0
    v_accvgpr_write_b32 a227, 0
    v_accvgpr_write_b32 a228, 0
    v_accvgpr_write_b32 a229, 0
    v_accvgpr_write_b32 a230, 0
    v_accvgpr_write_b32 a231, 0
    s_mov_b64 exec, 0
    s_cmp_eq_u32 s36, 0
    s_cbranch_scc1 L_hoo0
    s_cmp_eq_u32 s36, 1
    s_cbranch_scc1 L_hoo1
    s_cmp_eq_u32 s36, 2
    s_cbranch_scc1 L_hoo2
    s_branch L_hoo3
L_hoo3:
L_hoo_back:
    s_mov_b64 exec, -1
    global_load_dwordx4 v[48:51], v91, s[98:99] offset:0
    global_load_dwordx4 v[52:55], v91, s[98:99] offset:1024
    global_load_dwordx2 v[96:97], v88, s[92:93] offset:0
    global_load_dwordx2 v[98:99], v88, s[92:93] offset:32
    global_load_dwordx2 v[60:61], v89, s[92:93] offset:0
    global_load_dwordx2 v[62:63], v89, s[92:93] offset:32
    s_add_u32 m0, s95, 0
    s_nop 0
    buffer_load_dwordx4 v17, s[16:19], s54 offen offset:0 lds
    s_add_u32 m0, s95, 960
    s_nop 0
    buffer_load_dwordx4 v17, s[16:19], s54 offen offset:64 lds
    s_add_u32 m0, s94, 4096
    s_nop 0
    buffer_load_dwordx4 v16, s[16:19], s55 offen offset:0 lds
    s_add_u32 m0, s94, 5056
    s_nop 0
    buffer_load_dwordx4 v16, s[16:19], s55 offen offset:64 lds
    s_add_u32 m0, s95, 4096
    s_nop 0
    buffer_load_dwordx4 v17, s[16:19], s55 offen offset:0 lds
    s_add_u32 m0, s95, 5056
    s_nop 0
    buffer_load_dwordx4 v17, s[16:19], s55 offen offset:64 lds
    s_xor_b32 s58, s44, 1
    s_lshl_b32 s56, s58, 19
    s_mul_i32 s58, s58, 176128
    s_add_u32 m0, s47, 24704
    s_nop 0
    buffer_load_dwordx4 v19, s[20:23], s56 offen offset:0 lds
    s_add_u32 s57, s56, 31744
    buffer_load_dwordx4 v19, s[20:23], s57 offen offset:1024 lds
    s_add_u32 s57, s56, 260096
    buffer_load_dwordx4 v19, s[20:23], s57 offen offset:2048 lds
    s_add_u32 s57, s56, 291840
    buffer_load_dwordx4 v19, s[20:23], s57 offen offset:3072 lds
    v_mov_b32 v56, 0
    v_mov_b32 v57, 0
    v_mov_b32 v58, 0
    v_mov_b32 v59, 0
    v_mov_b32 v1, 0x3f803f80
    s_waitcnt vmcnt(15)
    v_dot2c_f32_bf16 v56, v48, v1
    v_dot2c_f32_bf16 v58, v48, v48
    s_waitcnt vmcnt(14)
    v_dot2c_f32_bf16 v57, v52, v1
    v_dot2c_f32_bf16 v59, v52, v52
    v_dot2c_f32_bf16 v56, v49, v1
    v_dot2c_f32_bf16 v58, v49, v49
    v_dot2c_f32_bf16 v57, v53, v1
    v_dot2c_f32_bf16 v59, v53, v53
    v_dot2c_f32_bf16 v56, v50, v1
    v_dot2c_f32_bf16 v58, v50, v50
    v_dot2c_f32_bf16 v57, v54, v1
    v_dot2c_f32_bf16 v59, v54, v54
    v_dot2c_f32_bf16 v56, v51, v1
    v_dot2c_f32_bf16 v58, v51, v51
    v_dot2c_f32_bf16 v57, v55, v1
    v_dot2c_f32_bf16 v59, v55, v55
    s_nop 2
    v_permlane32_swap_b32 v56, v57
    v_permlane32_swap_b32 v58, v59
    v_add_f32 v56, v56, v57
    v_add_f32 v58, v58, v59
    v_mov_b32 v57, v56
    v_mov_b32 v59, v58
    s_nop 0
    v_permlane16_swap_b32 v56, v57
    v_permlane16_swap_b32 v58, v59
    v_add_f32 v56, v56, v57
    v_add_f32_e64 v58, v58, v59
    s_nop 0
    v_add_f32_dpp v56, v56, v56 row_ror:8 row_mask:0xf bank_mask:0xf
    v_add_f32_dpp v58, v58, v58 row_ror:8 row_mask:0xf bank_mask:0xf
    s_nop 0
    v_add_f32_dpp v56, v56, v56 row_ror:4 row_mask:0xf bank_mask:0xf
    v_add_f32_dpp v58, v58, v58 row_ror:4 row_mask:0xf bank_mask:0xf
    s_nop 0
    v_add_f32_dpp v56, v56, v56 row_ror:2 row_mask:0xf bank_mask:0xf
    v_add_f32_dpp v58, v58, v58 row_ror:2 row_mask:0xf bank_mask:0xf
    s_nop 0
    v_add_f32_dpp v56, v56, v56 row_ror:1 row_mask:0xf bank_mask:0xf
    v_add_f32_dpp v58, v58, v58 row_ror:1 row_mask:0xf bank_mask:0xf
    v_mul_f32 v88, 0xbb000000, v56
    v_mul_f32 v58, 0x3b000000, v58
    v_fma_f32 v58, -v88, v88, v58
    v_max_f32 v58, 0, v58
    v_add_f32 v58, 0x3727c5ac, v58
    v_rsq_f32 v89, v58
    v_lshrrev_b32 v1, 5, v0
    v_lshlrev_b32 v1, 3, v1
    s_lshl_b32 s45, s45, 3
    s_add_u32 s45, s45, 25231360
    v_mov_b32 v91, 0
    v_mov_b32 v90, 1
    s_waitcnt vmcnt(13)
    v_lshlrev_b32 v32, 16, v96
    v_and_b32 v33, 0xffff0000, v96
    v_lshlrev_b32 v34, 16, v97
    v_and_b32 v35, 0xffff0000, v97
    s_waitcnt vmcnt(12)
    v_lshlrev_b32 v36, 16, v98
    v_and_b32 v37, 0xffff0000, v98
    v_lshlrev_b32 v38, 16, v99
    v_and_b32 v39, 0xffff0000, v99
    s_waitcnt vmcnt(11)
    v_lshlrev_b32 v40, 16, v60
    v_and_b32 v41, 0xffff0000, v60
    v_lshlrev_b32 v42, 16, v61
    v_and_b32 v43, 0xffff0000, v61
    s_waitcnt vmcnt(10)
    v_lshlrev_b32 v44, 16, v62
    v_and_b32 v45, 0xffff0000, v62
    v_lshlrev_b32 v46, 16, v63
    v_and_b32 v47, 0xffff0000, v63
    s_add_u32 m0, s47, 28800
    s_nop 0
    buffer_load_dwordx4 v20, s[24:27], s58 offen lds
    s_add_u32 m0, s47, 29824
    s_nop 0
    buffer_load_dwordx4 v20, s[28:31], s58 offen lds
    s_xor_b32 s54, s44, 1
    s_lshl_b32 s54, s54, 7
    s_lshl_b32 s55, s39, 15
    s_add_u32 s54, s54, s55
    s_xor_b32 s55, s54, 0x8000
    s_add_u32 m0, s94, 32832
    s_nop 0
    buffer_load_dwordx4 v16, s[16:19], s54 offen offset:0 lds
    s_add_u32 m0, s94, 33792
    s_nop 0
    buffer_load_dwordx4 v16, s[16:19], s54 offen offset:64 lds
    s_mov_b64 exec, 0
    s_cmp_eq_u32 s36, 0
    s_cbranch_scc1 L_hop0
    s_cmp_eq_u32 s36, 1
    s_cbranch_scc1 L_hop1
    s_cmp_eq_u32 s36, 2
    s_cbranch_scc1 L_hop2
    s_branch L_hop3
.p2align 12
L_hop_back:
    s_mov_b64 exec, -1
    s_waitcnt vmcnt(8)
    ds_read_b128 a[0:3], v18 offset:0
    ds_read_b128 a[4:7], v18 offset:1024
    ds_read_b128 a[8:11], v18 offset:2048
    ds_read_b128 a[12:15], v18 offset:3072
    ds_read_b128 a[16:19], v18 offset:4096
    ds_read_b128 a[20:23], v18 offset:5120
    ds_read_b128 a[24:27], v18 offset:6144
    ds_read_b128 a[28:31], v18 offset:7168
    s_waitcnt lgkmcnt(0)
    s_barrier
    ds_read_b64_tr_b16 a[128:129], v21 offset:0
    ds_read_b64_tr_b16 a[130:131], v21 offset:1024
    ds_read_b64_tr_b16 a[132:133], v21 offset:2048
    ds_read_b64_tr_b16 a[134:135], v21 offset:3072
    ds_read_b64_tr_b16 a[136:137], v21 offset:32
    ds_read_b64_tr_b16 a[138:139], v21 offset:1056
    ds_read_b64_tr_b16 a[140:141], v21 offset:2080
    ds_read_b64_tr_b16 a[142:143], v21 offset:3104
    s_waitcnt lgkmcnt(6)
    v_mfma_f32_16x16x32_bf16 v[128:131], a[128:131], a[0:3], 0
    s_waitcnt lgkmcnt(4)
    ds_read_b64_tr_b16 a[144:145], v21 offset:256
    v_mfma_f32_16x16x32_bf16 v[128:131], a[132:135], a[4:7], v[128:131]
    ds_read_b64_tr_b16 a[146:147], v21 offset:1280
    v_mfma_f32_16x16x32_bf16 v[132:135], a[128:131], a[8:11], 0
    ds_read_b64_tr_b16 a[148:149], v21 offset:2304
    v_mfma_f32_16x16x32_bf16 v[132:135], a[132:135], a[12:15], v[132:135]
    ds_read_b64_tr_b16 a[150:151], v21 offset:3328
    v_mfma_f32_16x16x32_bf16 v[136:139], a[128:131], a[16:19], 0
    s_add_u32 m0, s95, 32832
    ds_read_b64_tr_b16 a[152:153], v21 offset:5120
    v_mfma_f32_16x16x32_bf16 v[136:139], a[132:135], a[20:23], v[136:139]
    buffer_load_dwordx4 v17, s[16:19], s54 offen offset:0 lds
    v_mfma_f32_16x16x32_bf16 v[140:143], a[128:131], a[24:27], 0
    ds_read_b64_tr_b16 a[154:155], v21 offset:5376
    v_mfma_f32_16x16x32_bf16 v[140:143], a[132:135], a[28:31], v[140:143]
    s_waitcnt lgkmcnt(5)
    s_add_u32 m0, s95, 33792
    ds_read_b64_tr_b16 a[156:157], v21 offset:5632
    v_mfma_f32_16x16x32_bf16 v[144:147], a[136:139], a[0:3], 0
    buffer_load_dwordx4 v17, s[16:19], s54 offen offset:64 lds
    v_mfma_f32_16x16x32_bf16 v[144:147], a[140:143], a[4:7], v[144:147]
    ds_read_b64_tr_b16 a[158:159], v21 offset:5888
    v_mfma_f32_16x16x32_bf16 v[148:151], a[136:139], a[8:11], 0
    s_add_u32 m0, s94, 36928
    ds_read_b64_tr_b16 a[160:161], v21 offset:288
    v_mfma_f32_16x16x32_bf16 v[148:151], a[140:143], a[12:15], v[148:151]
    buffer_load_dwordx4 v16, s[16:19], s55 offen offset:0 lds
    v_mfma_f32_16x16x32_bf16 v[152:155], a[136:139], a[16:19], 0
    ds_read_b64_tr_b16 a[162:163], v21 offset:1312
    v_mfma_f32_16x16x32_bf16 v[152:155], a[140:143], a[20:23], v[152:155]
    s_add_u32 m0, s94, 37888
    ds_read_b64_tr_b16 a[164:165], v21 offset:2336
    v_mfma_f32_16x16x32_bf16 v[156:159], a[136:139], a[24:27], 0
    buffer_load_dwordx4 v16, s[16:19], s55 offen offset:64 lds
    v_mfma_f32_16x16x32_bf16 v[156:159], a[140:143], a[28:31], v[156:159]
    s_waitcnt lgkmcnt(4)
    ds_read_b64_tr_b16 a[166:167], v21 offset:3360
    v_mfma_f32_16x16x32_bf16 v[160:163], a[144:147], a[0:3], 0
    s_add_u32 m0, s95, 36928
    ds_read_b64_tr_b16 a[64:65], v22 offset:0
    v_mfma_f32_16x16x32_bf16 v[160:163], a[148:151], a[4:7], v[160:163]
    buffer_load_dwordx4 v17, s[16:19], s55 offen offset:0 lds
    v_mfma_f32_16x16x32_bf16 v[164:167], a[144:147], a[8:11], 0
    ds_read_b64_tr_b16 a[66:67], v22 offset:1024
    v_mfma_f32_16x16x32_bf16 v[164:167], a[148:151], a[12:15], v[164:167]
    s_add_u32 m0, s95, 37888
    ds_read_b64_tr_b16 a[68:69], v22 offset:2048
    v_mfma_f32_16x16x32_bf16 v[168:171], a[144:147], a[16:19], 0
    buffer_load_dwordx4 v17, s[16:19], s55 offen offset:64 lds
    v_mfma_f32_16x16x32_bf16 v[168:171], a[148:151], a[20:23], v[168:171]
    ds_read_b64_tr_b16 a[70:71], v22 offset:3072
    v_mfma_f32_16x16x32_bf16 v[172:175], a[144:147], a[24:27], 0
    ds_read_b64_tr_b16 a[168:169], v21 offset:512
    v_mfma_f32_16x16x32_bf16 v[172:175], a[148:151], a[28:31], v[172:175]
    buffer_store_dwordx2 v[88:89], v1, s[12:15], s45 offen sc1
    v_mfma_f32_16x16x32_bf16 v[64:67], a[152:155], a[0:3], 0
    s_waitcnt lgkmcnt(4)
    ds_read_b64_tr_b16 a[170:171], v21 offset:1536
    v_mfma_f32_16x16x32_bf16 v[64:67], a[156:159], a[4:7], v[64:67]
    ds_read_b64_tr_b16 a[172:173], v21 offset:2560
    v_mfma_f32_16x16x32_bf16 v[68:71], a[152:155], a[8:11], 0
    buffer_store_dword v91, v87, s[12:15], s89 offen sc1
    v_mfma_f32_16x16x32_bf16 v[68:71], a[156:159], a[12:15], v[68:71]
    s_lshl_b32 s52, s2, 7
    ds_read_b64_tr_b16 a[174:175], v21 offset:3584
    v_mfma_f32_16x16x32_bf16 v[176:179], a[160:163], a[0:3], 0
    s_add_u32 s52, s52, 25182208
    ds_read_b64_tr_b16 a[72:73], v22 offset:32
    v_mfma_f32_16x16x32_bf16 v[176:179], a[164:167], a[4:7], v[176:179]
    buffer_store_dword v91, v87, s[12:15], s52 offen sc1
    v_mfma_f32_16x16x32_bf16 v[180:183], a[160:163], a[8:11], 0
    ds_read_b64_tr_b16 a[74:75], v22 offset:1056
    v_mfma_f32_16x16x32_bf16 v[180:183], a[164:167], a[12:15], v[180:183]
    ds_read_b64_tr_b16 a[76:77], v22 offset:2080
    v_mfma_f32_16x16x32_bf16 v[184:187], a[160:163], a[16:19], 0
    ds_read_b64_tr_b16 a[136:137], v21 offset:5152
    s_xor_b32 s58, s44, 2
    s_lshl_b32 s56, s58, 19
    s_mul_i32 s58, s58, 176128
    s_add_u32 m0, s47, 49408
    v_mfma_f32_16x16x32_bf16 v[184:187], a[164:167], a[20:23], v[184:187]
    buffer_load_dwordx4 v19, s[20:23], s56 offen offset:0 lds
    v_mfma_f32_16x16x32_bf16 v[188:191], a[160:163], a[24:27], 0
    ds_read_b64_tr_b16 a[78:79], v22 offset:3104
    v_mfma_f32_16x16x32_bf16 v[188:191], a[164:167], a[28:31], v[188:191]
    s_waitcnt lgkmcnt(4)
    ds_read_b64_tr_b16 a[128:129], v21 offset:544
    v_smfmac_f32_16x16x64_bf16 a[88:91], v[8:11], a[64:71], v5
    s_add_u32 s57, s56, 31744
    ds_read_b64_tr_b16 a[130:131], v21 offset:1568
    v_mfma_f32_16x16x32_bf16 v[192:195], a[168:171], a[0:3], 0
    buffer_load_dwordx4 v19, s[20:23], s57 offen offset:1024 lds
    v_mfma_f32_16x16x32_bf16 v[192:195], a[172:175], a[4:7], v[192:195]
    ds_read_b64_tr_b16 a[132:133], v21 offset:2592
    v_mfma_f32_16x16x32_bf16 v[196:199], a[168:171], a[8:11], 0
    s_add_u32 s57, s56, 260096
    ds_read_b64_tr_b16 a[134:135], v21 offset:3616
    v_mfma_f32_16x16x32_bf16 v[196:199], a[172:175], a[12:15], v[196:199]
    buffer_load_dwordx4 v19, s[20:23], s57 offen offset:2048 lds
    v_mfma_f32_16x16x32_bf16 v[200:203], a[168:171], a[16:19], 0
    ds_read_b64_tr_b16 a[80:81], v23 offset:4096
    v_mfma_f32_16x16x32_bf16 v[200:203], a[172:175], a[20:23], v[200:203]
    s_add_u32 s57, s56, 291840
    ds_read_b64_tr_b16 a[82:83], v23 offset:4352
    v_mfma_f32_16x16x32_bf16 v[204:207], a[168:171], a[24:27], 0
    buffer_load_dwordx4 v19, s[20:23], s57 offen offset:3072 lds
    v_mfma_f32_16x16x32_bf16 v[204:207], a[172:175], a[28:31], v[204:207]
    s_waitcnt lgkmcnt(4)
    ds_read_b64_tr_b16 a[84:85], v23 offset:4608
    v_smfmac_f32_16x16x64_bf16 a[92:95], v[8:11], a[72:79], v5
    s_add_u32 m0, s47, 53504
    ds_read_b64_tr_b16 a[86:87], v23 offset:4864
    v_mfma_f32_16x16x32_bf16 v[208:211], a[128:131], a[0:3], 0
    s_waitcnt lgkmcnt(4)
    buffer_load_dwordx4 v20, s[24:27], s58 offen lds
    v_mfma_f32_16x16x32_bf16 v[208:211], a[132:135], a[4:7], v[208:211]
    ds_read_b64_tr_b16 a[138:139], v21 offset:5408
    v_mfma_f32_16x16x32_bf16 v[212:215], a[128:131], a[8:11], 0
    s_add_u32 m0, s47, 54528
    ds_read_b64_tr_b16 a[140:141], v21 offset:5664
    v_mfma_f32_16x16x32_bf16 v[212:215], a[132:135], a[12:15], v[212:215]
    buffer_load_dwordx4 v20, s[28:31], s58 offen lds
    v_mfma_f32_16x16x32_bf16 v[216:219], a[128:131], a[16:19], 0
    ds_read_b64_tr_b16 a[142:143], v21 offset:5920
    v_mfma_f32_16x16x32_bf16 v[216:219], a[132:135], a[20:23], v[216:219]
    ds_read_b64_tr_b16 a[144:145], v21 offset:768
    v_mfma_f32_16x16x32_bf16 v[220:223], a[128:131], a[24:27], 0
    ds_read_b64_tr_b16 a[146:147], v21 offset:1792
    v_mfma_f32_16x16x32_bf16 v[220:223], a[132:135], a[28:31], v[220:223]
    s_waitcnt lgkmcnt(5)
    ds_read_b64_tr_b16 a[148:149], v21 offset:2816
    v_smfmac_f32_16x16x64_bf16 a[96:99], v[8:11], a[80:87], v5
    ds_read_b64_tr_b16 a[150:151], v21 offset:3840
    s_xor_b32 s54, s44, 2
    s_lshl_b32 s54, s54, 7
    s_lshl_b32 s55, s39, 15
    s_add_u32 s54, s54, s55
    s_xor_b32 s55, s54, 0x8000
    s_add_u32 m0, s94, 0
    s_waitcnt lgkmcnt(6)
    v_mfma_f32_16x16x32_bf16 v[72:75], a[136:139], a[0:3], 0
    s_waitcnt vmcnt(9) lgkmcnt(4)
    buffer_load_dwordx4 v16, s[16:19], s54 offen offset:0 lds
    ds_read_b128 a[32:35], v18 offset:32832
    v_mfma_f32_16x16x32_bf16 v[72:75], a[140:143], a[4:7], v[72:75]
    ds_read_b64_tr_b16 a[152:153], v21 offset:800
    ds_read_b128 a[36:39], v18 offset:33856
    v_mfma_f32_16x16x32_bf16 v[76:79], a[136:139], a[8:11], 0
    s_add_u32 m0, s94, 960
    ds_read_b64_tr_b16 a[154:155], v21 offset:1824
    v_mfma_f32_16x16x32_bf16 v[76:79], a[140:143], a[12:15], v[76:79]
    s_waitcnt lgkmcnt(6)
    buffer_load_dwordx4 v16, s[16:19], s54 offen offset:64 lds
    v_mfma_f32_16x16x32_bf16 v[224:227], a[144:147], a[0:3], 0
    s_waitcnt lgkmcnt(4)
    ds_read_b64_tr_b16 a[156:157], v21 offset:2848
    v_mfma_f32_16x16x32_bf16 v[224:227], a[148:151], a[4:7], v[224:227]
    ds_read_b64_tr_b16 a[158:159], v21 offset:3872
    v_mfma_f32_16x16x32_bf16 v[228:231], a[144:147], a[8:11], 0
    ds_read_b64_tr_b16 a[160:161], v21 offset:4096
    v_mfma_f32_16x16x32_bf16 v[228:231], a[148:151], a[12:15], v[228:231]
    ds_read_b64_tr_b16 a[162:163], v21 offset:4352
    v_mfma_f32_16x16x32_bf16 v[232:235], a[144:147], a[16:19], 0
    ds_read_b64_tr_b16 a[164:165], v21 offset:4608
    v_mfma_f32_16x16x32_bf16 v[232:235], a[148:151], a[20:23], v[232:235]
    ds_read_b64_tr_b16 a[166:167], v21 offset:4864
    v_mfma_f32_16x16x32_bf16 v[236:239], a[144:147], a[24:27], 0
    ds_read_b64_tr_b16 a[168:169], v21 offset:4128
    v_mfma_f32_16x16x32_bf16 v[236:239], a[148:151], a[28:31], v[236:239]
    s_waitcnt lgkmcnt(6)
    ds_read_b64_tr_b16 a[170:171], v21 offset:4384
    v_mfma_f32_16x16x32_bf16 v[240:243], a[152:155], a[0:3], 0
    s_waitcnt lgkmcnt(6)
    ds_read_b64_tr_b16 a[172:173], v21 offset:4640
    v_mfma_f32_16x16x32_bf16 v[240:243], a[156:159], a[4:7], v[240:243]
    ds_read_b64_tr_b16 a[174:175], v21 offset:4896
    v_mfma_f32_16x16x32_bf16 v[244:247], a[152:155], a[8:11], 0
    ds_read_b128 a[40:43], v18 offset:34880
    v_mfma_f32_16x16x32_bf16 v[244:247], a[156:159], a[12:15], v[244:247]
    ds_read_b128 a[44:47], v18 offset:35904
    v_mfma_f32_16x16x32_bf16 v[248:251], a[152:155], a[16:19], 0
    ds_read_b128 a[48:51], v18 offset:36928
    v_mfma_f32_16x16x32_bf16 v[248:251], a[156:159], a[20:23], v[248:251]
    ds_read_b128 a[52:55], v18 offset:37952
    v_mfma_f32_16x16x32_bf16 v[252:255], a[152:155], a[24:27], 0
    ds_read_b128 a[56:59], v18 offset:38976
    v_mfma_f32_16x16x32_bf16 v[252:255], a[156:159], a[28:31], v[252:255]
    s_waitcnt lgkmcnt(6)
    ds_read_b128 a[60:63], v18 offset:40000
    v_mfma_f32_16x16x32_bf16 v[96:99], a[160:163], a[0:3], 0
    v_mfma_f32_16x16x32_bf16 v[96:99], a[164:167], a[4:7], v[96:99]
    v_mfma_f32_16x16x32_bf16 v[100:103], a[160:163], a[8:11], 0
    s_waitcnt lgkmcnt(0)
    s_barrier
    v_mfma_f32_16x16x32_bf16 v[100:103], a[164:167], a[12:15], v[100:103]
    ds_read_b64_tr_b16 a[128:129], v21 offset:24704
    v_mfma_f32_16x16x32_bf16 v[104:107], a[160:163], a[16:19], 0
    ds_read_b64_tr_b16 a[130:131], v21 offset:25728
    v_mfma_f32_16x16x32_bf16 v[104:107], a[164:167], a[20:23], v[104:107]
    ds_read_b64_tr_b16 a[132:133], v21 offset:26752
    v_mfma_f32_16x16x32_bf16 v[108:111], a[160:163], a[24:27], 0
    ds_read_b64_tr_b16 a[134:135], v21 offset:27776
    v_mfma_f32_16x16x32_bf16 v[108:111], a[164:167], a[28:31], v[108:111]
    s_add_u32 m0, s95, 0
    ds_read_b64_tr_b16 a[136:137], v21 offset:24736
    v_mfma_f32_16x16x32_bf16 v[112:115], a[168:171], a[0:3], 0
    buffer_load_dwordx4 v17, s[16:19], s54 offen offset:0 lds
    v_mfma_f32_16x16x32_bf16 v[112:115], a[172:175], a[4:7], v[112:115]
    ds_read_b64_tr_b16 a[138:139], v21 offset:25760
    v_mfma_f32_16x16x32_bf16 v[116:119], a[168:171], a[8:11], 0
    ds_read_b64_tr_b16 a[140:141], v21 offset:26784
    v_mfma_f32_16x16x32_bf16 v[116:119], a[172:175], a[12:15], v[116:119]
    s_add_u32 m0, s95, 960
    ds_read_b64_tr_b16 a[142:143], v21 offset:27808
    v_mfma_f32_16x16x32_bf16 v[120:123], a[168:171], a[16:19], 0
    buffer_load_dwordx4 v17, s[16:19], s54 offen offset:64 lds
    v_mfma_f32_16x16x32_bf16 v[120:123], a[172:175], a[20:23], v[120:123]
    ds_read_b64_tr_b16 a[144:145], v21 offset:24960
    v_mfma_f32_16x16x32_bf16 v[124:127], a[168:171], a[24:27], 0
    ds_read_b64_tr_b16 a[146:147], v21 offset:25984
    v_mfma_f32_16x16x32_bf16 v[124:127], a[172:175], a[28:31], v[124:127]
    s_waitcnt lgkmcnt(5)
    s_add_u32 m0, s94, 4096
    ds_read_b64_tr_b16 a[148:149], v21 offset:27008
    v_mfma_f32_16x16x32_bf16 v[128:131], a[128:131], a[32:35], v[128:131]
    buffer_load_dwordx4 v16, s[16:19], s55 offen offset:0 lds
    v_mfma_f32_16x16x32_bf16 v[128:131], a[132:135], a[36:39], v[128:131]
    ds_read_b64_tr_b16 a[150:151], v21 offset:28032
    v_mfma_f32_16x16x32_bf16 v[132:135], a[128:131], a[40:43], v[132:135]
    ds_read_b64_tr_b16 a[152:153], v21 offset:29824
    v_mfma_f32_16x16x32_bf16 v[132:135], a[132:135], a[44:47], v[132:135]
    s_add_u32 m0, s94, 5056
    ds_read_b64_tr_b16 a[154:155], v21 offset:30080
    v_mfma_f32_16x16x32_bf16 v[136:139], a[128:131], a[48:51], v[136:139]
    buffer_load_dwordx4 v16, s[16:19], s55 offen offset:64 lds
    v_mfma_f32_16x16x32_bf16 v[136:139], a[132:135], a[52:55], v[136:139]
    ds_read_b64_tr_b16 a[156:157], v21 offset:30336
    v_mfma_f32_16x16x32_bf16 v[140:143], a[128:131], a[56:59], v[140:143]
    ds_read_b64_tr_b16 a[158:159], v21 offset:30592
    v_mfma_f32_16x16x32_bf16 v[140:143], a[132:135], a[60:63], v[140:143]
    s_waitcnt lgkmcnt(5)
    s_add_u32 m0, s95, 4096
    ds_read_b64_tr_b16 a[160:161], v21 offset:24992
    v_mfma_f32_16x16x32_bf16 v[144:147], a[136:139], a[32:35], v[144:147]
    buffer_load_dwordx4 v17, s[16:19], s55 offen offset:0 lds
    v_mfma_f32_16x16x32_bf16 v[144:147], a[140:143], a[36:39], v[144:147]
    ds_read_b64_tr_b16 a[162:163], v21 offset:26016
    v_mfma_f32_16x16x32_bf16 v[148:151], a[136:139], a[40:43], v[148:151]
    ds_read_b64_tr_b16 a[164:165], v21 offset:27040
    v_mfma_f32_16x16x32_bf16 v[148:151], a[140:143], a[44:47], v[148:151]
    s_add_u32 m0, s95, 5056
    ds_read_b64_tr_b16 a[166:167], v21 offset:28064
    v_mfma_f32_16x16x32_bf16 v[152:155], a[136:139], a[48:51], v[152:155]
    buffer_load_dwordx4 v17, s[16:19], s55 offen offset:64 lds
    v_mfma_f32_16x16x32_bf16 v[152:155], a[140:143], a[52:55], v[152:155]
    ds_read_b64_tr_b16 a[64:65], v22 offset:24704
    v_mfma_f32_16x16x32_bf16 v[156:159], a[136:139], a[56:59], v[156:159]
    ds_read_b64_tr_b16 a[66:67], v22 offset:25728
    v_mfma_f32_16x16x32_bf16 v[156:159], a[140:143], a[60:63], v[156:159]
    s_xor_b32 s58, s44, 3
    s_lshl_b32 s56, s58, 19
    s_mul_i32 s58, s58, 176128
    s_add_u32 m0, s47, 0
    v_mfma_f32_16x16x32_bf16 v[160:163], a[144:147], a[32:35], v[160:163]
    s_waitcnt lgkmcnt(4)
    buffer_load_dwordx4 v19, s[20:23], s56 offen offset:0 lds
    v_mfma_f32_16x16x32_bf16 v[160:163], a[148:151], a[36:39], v[160:163]
    ds_read_b64_tr_b16 a[68:69], v22 offset:26752
    v_mfma_f32_16x16x32_bf16 v[164:167], a[144:147], a[40:43], v[164:167]
    ds_read_b64_tr_b16 a[70:71], v22 offset:27776
    v_mfma_f32_16x16x32_bf16 v[164:167], a[148:151], a[44:47], v[164:167]
    s_add_u32 s57, s56, 31744
    ds_read_b64_tr_b16 a[168:169], v21 offset:25216
    v_mfma_f32_16x16x32_bf16 v[168:171], a[144:147], a[48:51], v[168:171]
    buffer_load_dwordx4 v19, s[20:23], s57 offen offset:1024 lds
    v_mfma_f32_16x16x32_bf16 v[168:171], a[148:151], a[52:55], v[168:171]
    ds_read_b64_tr_b16 a[170:171], v21 offset:26240
    v_mfma_f32_16x16x32_bf16 v[172:175], a[144:147], a[56:59], v[172:175]
    ds_read_b64_tr_b16 a[172:173], v21 offset:27264
    v_mfma_f32_16x16x32_bf16 v[172:175], a[148:151], a[60:63], v[172:175]
    s_add_u32 s57, s56, 260096
    ds_read_b64_tr_b16 a[174:175], v21 offset:28288
    v_mfma_f32_16x16x32_bf16 v[64:67], a[152:155], a[32:35], v[64:67]
    buffer_load_dwordx4 v19, s[20:23], s57 offen offset:2048 lds
    v_mfma_f32_16x16x32_bf16 v[64:67], a[156:159], a[36:39], v[64:67]
    ds_read_b64_tr_b16 a[72:73], v22 offset:24736
    v_mfma_f32_16x16x32_bf16 v[68:71], a[152:155], a[40:43], v[68:71]
    ds_read_b64_tr_b16 a[74:75], v22 offset:25760
    v_mfma_f32_16x16x32_bf16 v[68:71], a[156:159], a[44:47], v[68:71]
    s_add_u32 s57, s56, 291840
    ds_read_b64_tr_b16 a[76:77], v22 offset:26784
    v_mfma_f32_16x16x32_bf16 v[176:179], a[160:163], a[32:35], v[176:179]
    s_waitcnt lgkmcnt(5)
    buffer_load_dwordx4 v19, s[20:23], s57 offen offset:3072 lds
    v_mfma_f32_16x16x32_bf16 v[176:179], a[164:167], a[36:39], v[176:179]
    ds_read_b64_tr_b16 a[78:79], v22 offset:27808
    v_mfma_f32_16x16x32_bf16 v[180:183], a[160:163], a[40:43], v[180:183]
    ds_read_b64_tr_b16 a[128:129], v21 offset:25248
    v_mfma_f32_16x16x32_bf16 v[180:183], a[164:167], a[44:47], v[180:183]
    s_add_u32 m0, s47, 4096
    ds_read_b64_tr_b16 a[130:131], v21 offset:26272
    v_mfma_f32_16x16x32_bf16 v[184:187], a[160:163], a[48:51], v[184:187]
    buffer_load_dwordx4 v20, s[24:27], s58 offen lds
    v_mfma_f32_16x16x32_bf16 v[184:187], a[164:167], a[52:55], v[184:187]
    ds_read_b64_tr_b16 a[132:133], v21 offset:27296
    v_mfma_f32_16x16x32_bf16 v[188:191], a[160:163], a[56:59], v[188:191]
    ds_read_b64_tr_b16 a[134:135], v21 offset:28320
    v_mfma_f32_16x16x32_bf16 v[188:191], a[164:167], a[60:63], v[188:191]
    ds_read_b64_tr_b16 a[80:81], v23 offset:28800
    v_smfmac_f32_16x16x64_bf16 a[88:91], v[8:11], a[64:71], v5
    s_add_u32 m0, s47, 5120
    ds_read_b64_tr_b16 a[82:83], v23 offset:29056
    v_mfma_f32_16x16x32_bf16 v[192:195], a[168:171], a[32:35], v[192:195]
    s_waitcnt lgkmcnt(5)
    buffer_load_dwordx4 v20, s[28:31], s58 offen lds
    v_mfma_f32_16x16x32_bf16 v[192:195], a[172:175], a[36:39], v[192:195]
    ds_read_b64_tr_b16 a[84:85], v23 offset:29312
    v_mfma_f32_16x16x32_bf16 v[196:199], a[168:171], a[40:43], v[196:199]
    ds_read_b64_tr_b16 a[86:87], v23 offset:29568
    v_mfma_f32_16x16x32_bf16 v[196:199], a[172:175], a[44:47], v[196:199]
    ds_read_b64_tr_b16 a[136:137], v21 offset:29856
    v_mfma_f32_16x16x32_bf16 v[200:203], a[168:171], a[48:51], v[200:203]
    ds_read_b64_tr_b16 a[138:139], v21 offset:30112
    v_mfma_f32_16x16x32_bf16 v[200:203], a[172:175], a[52:55], v[200:203]
    s_xor_b32 s54, s44, 3
    s_lshl_b32 s54, s54, 7
    s_lshl_b32 s55, s39, 15
    s_add_u32 s54, s54, s55
    s_xor_b32 s55, s54, 0x8000
    s_add_u32 m0, s94, 32832
    v_mfma_f32_16x16x32_bf16 v[204:207], a[168:171], a[56:59], v[204:207]
    buffer_load_dwordx4 v16, s[16:19], s54 offen offset:0 lds
    v_mfma_f32_16x16x32_bf16 v[204:207], a[172:175], a[60:63], v[204:207]
    ds_read_b64_tr_b16 a[140:141], v21 offset:30368
    v_smfmac_f32_16x16x64_bf16 a[92:95], v[8:11], a[72:79], v5
    s_waitcnt lgkmcnt(4)
    ds_read_b64_tr_b16 a[142:143], v21 offset:30624
    v_mfma_f32_16x16x32_bf16 v[208:211], a[128:131], a[32:35], v[208:211]
    s_add_u32 m0, s94, 33792
    ds_read_b64_tr_b16 a[144:145], v21 offset:25472
    v_mfma_f32_16x16x32_bf16 v[208:211], a[132:135], a[36:39], v[208:211]
    buffer_load_dwordx4 v16, s[16:19], s54 offen offset:64 lds
    v_mfma_f32_16x16x32_bf16 v[212:215], a[128:131], a[40:43], v[212:215]
    ds_read_b64_tr_b16 a[146:147], v21 offset:26496
    v_mfma_f32_16x16x32_bf16 v[212:215], a[132:135], a[44:47], v[212:215]
    ds_read_b64_tr_b16 a[148:149], v21 offset:27520
    v_mfma_f32_16x16x32_bf16 v[216:219], a[128:131], a[48:51], v[216:219]
    ds_read_b64_tr_b16 a[150:151], v21 offset:28544
    v_mfma_f32_16x16x32_bf16 v[216:219], a[132:135], a[52:55], v[216:219]
    ds_read_b64_tr_b16 a[152:153], v21 offset:25504
    v_mfma_f32_16x16x32_bf16 v[220:223], a[128:131], a[56:59], v[220:223]
    ds_read_b64_tr_b16 a[154:155], v21 offset:26528
    v_mfma_f32_16x16x32_bf16 v[220:223], a[132:135], a[60:63], v[220:223]
    s_waitcnt lgkmcnt(5)
    ds_read_b64_tr_b16 a[156:157], v21 offset:27552
    v_smfmac_f32_16x16x64_bf16 a[96:99], v[8:11], a[80:87], v5
    ds_read_b64_tr_b16 a[158:159], v21 offset:28576
    v_mfma_f32_16x16x32_bf16 v[72:75], a[136:139], a[32:35], v[72:75]
    s_waitcnt vmcnt(8)
    ds_read_b64_tr_b16 a[160:161], v21 offset:28800
    v_mfma_f32_16x16x32_bf16 v[72:75], a[140:143], a[36:39], v[72:75]
    ds_read_b64_tr_b16 a[162:163], v21 offset:29056
    v_mfma_f32_16x16x32_bf16 v[76:79], a[136:139], a[40:43], v[76:79]
    ds_read_b64_tr_b16 a[164:165], v21 offset:29312
    v_mfma_f32_16x16x32_bf16 v[76:79], a[140:143], a[44:47], v[76:79]
    s_waitcnt lgkmcnt(6)
    ds_read_b64_tr_b16 a[166:167], v21 offset:29568
    v_mfma_f32_16x16x32_bf16 v[224:227], a[144:147], a[32:35], v[224:227]
    ds_read_b64_tr_b16 a[168:169], v21 offset:28832
    v_mfma_f32_16x16x32_bf16 v[224:227], a[148:151], a[36:39], v[224:227]
    ds_read_b64_tr_b16 a[170:171], v21 offset:29088
    v_mfma_f32_16x16x32_bf16 v[228:231], a[144:147], a[40:43], v[228:231]
    ds_read_b64_tr_b16 a[172:173], v21 offset:29344
    v_mfma_f32_16x16x32_bf16 v[228:231], a[148:151], a[44:47], v[228:231]
    ds_read_b64_tr_b16 a[174:175], v21 offset:29600
    v_mfma_f32_16x16x32_bf16 v[232:235], a[144:147], a[48:51], v[232:235]
    ds_read_b128 a[0:3], v18 offset:0
    v_mfma_f32_16x16x32_bf16 v[232:235], a[148:151], a[52:55], v[232:235]
    ds_read_b128 a[4:7], v18 offset:1024
    v_mfma_f32_16x16x32_bf16 v[236:239], a[144:147], a[56:59], v[236:239]
    ds_read_b128 a[8:11], v18 offset:2048
    v_mfma_f32_16x16x32_bf16 v[236:239], a[148:151], a[60:63], v[236:239]
    s_waitcnt lgkmcnt(6)
    ds_read_b128 a[12:15], v18 offset:3072
    v_mfma_f32_16x16x32_bf16 v[240:243], a[152:155], a[32:35], v[240:243]
    ds_read_b128 a[16:19], v18 offset:4096
    v_mfma_f32_16x16x32_bf16 v[240:243], a[156:159], a[36:39], v[240:243]
    ds_read_b128 a[20:23], v18 offset:5120
    v_mfma_f32_16x16x32_bf16 v[244:247], a[152:155], a[40:43], v[244:247]
    ds_read_b128 a[24:27], v18 offset:6144
    v_mfma_f32_16x16x32_bf16 v[244:247], a[156:159], a[44:47], v[244:247]
    ds_read_b128 a[28:31], v18 offset:7168
    v_mfma_f32_16x16x32_bf16 v[248:251], a[152:155], a[48:51], v[248:251]
    v_mfma_f32_16x16x32_bf16 v[248:251], a[156:159], a[52:55], v[248:251]
    v_mfma_f32_16x16x32_bf16 v[252:255], a[152:155], a[56:59], v[252:255]
    v_mfma_f32_16x16x32_bf16 v[252:255], a[156:159], a[60:63], v[252:255]
    v_mfma_f32_16x16x32_bf16 v[96:99], a[160:163], a[32:35], v[96:99]
    v_mfma_f32_16x16x32_bf16 v[96:99], a[164:167], a[36:39], v[96:99]
    v_mfma_f32_16x16x32_bf16 v[100:103], a[160:163], a[40:43], v[100:103]
    s_waitcnt lgkmcnt(0)
    s_barrier
    v_mfma_f32_16x16x32_bf16 v[100:103], a[164:167], a[44:47], v[100:103]
    ds_read_b64_tr_b16 a[128:129], v21 offset:49408
    v_mfma_f32_16x16x32_bf16 v[104:107], a[160:163], a[48:51], v[104:107]
    ds_read_b64_tr_b16 a[130:131], v21 offset:50432
    v_mfma_f32_16x16x32_bf16 v[104:107], a[164:167], a[52:55], v[104:107]
    ds_read_b64_tr_b16 a[132:133], v21 offset:51456
    v_mfma_f32_16x16x32_bf16 v[108:111], a[160:163], a[56:59], v[108:111]
    ds_read_b64_tr_b16 a[134:135], v21 offset:52480
    v_mfma_f32_16x16x32_bf16 v[108:111], a[164:167], a[60:63], v[108:111]
    s_add_u32 m0, s95, 32832
    ds_read_b64_tr_b16 a[136:137], v21 offset:49440
    v_mfma_f32_16x16x32_bf16 v[112:115], a[168:171], a[32:35], v[112:115]
    buffer_load_dwordx4 v17, s[16:19], s54 offen offset:0 lds
    v_mfma_f32_16x16x32_bf16 v[112:115], a[172:175], a[36:39], v[112:115]
    ds_read_b64_tr_b16 a[138:139], v21 offset:50464
    v_mfma_f32_16x16x32_bf16 v[116:119], a[168:171], a[40:43], v[116:119]
    ds_read_b64_tr_b16 a[140:141], v21 offset:51488
    v_mfma_f32_16x16x32_bf16 v[116:119], a[172:175], a[44:47], v[116:119]
    s_add_u32 m0, s95, 33792
    ds_read_b64_tr_b16 a[142:143], v21 offset:52512
    v_mfma_f32_16x16x32_bf16 v[120:123], a[168:171], a[48:51], v[120:123]
    buffer_load_dwordx4 v17, s[16:19], s54 offen offset:64 lds
    v_mfma_f32_16x16x32_bf16 v[120:123], a[172:175], a[52:55], v[120:123]
    ds_read_b64_tr_b16 a[144:145], v21 offset:49664
    v_mfma_f32_16x16x32_bf16 v[124:127], a[168:171], a[56:59], v[124:127]
    ds_read_b64_tr_b16 a[146:147], v21 offset:50688
    v_mfma_f32_16x16x32_bf16 v[124:127], a[172:175], a[60:63], v[124:127]
    s_waitcnt lgkmcnt(5)
    s_add_u32 m0, s94, 36928
    ds_read_b64_tr_b16 a[148:149], v21 offset:51712
    v_mfma_f32_16x16x32_bf16 v[128:131], a[128:131], a[0:3], v[128:131]
    buffer_load_dwordx4 v16, s[16:19], s55 offen offset:0 lds
    v_mfma_f32_16x16x32_bf16 v[128:131], a[132:135], a[4:7], v[128:131]
    ds_read_b64_tr_b16 a[150:151], v21 offset:52736
    v_mfma_f32_16x16x32_bf16 v[132:135], a[128:131], a[8:11], v[132:135]
    ds_read_b64_tr_b16 a[152:153], v21 offset:54528
    v_mfma_f32_16x16x32_bf16 v[132:135], a[132:135], a[12:15], v[132:135]
    s_add_u32 m0, s94, 37888
    ds_read_b64_tr_b16 a[154:155], v21 offset:54784
    v_mfma_f32_16x16x32_bf16 v[136:139], a[128:131], a[16:19], v[136:139]
    buffer_load_dwordx4 v16, s[16:19], s55 offen offset:64 lds
    v_mfma_f32_16x16x32_bf16 v[136:139], a[132:135], a[20:23], v[136:139]
    ds_read_b64_tr_b16 a[156:157], v21 offset:55040
    v_mfma_f32_16x16x32_bf16 v[140:143], a[128:131], a[24:27], v[140:143]
    ds_read_b64_tr_b16 a[158:159], v21 offset:55296
    v_mfma_f32_16x16x32_bf16 v[140:143], a[132:135], a[28:31], v[140:143]
    s_waitcnt lgkmcnt(5)
    s_add_u32 m0, s95, 36928
    ds_read_b64_tr_b16 a[160:161], v21 offset:49696
    v_mfma_f32_16x16x32_bf16 v[144:147], a[136:139], a[0:3], v[144:147]
    buffer_load_dwordx4 v17, s[16:19], s55 offen offset:0 lds
    v_mfma_f32_16x16x32_bf16 v[144:147], a[140:143], a[4:7], v[144:147]
    ds_read_b64_tr_b16 a[162:163], v21 offset:50720
    v_mfma_f32_16x16x32_bf16 v[148:151], a[136:139], a[8:11], v[148:151]
    ds_read_b64_tr_b16 a[164:165], v21 offset:51744
    v_mfma_f32_16x16x32_bf16 v[148:151], a[140:143], a[12:15], v[148:151]
    s_add_u32 m0, s95, 37888
    ds_read_b64_tr_b16 a[166:167], v21 offset:52768
    v_mfma_f32_16x16x32_bf16 v[152:155], a[136:139], a[16:19], v[152:155]
    buffer_load_dwordx4 v17, s[16:19], s55 offen offset:64 lds
    v_mfma_f32_16x16x32_bf16 v[152:155], a[140:143], a[20:23], v[152:155]
    ds_read_b64_tr_b16 a[64:65], v22 offset:49408
    v_mfma_f32_16x16x32_bf16 v[156:159], a[136:139], a[24:27], v[156:159]
    ds_read_b64_tr_b16 a[66:67], v22 offset:50432
    v_mfma_f32_16x16x32_bf16 v[156:159], a[140:143], a[28:31], v[156:159]
    s_lshl_b32 s59, s38, 5
    ds_read_b64_tr_b16 a[68:69], v22 offset:51456
    v_mfma_f32_16x16x32_bf16 v[160:163], a[144:147], a[0:3], v[160:163]
    s_waitcnt lgkmcnt(5)
    buffer_atomic_add v90, v87, s[32:35], s59 offen offset:4 sc1
    v_mfma_f32_16x16x32_bf16 v[160:163], a[148:151], a[4:7], v[160:163]
    ds_read_b64_tr_b16 a[70:71], v22 offset:52480
    v_mfma_f32_16x16x32_bf16 v[164:167], a[144:147], a[8:11], v[164:167]
    ds_read_b64_tr_b16 a[168:169], v21 offset:49920
    v_mfma_f32_16x16x32_bf16 v[164:167], a[148:151], a[12:15], v[164:167]
    s_xor_b32 s58, s44, 4
    s_lshl_b32 s56, s58, 19
    s_mul_i32 s58, s58, 176128
    s_add_u32 m0, s47, 24704
    v_mfma_f32_16x16x32_bf16 v[168:171], a[144:147], a[16:19], v[168:171]
    buffer_load_dwordx4 v19, s[20:23], s56 offen offset:0 lds
    v_mfma_f32_16x16x32_bf16 v[168:171], a[148:151], a[20:23], v[168:171]
    ds_read_b64_tr_b16 a[170:171], v21 offset:50944
    v_mfma_f32_16x16x32_bf16 v[172:175], a[144:147], a[24:27], v[172:175]
    ds_read_b64_tr_b16 a[172:173], v21 offset:51968
    v_mfma_f32_16x16x32_bf16 v[172:175], a[148:151], a[28:31], v[172:175]
    s_add_u32 s57, s56, 31744
    ds_read_b64_tr_b16 a[174:175], v21 offset:52992
    v_mfma_f32_16x16x32_bf16 v[64:67], a[152:155], a[0:3], v[64:67]
    buffer_load_dwordx4 v19, s[20:23], s57 offen offset:1024 lds
    v_mfma_f32_16x16x32_bf16 v[64:67], a[156:159], a[4:7], v[64:67]
    ds_read_b64_tr_b16 a[72:73], v22 offset:49440
    v_mfma_f32_16x16x32_bf16 v[68:71], a[152:155], a[8:11], v[68:71]
    ds_read_b64_tr_b16 a[74:75], v22 offset:50464
    v_mfma_f32_16x16x32_bf16 v[68:71], a[156:159], a[12:15], v[68:71]
    s_add_u32 s57, s56, 260096
    ds_read_b64_tr_b16 a[76:77], v22 offset:51488
    v_mfma_f32_16x16x32_bf16 v[176:179], a[160:163], a[0:3], v[176:179]
    s_waitcnt lgkmcnt(5)
    buffer_load_dwordx4 v19, s[20:23], s57 offen offset:2048 lds
    v_mfma_f32_16x16x32_bf16 v[176:179], a[164:167], a[4:7], v[176:179]
    ds_read_b64_tr_b16 a[78:79], v22 offset:52512
    v_mfma_f32_16x16x32_bf16 v[180:183], a[160:163], a[8:11], v[180:183]
    ds_read_b64_tr_b16 a[128:129], v21 offset:49952
    v_mfma_f32_16x16x32_bf16 v[180:183], a[164:167], a[12:15], v[180:183]
    s_add_u32 s57, s56, 291840
    ds_read_b64_tr_b16 a[130:131], v21 offset:50976
    v_mfma_f32_16x16x32_bf16 v[184:187], a[160:163], a[16:19], v[184:187]
    buffer_load_dwordx4 v19, s[20:23], s57 offen offset:3072 lds
    v_mfma_f32_16x16x32_bf16 v[184:187], a[164:167], a[20:23], v[184:187]
    ds_read_b64_tr_b16 a[132:133], v21 offset:52000
    v_mfma_f32_16x16x32_bf16 v[188:191], a[160:163], a[24:27], v[188:191]
    ds_read_b64_tr_b16 a[134:135], v21 offset:53024
    v_mfma_f32_16x16x32_bf16 v[188:191], a[164:167], a[28:31], v[188:191]
    ds_read_b64_tr_b16 a[80:81], v23 offset:53504
    v_smfmac_f32_16x16x64_bf16 a[88:91], v[8:11], a[64:71], v5
    s_add_u32 m0, s47, 28800
    ds_read_b64_tr_b16 a[82:83], v23 offset:53760
    v_mfma_f32_16x16x32_bf16 v[192:195], a[168:171], a[0:3], v[192:195]
    s_waitcnt lgkmcnt(5)
    buffer_load_dwordx4 v20, s[24:27], s58 offen lds
    v_mfma_f32_16x16x32_bf16 v[192:195], a[172:175], a[4:7], v[192:195]
L_hop0:
    s_cbranch_execz L_hop4
    ds_read_b64_tr_b16 a[84:85], v23 offset:54016
    v_mfma_f32_16x16x32_bf16 v[196:199], a[168:171], a[8:11], v[196:199]
    ds_read_b64_tr_b16 a[86:87], v23 offset:54272
    v_mfma_f32_16x16x32_bf16 v[196:199], a[172:175], a[12:15], v[196:199]
    s_add_u32 m0, s47, 29824
    ds_read_b64_tr_b16 a[136:137], v21 offset:54560
    v_mfma_f32_16x16x32_bf16 v[200:203], a[168:171], a[16:19], v[200:203]
    buffer_load_dwordx4 v20, s[28:31], s58 offen lds
    v_mfma_f32_16x16x32_bf16 v[200:203], a[172:175], a[20:23], v[200:203]
    ds_read_b64_tr_b16 a[138:139], v21 offset:54816
    v_mfma_f32_16x16x32_bf16 v[204:207], a[168:171], a[24:27], v[204:207]
    ds_read_b64_tr_b16 a[140:141], v21 offset:55072
    v_mfma_f32_16x16x32_bf16 v[204:207], a[172:175], a[28:31], v[204:207]
    ds_read_b64_tr_b16 a[142:143], v21 offset:55328
    v_smfmac_f32_16x16x64_bf16 a[92:95], v[8:11], a[72:79], v5
    s_waitcnt lgkmcnt(5)
    ds_read_b64_tr_b16 a[144:145], v21 offset:50176
    v_mfma_f32_16x16x32_bf16 v[208:211], a[128:131], a[0:3], v[208:211]
    s_xor_b32 s54, s44, 4
    s_lshl_b32 s54, s54, 7
    s_lshl_b32 s55, s39, 15
    s_add_u32 s54, s54, s55
    s_xor_b32 s55, s54, 0x8000
    s_add_u32 m0, s94, 0
    v_mfma_f32_16x16x32_bf16 v[208:211], a[132:135], a[4:7], v[208:211]
    buffer_load_dwordx4 v16, s[16:19], s54 offen offset:0 lds
    v_mfma_f32_16x16x32_bf16 v[212:215], a[128:131], a[8:11], v[212:215]
    ds_read_b64_tr_b16 a[146:147], v21 offset:51200
    v_mfma_f32_16x16x32_bf16 v[212:215], a[132:135], a[12:15], v[212:215]
    ds_read_b64_tr_b16 a[148:149], v21 offset:52224
    v_mfma_f32_16x16x32_bf16 v[216:219], a[128:131], a[16:19], v[216:219]
    s_add_u32 m0, s94, 960
    ds_read_b64_tr_b16 a[150:151], v21 offset:53248
    v_mfma_f32_16x16x32_bf16 v[216:219], a[132:135], a[20:23], v[216:219]
    buffer_load_dwordx4 v16, s[16:19], s54 offen offset:64 lds
    v_mfma_f32_16x16x32_bf16 v[220:223], a[128:131], a[24:27], v[220:223]
    ds_read_b64_tr_b16 a[152:153], v21 offset:50208
    v_mfma_f32_16x16x32_bf16 v[220:223], a[132:135], a[28:31], v[220:223]
    s_waitcnt lgkmcnt(4)
    ds_read_b64_tr_b16 a[154:155], v21 offset:51232
    v_smfmac_f32_16x16x64_bf16 a[96:99], v[8:11], a[80:87], v5
    ds_read_b64_tr_b16 a[156:157], v21 offset:52256
    v_mfma_f32_16x16x32_bf16 v[72:75], a[136:139], a[0:3], v[72:75]
    s_waitcnt vmcnt(9)
    ds_read_b64_tr_b16 a[158:159], v21 offset:53280
    v_mfma_f32_16x16x32_bf16 v[72:75], a[140:143], a[4:7], v[72:75]
    ds_read_b64_tr_b16 a[160:161], v21 offset:53504
    v_mfma_f32_16x16x32_bf16 v[76:79], a[136:139], a[8:11], v[76:79]
    ds_read_b64_tr_b16 a[162:163], v21 offset:53760
    v_mfma_f32_16x16x32_bf16 v[76:79], a[140:143], a[12:15], v[76:79]
    s_waitcnt lgkmcnt(6)
    ds_read_b64_tr_b16 a[164:165], v21 offset:54016
    v_mfma_f32_16x16x32_bf16 v[224:227], a[144:147], a[0:3], v[224:227]
    ds_read_b64_tr_b16 a[166:167], v21 offset:54272
    v_mfma_f32_16x16x32_bf16 v[224:227], a[148:151], a[4:7], v[224:227]
    ds_read_b64_tr_b16 a[168:169], v21 offset:53536
    v_mfma_f32_16x16x32_bf16 v[228:231], a[144:147], a[8:11], v[228:231]
    ds_read_b64_tr_b16 a[170:171], v21 offset:53792
    v_mfma_f32_16x16x32_bf16 v[228:231], a[148:151], a[12:15], v[228:231]
    ds_read_b64_tr_b16 a[172:173], v21 offset:54048
    v_mfma_f32_16x16x32_bf16 v[232:235], a[144:147], a[16:19], v[232:235]
    ds_read_b64_tr_b16 a[174:175], v21 offset:54304
    v_mfma_f32_16x16x32_bf16 v[232:235], a[148:151], a[20:23], v[232:235]
    ds_read_b128 a[32:35], v18 offset:32832
    v_mfma_f32_16x16x32_bf16 v[236:239], a[144:147], a[24:27], v[236:239]
    ds_read_b128 a[36:39], v18 offset:33856
    v_mfma_f32_16x16x32_bf16 v[236:239], a[148:151], a[28:31], v[236:239]
    s_waitcnt lgkmcnt(6)
    ds_read_b128 a[40:43], v18 offset:34880
    v_mfma_f32_16x16x32_bf16 v[240:243], a[152:155], a[0:3], v[240:243]
    ds_read_b128 a[44:47], v18 offset:35904
    v_mfma_f32_16x16x32_bf16 v[240:243], a[156:159], a[4:7], v[240:243]
    ds_read_b128 a[48:51], v18 offset:36928
    v_mfma_f32_16x16x32_bf16 v[244:247], a[152:155], a[8:11], v[244:247]
    ds_read_b128 a[52:55], v18 offset:37952
    v_mfma_f32_16x16x32_bf16 v[244:247], a[156:159], a[12:15], v[244:247]
    ds_read_b128 a[56:59], v18 offset:38976
    v_mfma_f32_16x16x32_bf16 v[248:251], a[152:155], a[16:19], v[248:251]
    ds_read_b128 a[60:63], v18 offset:40000
    v_mfma_f32_16x16x32_bf16 v[248:251], a[156:159], a[20:23], v[248:251]
    v_mfma_f32_16x16x32_bf16 v[252:255], a[152:155], a[24:27], v[252:255]
    v_mfma_f32_16x16x32_bf16 v[252:255], a[156:159], a[28:31], v[252:255]
    v_mfma_f32_16x16x32_bf16 v[96:99], a[160:163], a[0:3], v[96:99]
    v_mfma_f32_16x16x32_bf16 v[96:99], a[164:167], a[4:7], v[96:99]
    v_mfma_f32_16x16x32_bf16 v[100:103], a[160:163], a[8:11], v[100:103]
    s_waitcnt lgkmcnt(0)
    s_barrier
    v_mfma_f32_16x16x32_bf16 v[100:103], a[164:167], a[12:15], v[100:103]
    ds_read_b64_tr_b16 a[128:129], v21 offset:0
    v_mfma_f32_16x16x32_bf16 v[104:107], a[160:163], a[16:19], v[104:107]
    ds_read_b64_tr_b16 a[130:131], v21 offset:1024
    v_mfma_f32_16x16x32_bf16 v[104:107], a[164:167], a[20:23], v[104:107]
    ds_read_b64_tr_b16 a[132:133], v21 offset:2048
    v_mfma_f32_16x16x32_bf16 v[108:111], a[160:163], a[24:27], v[108:111]
    ds_read_b64_tr_b16 a[134:135], v21 offset:3072
    v_mfma_f32_16x16x32_bf16 v[108:111], a[164:167], a[28:31], v[108:111]
    s_add_u32 m0, s95, 0
    ds_read_b64_tr_b16 a[136:137], v21 offset:32
    v_mfma_f32_16x16x32_bf16 v[112:115], a[168:171], a[0:3], v[112:115]
    buffer_load_dwordx4 v17, s[16:19], s54 offen offset:0 lds
    v_mfma_f32_16x16x32_bf16 v[112:115], a[172:175], a[4:7], v[112:115]
    ds_read_b64_tr_b16 a[138:139], v21 offset:1056
    v_mfma_f32_16x16x32_bf16 v[116:119], a[168:171], a[8:11], v[116:119]
    ds_read_b64_tr_b16 a[140:141], v21 offset:2080
    v_mfma_f32_16x16x32_bf16 v[116:119], a[172:175], a[12:15], v[116:119]
    s_add_u32 m0, s95, 960
    ds_read_b64_tr_b16 a[142:143], v21 offset:3104
    v_mfma_f32_16x16x32_bf16 v[120:123], a[168:171], a[16:19], v[120:123]
    buffer_load_dwordx4 v17, s[16:19], s54 offen offset:64 lds
    v_mfma_f32_16x16x32_bf16 v[120:123], a[172:175], a[20:23], v[120:123]
    ds_read_b64_tr_b16 a[144:145], v21 offset:256
    v_mfma_f32_16x16x32_bf16 v[124:127], a[168:171], a[24:27], v[124:127]
    ds_read_b64_tr_b16 a[146:147], v21 offset:1280
    v_mfma_f32_16x16x32_bf16 v[124:127], a[172:175], a[28:31], v[124:127]
    s_waitcnt lgkmcnt(5)
    s_add_u32 m0, s94, 4096
    ds_read_b64_tr_b16 a[148:149], v21 offset:2304
    v_mfma_f32_16x16x32_bf16 v[128:131], a[128:131], a[32:35], v[128:131]
    buffer_load_dwordx4 v16, s[16:19], s55 offen offset:0 lds
    v_mfma_f32_16x16x32_bf16 v[128:131], a[132:135], a[36:39], v[128:131]
    ds_read_b64_tr_b16 a[150:151], v21 offset:3328
    v_mfma_f32_16x16x32_bf16 v[132:135], a[128:131], a[40:43], v[132:135]
    ds_read_b64_tr_b16 a[152:153], v21 offset:5120
    v_mfma_f32_16x16x32_bf16 v[132:135], a[132:135], a[44:47], v[132:135]
    s_add_u32 m0, s94, 5056
    ds_read_b64_tr_b16 a[154:155], v21 offset:5376
    v_mfma_f32_16x16x32_bf16 v[136:139], a[128:131], a[48:51], v[136:139]
    buffer_load_dwordx4 v16, s[16:19], s55 offen offset:64 lds
    v_mfma_f32_16x16x32_bf16 v[136:139], a[132:135], a[52:55], v[136:139]
    ds_read_b64_tr_b16 a[156:157], v21 offset:5632
    v_mfma_f32_16x16x32_bf16 v[140:143], a[128:131], a[56:59], v[140:143]
    ds_read_b64_tr_b16 a[158:159], v21 offset:5888
    v_mfma_f32_16x16x32_bf16 v[140:143], a[132:135], a[60:63], v[140:143]
    s_waitcnt lgkmcnt(5)
    s_add_u32 m0, s95, 4096
    ds_read_b64_tr_b16 a[160:161], v21 offset:288
    v_mfma_f32_16x16x32_bf16 v[144:147], a[136:139], a[32:35], v[144:147]
    buffer_load_dwordx4 v17, s[16:19], s55 offen offset:0 lds
    v_mfma_f32_16x16x32_bf16 v[144:147], a[140:143], a[36:39], v[144:147]
    ds_read_b64_tr_b16 a[162:163], v21 offset:1312
    v_mfma_f32_16x16x32_bf16 v[148:151], a[136:139], a[40:43], v[148:151]
    ds_read_b64_tr_b16 a[164:165], v21 offset:2336
    v_mfma_f32_16x16x32_bf16 v[148:151], a[140:143], a[44:47], v[148:151]
    s_add_u32 m0, s95, 5056
    ds_read_b64_tr_b16 a[166:167], v21 offset:3360
    v_mfma_f32_16x16x32_bf16 v[152:155], a[136:139], a[48:51], v[152:155]
    buffer_load_dwordx4 v17, s[16:19], s55 offen offset:64 lds
    v_mfma_f32_16x16x32_bf16 v[152:155], a[140:143], a[52:55], v[152:155]
    ds_read_b64_tr_b16 a[64:65], v22 offset:0
    v_mfma_f32_16x16x32_bf16 v[156:159], a[136:139], a[56:59], v[156:159]
    ds_read_b64_tr_b16 a[66:67], v22 offset:1024
    v_mfma_f32_16x16x32_bf16 v[156:159], a[140:143], a[60:63], v[156:159]
    s_xor_b32 s58, s44, 5
    s_lshl_b32 s56, s58, 19
    s_mul_i32 s58, s58, 176128
    s_add_u32 m0, s47, 49408
    v_mfma_f32_16x16x32_bf16 v[160:163], a[144:147], a[32:35], v[160:163]
    s_waitcnt lgkmcnt(4)
    buffer_load_dwordx4 v19, s[20:23], s56 offen offset:0 lds
    v_mfma_f32_16x16x32_bf16 v[160:163], a[148:151], a[36:39], v[160:163]
    ds_read_b64_tr_b16 a[68:69], v22 offset:2048
    v_mfma_f32_16x16x32_bf16 v[164:167], a[144:147], a[40:43], v[164:167]
    ds_read_b64_tr_b16 a[70:71], v22 offset:3072
    v_mfma_f32_16x16x32_bf16 v[164:167], a[148:151], a[44:47], v[164:167]
    s_add_u32 s57, s56, 31744
    ds_read_b64_tr_b16 a[168:169], v21 offset:512
    v_mfma_f32_16x16x32_bf16 v[168:171], a[144:147], a[48:51], v[168:171]
    buffer_load_dwordx4 v19, s[20:23], s57 offen offset:1024 lds
    v_mfma_f32_16x16x32_bf16 v[168:171], a[148:151], a[52:55], v[168:171]
    ds_read_b64_tr_b16 a[170:171], v21 offset:1536
    v_mfma_f32_16x16x32_bf16 v[172:175], a[144:147], a[56:59], v[172:175]
    ds_read_b64_tr_b16 a[172:173], v21 offset:2560
    v_mfma_f32_16x16x32_bf16 v[172:175], a[148:151], a[60:63], v[172:175]
    s_add_u32 s57, s56, 260096
    ds_read_b64_tr_b16 a[174:175], v21 offset:3584
    v_mfma_f32_16x16x32_bf16 v[64:67], a[152:155], a[32:35], v[64:67]
    buffer_load_dwordx4 v19, s[20:23], s57 offen offset:2048 lds
    v_mfma_f32_16x16x32_bf16 v[64:67], a[156:159], a[36:39], v[64:67]
    ds_read_b64_tr_b16 a[72:73], v22 offset:32
    v_mfma_f32_16x16x32_bf16 v[68:71], a[152:155], a[40:43], v[68:71]
    ds_read_b64_tr_b16 a[74:75], v22 offset:1056
    v_mfma_f32_16x16x32_bf16 v[68:71], a[156:159], a[44:47], v[68:71]
    s_add_u32 s57, s56, 291840
    ds_read_b64_tr_b16 a[76:77], v22 offset:2080
    v_mfma_f32_16x16x32_bf16 v[176:179], a[160:163], a[32:35], v[176:179]
    s_waitcnt lgkmcnt(5)
    buffer_load_dwordx4 v19, s[20:23], s57 offen offset:3072 lds
    v_mfma_f32_16x16x32_bf16 v[176:179], a[164:167], a[36:39], v[176:179]
    ds_read_b64_tr_b16 a[78:79], v22 offset:3104
    v_mfma_f32_16x16x32_bf16 v[180:183], a[160:163], a[40:43], v[180:183]
    ds_read_b64_tr_b16 a[128:129], v21 offset:544
    v_mfma_f32_16x16x32_bf16 v[180:183], a[164:167], a[44:47], v[180:183]
    s_add_u32 m0, s47, 53504
    ds_read_b64_tr_b16 a[130:131], v21 offset:1568
    v_mfma_f32_16x16x32_bf16 v[184:187], a[160:163], a[48:51], v[184:187]
    buffer_load_dwordx4 v20, s[24:27], s58 offen lds
    v_mfma_f32_16x16x32_bf16 v[184:187], a[164:167], a[52:55], v[184:187]
    ds_read_b64_tr_b16 a[132:133], v21 offset:2592
    v_mfma_f32_16x16x32_bf16 v[188:191], a[160:163], a[56:59], v[188:191]
    ds_read_b64_tr_b16 a[134:135], v21 offset:3616
    v_mfma_f32_16x16x32_bf16 v[188:191], a[164:167], a[60:63], v[188:191]
    ds_read_b64_tr_b16 a[80:81], v23 offset:4096
    v_smfmac_f32_16x16x64_bf16 a[88:91], v[8:11], a[64:71], v5
    s_add_u32 m0, s47, 54528
    ds_read_b64_tr_b16 a[82:83], v23 offset:4352
    v_mfma_f32_16x16x32_bf16 v[192:195], a[168:171], a[32:35], v[192:195]
    s_waitcnt lgkmcnt(5)
    buffer_load_dwordx4 v20, s[28:31], s58 offen lds
    v_mfma_f32_16x16x32_bf16 v[192:195], a[172:175], a[36:39], v[192:195]
    ds_read_b64_tr_b16 a[84:85], v23 offset:4608
    v_mfma_f32_16x16x32_bf16 v[196:199], a[168:171], a[40:43], v[196:199]
    ds_read_b64_tr_b16 a[86:87], v23 offset:4864
    v_mfma_f32_16x16x32_bf16 v[196:199], a[172:175], a[44:47], v[196:199]
    ds_read_b64_tr_b16 a[136:137], v21 offset:5152
    v_mfma_f32_16x16x32_bf16 v[200:203], a[168:171], a[48:51], v[200:203]
    ds_read_b64_tr_b16 a[138:139], v21 offset:5408
    v_mfma_f32_16x16x32_bf16 v[200:203], a[172:175], a[52:55], v[200:203]
    s_xor_b32 s54, s44, 5
    s_lshl_b32 s54, s54, 7
    s_lshl_b32 s55, s39, 15
    s_add_u32 s54, s54, s55
    s_xor_b32 s55, s54, 0x8000
    s_add_u32 m0, s94, 32832
    v_mfma_f32_16x16x32_bf16 v[204:207], a[168:171], a[56:59], v[204:207]
    buffer_load_dwordx4 v16, s[16:19], s54 offen offset:0 lds
    v_mfma_f32_16x16x32_bf16 v[204:207], a[172:175], a[60:63], v[204:207]
    ds_read_b64_tr_b16 a[140:141], v21 offset:5664
    v_smfmac_f32_16x16x64_bf16 a[92:95], v[8:11], a[72:79], v5
    s_waitcnt lgkmcnt(4)
    ds_read_b64_tr_b16 a[142:143], v21 offset:5920
    v_mfma_f32_16x16x32_bf16 v[208:211], a[128:131], a[32:35], v[208:211]
    s_add_u32 m0, s94, 33792
    ds_read_b64_tr_b16 a[144:145], v21 offset:768
    v_mfma_f32_16x16x32_bf16 v[208:211], a[132:135], a[36:39], v[208:211]
    buffer_load_dwordx4 v16, s[16:19], s54 offen offset:64 lds
    v_mfma_f32_16x16x32_bf16 v[212:215], a[128:131], a[40:43], v[212:215]
    ds_read_b64_tr_b16 a[146:147], v21 offset:1792
    v_mfma_f32_16x16x32_bf16 v[212:215], a[132:135], a[44:47], v[212:215]
    ds_read_b64_tr_b16 a[148:149], v21 offset:2816
    v_mfma_f32_16x16x32_bf16 v[216:219], a[128:131], a[48:51], v[216:219]
    ds_read_b64_tr_b16 a[150:151], v21 offset:3840
    v_mfma_f32_16x16x32_bf16 v[216:219], a[132:135], a[52:55], v[216:219]
    ds_read_b64_tr_b16 a[152:153], v21 offset:800
    v_mfma_f32_16x16x32_bf16 v[220:223], a[128:131], a[56:59], v[220:223]
    ds_read_b64_tr_b16 a[154:155], v21 offset:1824
    v_mfma_f32_16x16x32_bf16 v[220:223], a[132:135], a[60:63], v[220:223]
    s_waitcnt lgkmcnt(5)
    ds_read_b64_tr_b16 a[156:157], v21 offset:2848
    v_smfmac_f32_16x16x64_bf16 a[96:99], v[8:11], a[80:87], v5
    ds_read_b64_tr_b16 a[158:159], v21 offset:3872
    v_mfma_f32_16x16x32_bf16 v[72:75], a[136:139], a[32:35], v[72:75]
    s_waitcnt vmcnt(8)
    ds_read_b64_tr_b16 a[160:161], v21 offset:4096
    v_mfma_f32_16x16x32_bf16 v[72:75], a[140:143], a[36:39], v[72:75]
    ds_read_b64_tr_b16 a[162:163], v21 offset:4352
    v_mfma_f32_16x16x32_bf16 v[76:79], a[136:139], a[40:43], v[76:79]
    ds_read_b64_tr_b16 a[164:165], v21 offset:4608
    v_mfma_f32_16x16x32_bf16 v[76:79], a[140:143], a[44:47], v[76:79]
    s_waitcnt lgkmcnt(6)
    ds_read_b64_tr_b16 a[166:167], v21 offset:4864
    v_mfma_f32_16x16x32_bf16 v[224:227], a[144:147], a[32:35], v[224:227]
    ds_read_b64_tr_b16 a[168:169], v21 offset:4128
    v_mfma_f32_16x16x32_bf16 v[224:227], a[148:151], a[36:39], v[224:227]
    ds_read_b64_tr_b16 a[170:171], v21 offset:4384
    v_mfma_f32_16x16x32_bf16 v[228:231], a[144:147], a[40:43], v[228:231]
    ds_read_b64_tr_b16 a[172:173], v21 offset:4640
    v_mfma_f32_16x16x32_bf16 v[228:231], a[148:151], a[44:47], v[228:231]
    ds_read_b64_tr_b16 a[174:175], v21 offset:4896
    v_mfma_f32_16x16x32_bf16 v[232:235], a[144:147], a[48:51], v[232:235]
    ds_read_b128 a[0:3], v18 offset:0
    v_mfma_f32_16x16x32_bf16 v[232:235], a[148:151], a[52:55], v[232:235]
    ds_read_b128 a[4:7], v18 offset:1024
    v_mfma_f32_16x16x32_bf16 v[236:239], a[144:147], a[56:59], v[236:239]
    ds_read_b128 a[8:11], v18 offset:2048
    v_mfma_f32_16x16x32_bf16 v[236:239], a[148:151], a[60:63], v[236:239]
    s_waitcnt lgkmcnt(6)
    ds_read_b128 a[12:15], v18 offset:3072
    v_mfma_f32_16x16x32_bf16 v[240:243], a[152:155], a[32:35], v[240:243]
    ds_read_b128 a[16:19], v18 offset:4096
    v_mfma_f32_16x16x32_bf16 v[240:243], a[156:159], a[36:39], v[240:243]
    ds_read_b128 a[20:23], v18 offset:5120
    v_mfma_f32_16x16x32_bf16 v[244:247], a[152:155], a[40:43], v[244:247]
    ds_read_b128 a[24:27], v18 offset:6144
    v_mfma_f32_16x16x32_bf16 v[244:247], a[156:159], a[44:47], v[244:247]
    ds_read_b128 a[28:31], v18 offset:7168
    v_mfma_f32_16x16x32_bf16 v[248:251], a[152:155], a[48:51], v[248:251]
    v_mfma_f32_16x16x32_bf16 v[248:251], a[156:159], a[52:55], v[248:251]
    v_mfma_f32_16x16x32_bf16 v[252:255], a[152:155], a[56:59], v[252:255]
    v_mfma_f32_16x16x32_bf16 v[252:255], a[156:159], a[60:63], v[252:255]
    v_mfma_f32_16x16x32_bf16 v[96:99], a[160:163], a[32:35], v[96:99]
    v_mfma_f32_16x16x32_bf16 v[96:99], a[164:167], a[36:39], v[96:99]
    v_mfma_f32_16x16x32_bf16 v[100:103], a[160:163], a[40:43], v[100:103]
    s_waitcnt lgkmcnt(0)
    s_barrier
    v_mfma_f32_16x16x32_bf16 v[100:103], a[164:167], a[44:47], v[100:103]
    ds_read_b64_tr_b16 a[128:129], v21 offset:24704
    v_mfma_f32_16x16x32_bf16 v[104:107], a[160:163], a[48:51], v[104:107]
    ds_read_b64_tr_b16 a[130:131], v21 offset:25728
    v_mfma_f32_16x16x32_bf16 v[104:107], a[164:167], a[52:55], v[104:107]
    ds_read_b64_tr_b16 a[132:133], v21 offset:26752
    v_mfma_f32_16x16x32_bf16 v[108:111], a[160:163], a[56:59], v[108:111]
    ds_read_b64_tr_b16 a[134:135], v21 offset:27776
    v_mfma_f32_16x16x32_bf16 v[108:111], a[164:167], a[60:63], v[108:111]
    s_add_u32 m0, s95, 32832
    ds_read_b64_tr_b16 a[136:137], v21 offset:24736
    v_mfma_f32_16x16x32_bf16 v[112:115], a[168:171], a[32:35], v[112:115]
    buffer_load_dwordx4 v17, s[16:19], s54 offen offset:0 lds
    v_mfma_f32_16x16x32_bf16 v[112:115], a[172:175], a[36:39], v[112:115]
    ds_read_b64_tr_b16 a[138:139], v21 offset:25760
    v_mfma_f32_16x16x32_bf16 v[116:119], a[168:171], a[40:43], v[116:119]
    ds_read_b64_tr_b16 a[140:141], v21 offset:26784
    v_mfma_f32_16x16x32_bf16 v[116:119], a[172:175], a[44:47], v[116:119]
    s_add_u32 m0, s95, 33792
    ds_read_b64_tr_b16 a[142:143], v21 offset:27808
    v_mfma_f32_16x16x32_bf16 v[120:123], a[168:171], a[48:51], v[120:123]
    buffer_load_dwordx4 v17, s[16:19], s54 offen offset:64 lds
    v_mfma_f32_16x16x32_bf16 v[120:123], a[172:175], a[52:55], v[120:123]
    ds_read_b64_tr_b16 a[144:145], v21 offset:24960
    v_mfma_f32_16x16x32_bf16 v[124:127], a[168:171], a[56:59], v[124:127]
    ds_read_b64_tr_b16 a[146:147], v21 offset:25984
    v_mfma_f32_16x16x32_bf16 v[124:127], a[172:175], a[60:63], v[124:127]
    s_waitcnt lgkmcnt(5)
    s_add_u32 m0, s94, 36928
    ds_read_b64_tr_b16 a[148:149], v21 offset:27008
    v_mfma_f32_16x16x32_bf16 v[128:131], a[128:131], a[0:3], v[128:131]
    buffer_load_dwordx4 v16, s[16:19], s55 offen offset:0 lds
    v_mfma_f32_16x16x32_bf16 v[128:131], a[132:135], a[4:7], v[128:131]
    ds_read_b64_tr_b16 a[150:151], v21 offset:28032
    v_mfma_f32_16x16x32_bf16 v[132:135], a[128:131], a[8:11], v[132:135]
    ds_read_b64_tr_b16 a[152:153], v21 offset:29824
    v_mfma_f32_16x16x32_bf16 v[132:135], a[132:135], a[12:15], v[132:135]
    s_add_u32 m0, s94, 37888
    ds_read_b64_tr_b16 a[154:155], v21 offset:30080
    v_mfma_f32_16x16x32_bf16 v[136:139], a[128:131], a[16:19], v[136:139]
    buffer_load_dwordx4 v16, s[16:19], s55 offen offset:64 lds
    v_mfma_f32_16x16x32_bf16 v[136:139], a[132:135], a[20:23], v[136:139]
    ds_read_b64_tr_b16 a[156:157], v21 offset:30336
    v_mfma_f32_16x16x32_bf16 v[140:143], a[128:131], a[24:27], v[140:143]
    ds_read_b64_tr_b16 a[158:159], v21 offset:30592
    v_mfma_f32_16x16x32_bf16 v[140:143], a[132:135], a[28:31], v[140:143]
    s_waitcnt lgkmcnt(5)
    s_add_u32 m0, s95, 36928
    ds_read_b64_tr_b16 a[160:161], v21 offset:24992
    v_mfma_f32_16x16x32_bf16 v[144:147], a[136:139], a[0:3], v[144:147]
    buffer_load_dwordx4 v17, s[16:19], s55 offen offset:0 lds
    v_mfma_f32_16x16x32_bf16 v[144:147], a[140:143], a[4:7], v[144:147]
    ds_read_b64_tr_b16 a[162:163], v21 offset:26016
    v_mfma_f32_16x16x32_bf16 v[148:151], a[136:139], a[8:11], v[148:151]
    ds_read_b64_tr_b16 a[164:165], v21 offset:27040
    v_mfma_f32_16x16x32_bf16 v[148:151], a[140:143], a[12:15], v[148:151]
    s_add_u32 m0, s95, 37888
    ds_read_b64_tr_b16 a[166:167], v21 offset:28064
    v_mfma_f32_16x16x32_bf16 v[152:155], a[136:139], a[16:19], v[152:155]
    buffer_load_dwordx4 v17, s[16:19], s55 offen offset:64 lds
    v_mfma_f32_16x16x32_bf16 v[152:155], a[140:143], a[20:23], v[152:155]
    ds_read_b64_tr_b16 a[64:65], v22 offset:24704
    v_mfma_f32_16x16x32_bf16 v[156:159], a[136:139], a[24:27], v[156:159]
    ds_read_b64_tr_b16 a[66:67], v22 offset:25728
    v_mfma_f32_16x16x32_bf16 v[156:159], a[140:143], a[28:31], v[156:159]
    s_xor_b32 s58, s44, 6
    s_lshl_b32 s56, s58, 19
    s_mul_i32 s58, s58, 176128
    s_add_u32 m0, s47, 0
    v_mfma_f32_16x16x32_bf16 v[160:163], a[144:147], a[0:3], v[160:163]
    s_waitcnt lgkmcnt(4)
    buffer_load_dwordx4 v19, s[20:23], s56 offen offset:0 lds
    v_mfma_f32_16x16x32_bf16 v[160:163], a[148:151], a[4:7], v[160:163]
    ds_read_b64_tr_b16 a[68:69], v22 offset:26752
    v_mfma_f32_16x16x32_bf16 v[164:167], a[144:147], a[8:11], v[164:167]
    ds_read_b64_tr_b16 a[70:71], v22 offset:27776
    v_mfma_f32_16x16x32_bf16 v[164:167], a[148:151], a[12:15], v[164:167]
    s_add_u32 s57, s56, 31744
    ds_read_b64_tr_b16 a[168:169], v21 offset:25216
    v_mfma_f32_16x16x32_bf16 v[168:171], a[144:147], a[16:19], v[168:171]
    buffer_load_dwordx4 v19, s[20:23], s57 offen offset:1024 lds
    v_mfma_f32_16x16x32_bf16 v[168:171], a[148:151], a[20:23], v[168:171]
    ds_read_b64_tr_b16 a[170:171], v21 offset:26240
    v_mfma_f32_16x16x32_bf16 v[172:175], a[144:147], a[24:27], v[172:175]
    ds_read_b64_tr_b16 a[172:173], v21 offset:27264
    v_mfma_f32_16x16x32_bf16 v[172:175], a[148:151], a[28:31], v[172:175]
    s_add_u32 s57, s56, 260096
    ds_read_b64_tr_b16 a[174:175], v21 offset:28288
    v_mfma_f32_16x16x32_bf16 v[64:67], a[152:155], a[0:3], v[64:67]
    buffer_load_dwordx4 v19, s[20:23], s57 offen offset:2048 lds
    v_mfma_f32_16x16x32_bf16 v[64:67], a[156:159], a[4:7], v[64:67]
    ds_read_b64_tr_b16 a[72:73], v22 offset:24736
    v_mfma_f32_16x16x32_bf16 v[68:71], a[152:155], a[8:11], v[68:71]
    ds_read_b64_tr_b16 a[74:75], v22 offset:25760
    v_mfma_f32_16x16x32_bf16 v[68:71], a[156:159], a[12:15], v[68:71]
    s_add_u32 s57, s56, 291840
    ds_read_b64_tr_b16 a[76:77], v22 offset:26784
    v_mfma_f32_16x16x32_bf16 v[176:179], a[160:163], a[0:3], v[176:179]
    s_waitcnt lgkmcnt(5)
    buffer_load_dwordx4 v19, s[20:23], s57 offen offset:3072 lds
    v_mfma_f32_16x16x32_bf16 v[176:179], a[164:167], a[4:7], v[176:179]
    ds_read_b64_tr_b16 a[78:79], v22 offset:27808
    v_mfma_f32_16x16x32_bf16 v[180:183], a[160:163], a[8:11], v[180:183]
    ds_read_b64_tr_b16 a[128:129], v21 offset:25248
    v_mfma_f32_16x16x32_bf16 v[180:183], a[164:167], a[12:15], v[180:183]
    s_add_u32 m0, s47, 4096
    ds_read_b64_tr_b16 a[130:131], v21 offset:26272
    v_mfma_f32_16x16x32_bf16 v[184:187], a[160:163], a[16:19], v[184:187]
    buffer_load_dwordx4 v20, s[24:27], s58 offen lds
    v_mfma_f32_16x16x32_bf16 v[184:187], a[164:167], a[20:23], v[184:187]
    ds_read_b64_tr_b16 a[132:133], v21 offset:27296
    v_mfma_f32_16x16x32_bf16 v[188:191], a[160:163], a[24:27], v[188:191]
    ds_read_b64_tr_b16 a[134:135], v21 offset:28320
    v_mfma_f32_16x16x32_bf16 v[188:191], a[164:167], a[28:31], v[188:191]
    ds_read_b64_tr_b16 a[80:81], v23 offset:28800
    v_smfmac_f32_16x16x64_bf16 a[88:91], v[8:11], a[64:71], v5
    s_add_u32 m0, s47, 5120
    ds_read_b64_tr_b16 a[82:83], v23 offset:29056
    v_mfma_f32_16x16x32_bf16 v[192:195], a[168:171], a[0:3], v[192:195]
    s_waitcnt lgkmcnt(5)
    buffer_load_dwordx4 v20, s[28:31], s58 offen lds
    v_mfma_f32_16x16x32_bf16 v[192:195], a[172:175], a[4:7], v[192:195]
    ds_read_b64_tr_b16 a[84:85], v23 offset:29312
    v_mfma_f32_16x16x32_bf16 v[196:199], a[168:171], a[8:11], v[196:199]
    ds_read_b64_tr_b16 a[86:87], v23 offset:29568
    v_mfma_f32_16x16x32_bf16 v[196:199], a[172:175], a[12:15], v[196:199]
    ds_read_b64_tr_b16 a[136:137], v21 offset:29856
    v_mfma_f32_16x16x32_bf16 v[200:203], a[168:171], a[16:19], v[200:203]
    ds_read_b64_tr_b16 a[138:139], v21 offset:30112
    v_mfma_f32_16x16x32_bf16 v[200:203], a[172:175], a[20:23], v[200:203]
    s_xor_b32 s54, s44, 6
    s_lshl_b32 s54, s54, 7
    s_lshl_b32 s55, s39, 15
    s_add_u32 s54, s54, s55
    s_xor_b32 s55, s54, 0x8000
    s_add_u32 m0, s94, 0
    v_mfma_f32_16x16x32_bf16 v[204:207], a[168:171], a[24:27], v[204:207]
    buffer_load_dwordx4 v16, s[16:19], s54 offen offset:0 lds
    v_mfma_f32_16x16x32_bf16 v[204:207], a[172:175], a[28:31], v[204:207]
    ds_read_b64_tr_b16 a[140:141], v21 offset:30368
    v_smfmac_f32_16x16x64_bf16 a[92:95], v[8:11], a[72:79], v5
    s_waitcnt lgkmcnt(4)
    ds_read_b64_tr_b16 a[142:143], v21 offset:30624
    v_mfma_f32_16x16x32_bf16 v[208:211], a[128:131], a[0:3], v[208:211]
    s_add_u32 m0, s94, 960
    ds_read_b64_tr_b16 a[144:145], v21 offset:25472
    v_mfma_f32_16x16x32_bf16 v[208:211], a[132:135], a[4:7], v[208:211]
    buffer_load_dwordx4 v16, s[16:19], s54 offen offset:64 lds
    v_mfma_f32_16x16x32_bf16 v[212:215], a[128:131], a[8:11], v[212:215]
    ds_read_b64_tr_b16 a[146:147], v21 offset:26496
    v_mfma_f32_16x16x32_bf16 v[212:215], a[132:135], a[12:15], v[212:215]
    ds_read_b64_tr_b16 a[148:149], v21 offset:27520
    v_mfma_f32_16x16x32_bf16 v[216:219], a[128:131], a[16:19], v[216:219]
    ds_read_b64_tr_b16 a[150:151], v21 offset:28544
    v_mfma_f32_16x16x32_bf16 v[216:219], a[132:135], a[20:23], v[216:219]
    ds_read_b64_tr_b16 a[152:153], v21 offset:25504
    v_mfma_f32_16x16x32_bf16 v[220:223], a[128:131], a[24:27], v[220:223]
    ds_read_b64_tr_b16 a[154:155], v21 offset:26528
    v_mfma_f32_16x16x32_bf16 v[220:223], a[132:135], a[28:31], v[220:223]
    s_waitcnt lgkmcnt(5)
    ds_read_b64_tr_b16 a[156:157], v21 offset:27552
    v_smfmac_f32_16x16x64_bf16 a[96:99], v[8:11], a[80:87], v5
    ds_read_b64_tr_b16 a[158:159], v21 offset:28576
    v_mfma_f32_16x16x32_bf16 v[72:75], a[136:139], a[0:3], v[72:75]
    s_waitcnt vmcnt(8)
    ds_read_b64_tr_b16 a[160:161], v21 offset:28800
    v_mfma_f32_16x16x32_bf16 v[72:75], a[140:143], a[4:7], v[72:75]
    ds_read_b64_tr_b16 a[162:163], v21 offset:29056
    v_mfma_f32_16x16x32_bf16 v[76:79], a[136:139], a[8:11], v[76:79]
    ds_read_b64_tr_b16 a[164:165], v21 offset:29312
    v_mfma_f32_16x16x32_bf16 v[76:79], a[140:143], a[12:15], v[76:79]
    s_waitcnt lgkmcnt(6)
    ds_read_b64_tr_b16 a[166:167], v21 offset:29568
    v_mfma_f32_16x16x32_bf16 v[224:227], a[144:147], a[0:3], v[224:227]
    ds_read_b64_tr_b16 a[168:169], v21 offset:28832
    v_mfma_f32_16x16x32_bf16 v[224:227], a[148:151], a[4:7], v[224:227]
    ds_read_b64_tr_b16 a[170:171], v21 offset:29088
    v_mfma_f32_16x16x32_bf16 v[228:231], a[144:147], a[8:11], v[228:231]
    ds_read_b64_tr_b16 a[172:173], v21 offset:29344
    v_mfma_f32_16x16x32_bf16 v[228:231], a[148:151], a[12:15], v[228:231]
    ds_read_b64_tr_b16 a[174:175], v21 offset:29600
    v_mfma_f32_16x16x32_bf16 v[232:235], a[144:147], a[16:19], v[232:235]
    ds_read_b128 a[32:35], v18 offset:32832
    v_mfma_f32_16x16x32_bf16 v[232:235], a[148:151], a[20:23], v[232:235]
    ds_read_b128 a[36:39], v18 offset:33856
    v_mfma_f32_16x16x32_bf16 v[236:239], a[144:147], a[24:27], v[236:239]
    ds_read_b128 a[40:43], v18 offset:34880
    v_mfma_f32_16x16x32_bf16 v[236:239], a[148:151], a[28:31], v[236:239]
    s_waitcnt lgkmcnt(6)
    ds_read_b128 a[44:47], v18 offset:35904
    v_mfma_f32_16x16x32_bf16 v[240:243], a[152:155], a[0:3], v[240:243]
    ds_read_b128 a[48:51], v18 offset:36928
    v_mfma_f32_16x16x32_bf16 v[240:243], a[156:159], a[4:7], v[240:243]
    ds_read_b128 a[52:55], v18 offset:37952
    v_mfma_f32_16x16x32_bf16 v[244:247], a[152:155], a[8:11], v[244:247]
    ds_read_b128 a[56:59], v18 offset:38976
    v_mfma_f32_16x16x32_bf16 v[244:247], a[156:159], a[12:15], v[244:247]
    ds_read_b128 a[60:63], v18 offset:40000
    v_mfma_f32_16x16x32_bf16 v[248:251], a[152:155], a[16:19], v[248:251]
    v_mfma_f32_16x16x32_bf16 v[248:251], a[156:159], a[20:23], v[248:251]
    v_mfma_f32_16x16x32_bf16 v[252:255], a[152:155], a[24:27], v[252:255]
    v_mfma_f32_16x16x32_bf16 v[252:255], a[156:159], a[28:31], v[252:255]
    v_mfma_f32_16x16x32_bf16 v[96:99], a[160:163], a[0:3], v[96:99]
    v_mfma_f32_16x16x32_bf16 v[96:99], a[164:167], a[4:7], v[96:99]
    v_mfma_f32_16x16x32_bf16 v[100:103], a[160:163], a[8:11], v[100:103]
    s_waitcnt lgkmcnt(0)
    s_barrier
    v_mfma_f32_16x16x32_bf16 v[100:103], a[164:167], a[12:15], v[100:103]
    ds_read_b64_tr_b16 a[128:129], v21 offset:49408
    v_mfma_f32_16x16x32_bf16 v[104:107], a[160:163], a[16:19], v[104:107]
    ds_read_b64_tr_b16 a[130:131], v21 offset:50432
    v_mfma_f32_16x16x32_bf16 v[104:107], a[164:167], a[20:23], v[104:107]
    ds_read_b64_tr_b16 a[132:133], v21 offset:51456
    v_mfma_f32_16x16x32_bf16 v[108:111], a[160:163], a[24:27], v[108:111]
    ds_read_b64_tr_b16 a[134:135], v21 offset:52480
    v_mfma_f32_16x16x32_bf16 v[108:111], a[164:167], a[28:31], v[108:111]
    s_add_u32 m0, s95, 0
    ds_read_b64_tr_b16 a[136:137], v21 offset:49440
    v_mfma_f32_16x16x32_bf16 v[112:115], a[168:171], a[0:3], v[112:115]
    buffer_load_dwordx4 v17, s[16:19], s54 offen offset:0 lds
    v_mfma_f32_16x16x32_bf16 v[112:115], a[172:175], a[4:7], v[112:115]
    ds_read_b64_tr_b16 a[138:139], v21 offset:50464
    v_mfma_f32_16x16x32_bf16 v[116:119], a[168:171], a[8:11], v[116:119]
    ds_read_b64_tr_b16 a[140:141], v21 offset:51488
    v_mfma_f32_16x16x32_bf16 v[116:119], a[172:175], a[12:15], v[116:119]
    s_add_u32 m0, s95, 960
    ds_read_b64_tr_b16 a[142:143], v21 offset:52512
    v_mfma_f32_16x16x32_bf16 v[120:123], a[168:171], a[16:19], v[120:123]
    buffer_load_dwordx4 v17, s[16:19], s54 offen offset:64 lds
    v_mfma_f32_16x16x32_bf16 v[120:123], a[172:175], a[20:23], v[120:123]
    ds_read_b64_tr_b16 a[144:145], v21 offset:49664
    v_mfma_f32_16x16x32_bf16 v[124:127], a[168:171], a[24:27], v[124:127]
    ds_read_b64_tr_b16 a[146:147], v21 offset:50688
    v_mfma_f32_16x16x32_bf16 v[124:127], a[172:175], a[28:31], v[124:127]
    s_waitcnt lgkmcnt(5)
    s_add_u32 m0, s94, 4096
    ds_read_b64_tr_b16 a[148:149], v21 offset:51712
    v_mfma_f32_16x16x32_bf16 v[128:131], a[128:131], a[32:35], v[128:131]
    buffer_load_dwordx4 v16, s[16:19], s55 offen offset:0 lds
    v_mfma_f32_16x16x32_bf16 v[128:131], a[132:135], a[36:39], v[128:131]
L_hop1:
    s_cbranch_execz L_hop5
    ds_read_b64_tr_b16 a[150:151], v21 offset:52736
    v_mfma_f32_16x16x32_bf16 v[132:135], a[128:131], a[40:43], v[132:135]
    ds_read_b64_tr_b16 a[152:153], v21 offset:54528
    v_mfma_f32_16x16x32_bf16 v[132:135], a[132:135], a[44:47], v[132:135]
    s_add_u32 m0, s94, 5056
    ds_read_b64_tr_b16 a[154:155], v21 offset:54784
    v_mfma_f32_16x16x32_bf16 v[136:139], a[128:131], a[48:51], v[136:139]
    buffer_load_dwordx4 v16, s[16:19], s55 offen offset:64 lds
    v_mfma_f32_16x16x32_bf16 v[136:139], a[132:135], a[52:55], v[136:139]
    ds_read_b64_tr_b16 a[156:157], v21 offset:55040
    v_mfma_f32_16x16x32_bf16 v[140:143], a[128:131], a[56:59], v[140:143]
    ds_read_b64_tr_b16 a[158:159], v21 offset:55296
    v_mfma_f32_16x16x32_bf16 v[140:143], a[132:135], a[60:63], v[140:143]
    s_waitcnt lgkmcnt(5)
    s_add_u32 m0, s95, 4096
    ds_read_b64_tr_b16 a[160:161], v21 offset:49696
    v_mfma_f32_16x16x32_bf16 v[144:147], a[136:139], a[32:35], v[144:147]
    buffer_load_dwordx4 v17, s[16:19], s55 offen offset:0 lds
    v_mfma_f32_16x16x32_bf16 v[144:147], a[140:143], a[36:39], v[144:147]
    ds_read_b64_tr_b16 a[162:163], v21 offset:50720
    v_mfma_f32_16x16x32_bf16 v[148:151], a[136:139], a[40:43], v[148:151]
    ds_read_b64_tr_b16 a[164:165], v21 offset:51744
    v_mfma_f32_16x16x32_bf16 v[148:151], a[140:143], a[44:47], v[148:151]
    s_add_u32 m0, s95, 5056
    ds_read_b64_tr_b16 a[166:167], v21 offset:52768
    v_mfma_f32_16x16x32_bf16 v[152:155], a[136:139], a[48:51], v[152:155]
    buffer_load_dwordx4 v17, s[16:19], s55 offen offset:64 lds
    v_mfma_f32_16x16x32_bf16 v[152:155], a[140:143], a[52:55], v[152:155]
    ds_read_b64_tr_b16 a[64:65], v22 offset:49408
    v_mfma_f32_16x16x32_bf16 v[156:159], a[136:139], a[56:59], v[156:159]
    ds_read_b64_tr_b16 a[66:67], v22 offset:50432
    v_mfma_f32_16x16x32_bf16 v[156:159], a[140:143], a[60:63], v[156:159]
    s_xor_b32 s58, s44, 7
    s_lshl_b32 s56, s58, 19
    s_mul_i32 s58, s58, 176128
    s_add_u32 m0, s47, 24704
    v_mfma_f32_16x16x32_bf16 v[160:163], a[144:147], a[32:35], v[160:163]
    s_waitcnt lgkmcnt(4)
    buffer_load_dwordx4 v19, s[20:23], s56 offen offset:0 lds
    v_mfma_f32_16x16x32_bf16 v[160:163], a[148:151], a[36:39], v[160:163]
    ds_read_b64_tr_b16 a[68:69], v22 offset:51456
    v_mfma_f32_16x16x32_bf16 v[164:167], a[144:147], a[40:43], v[164:167]
    ds_read_b64_tr_b16 a[70:71], v22 offset:52480
    v_mfma_f32_16x16x32_bf16 v[164:167], a[148:151], a[44:47], v[164:167]
    s_add_u32 s57, s56, 31744
    ds_read_b64_tr_b16 a[168:169], v21 offset:49920
    v_mfma_f32_16x16x32_bf16 v[168:171], a[144:147], a[48:51], v[168:171]
    buffer_load_dwordx4 v19, s[20:23], s57 offen offset:1024 lds
    v_mfma_f32_16x16x32_bf16 v[168:171], a[148:151], a[52:55], v[168:171]
    ds_read_b64_tr_b16 a[170:171], v21 offset:50944
    v_mfma_f32_16x16x32_bf16 v[172:175], a[144:147], a[56:59], v[172:175]
    ds_read_b64_tr_b16 a[172:173], v21 offset:51968
    v_mfma_f32_16x16x32_bf16 v[172:175], a[148:151], a[60:63], v[172:175]
    s_add_u32 s57, s56, 260096
    ds_read_b64_tr_b16 a[174:175], v21 offset:52992
    v_mfma_f32_16x16x32_bf16 v[64:67], a[152:155], a[32:35], v[64:67]
    buffer_load_dwordx4 v19, s[20:23], s57 offen offset:2048 lds
    v_mfma_f32_16x16x32_bf16 v[64:67], a[156:159], a[36:39], v[64:67]
    ds_read_b64_tr_b16 a[72:73], v22 offset:49440
    v_mfma_f32_16x16x32_bf16 v[68:71], a[152:155], a[40:43], v[68:71]
    ds_read_b64_tr_b16 a[74:75], v22 offset:50464
    v_mfma_f32_16x16x32_bf16 v[68:71], a[156:159], a[44:47], v[68:71]
    s_add_u32 s57, s56, 291840
    ds_read_b64_tr_b16 a[76:77], v22 offset:51488
    v_mfma_f32_16x16x32_bf16 v[176:179], a[160:163], a[32:35], v[176:179]
    s_waitcnt lgkmcnt(5)
    buffer_load_dwordx4 v19, s[20:23], s57 offen offset:3072 lds
    v_mfma_f32_16x16x32_bf16 v[176:179], a[164:167], a[36:39], v[176:179]
    ds_read_b64_tr_b16 a[78:79], v22 offset:52512
    v_mfma_f32_16x16x32_bf16 v[180:183], a[160:163], a[40:43], v[180:183]
    ds_read_b64_tr_b16 a[128:129], v21 offset:49952
    v_mfma_f32_16x16x32_bf16 v[180:183], a[164:167], a[44:47], v[180:183]
    s_add_u32 m0, s47, 28800
    ds_read_b64_tr_b16 a[130:131], v21 offset:50976
    v_mfma_f32_16x16x32_bf16 v[184:187], a[160:163], a[48:51], v[184:187]
    buffer_load_dwordx4 v20, s[24:27], s58 offen lds
    v_mfma_f32_16x16x32_bf16 v[184:187], a[164:167], a[52:55], v[184:187]
    ds_read_b64_tr_b16 a[132:133], v21 offset:52000
    v_mfma_f32_16x16x32_bf16 v[188:191], a[160:163], a[56:59], v[188:191]
    ds_read_b64_tr_b16 a[134:135], v21 offset:53024
    v_mfma_f32_16x16x32_bf16 v[188:191], a[164:167], a[60:63], v[188:191]
    ds_read_b64_tr_b16 a[80:81], v23 offset:53504
    v_smfmac_f32_16x16x64_bf16 a[88:91], v[8:11], a[64:71], v5
    s_add_u32 m0, s47, 29824
    ds_read_b64_tr_b16 a[82:83], v23 offset:53760
    v_mfma_f32_16x16x32_bf16 v[192:195], a[168:171], a[32:35], v[192:195]
    s_waitcnt lgkmcnt(5)
    buffer_load_dwordx4 v20, s[28:31], s58 offen lds
    v_mfma_f32_16x16x32_bf16 v[192:195], a[172:175], a[36:39], v[192:195]
    ds_read_b64_tr_b16 a[84:85], v23 offset:54016
    v_mfma_f32_16x16x32_bf16 v[196:199], a[168:171], a[40:43], v[196:199]
    ds_read_b64_tr_b16 a[86:87], v23 offset:54272
    v_mfma_f32_16x16x32_bf16 v[196:199], a[172:175], a[44:47], v[196:199]
    ds_read_b64_tr_b16 a[136:137], v21 offset:54560
    v_mfma_f32_16x16x32_bf16 v[200:203], a[168:171], a[48:51], v[200:203]
    ds_read_b64_tr_b16 a[138:139], v21 offset:54816
    v_mfma_f32_16x16x32_bf16 v[200:203], a[172:175], a[52:55], v[200:203]
    s_xor_b32 s54, s44, 7
    s_lshl_b32 s54, s54, 7
    s_lshl_b32 s55, s39, 15
    s_add_u32 s54, s54, s55
    s_xor_b32 s55, s54, 0x8000
    s_add_u32 m0, s94, 32832
    v_mfma_f32_16x16x32_bf16 v[204:207], a[168:171], a[56:59], v[204:207]
    buffer_load_dwordx4 v16, s[16:19], s54 offen offset:0 lds
    v_mfma_f32_16x16x32_bf16 v[204:207], a[172:175], a[60:63], v[204:207]
    ds_read_b64_tr_b16 a[140:141], v21 offset:55072
    v_smfmac_f32_16x16x64_bf16 a[92:95], v[8:11], a[72:79], v5
    s_waitcnt lgkmcnt(4)
    ds_read_b64_tr_b16 a[142:143], v21 offset:55328
    v_mfma_f32_16x16x32_bf16 v[208:211], a[128:131], a[32:35], v[208:211]
    s_add_u32 m0, s94, 33792
    ds_read_b64_tr_b16 a[144:145], v21 offset:50176
    v_mfma_f32_16x16x32_bf16 v[208:211], a[132:135], a[36:39], v[208:211]
    buffer_load_dwordx4 v16, s[16:19], s54 offen offset:64 lds
    v_mfma_f32_16x16x32_bf16 v[212:215], a[128:131], a[40:43], v[212:215]
    ds_read_b64_tr_b16 a[146:147], v21 offset:51200
    v_mfma_f32_16x16x32_bf16 v[212:215], a[132:135], a[44:47], v[212:215]
    ds_read_b64_tr_b16 a[148:149], v21 offset:52224
    v_mfma_f32_16x16x32_bf16 v[216:219], a[128:131], a[48:51], v[216:219]
    ds_read_b64_tr_b16 a[150:151], v21 offset:53248
    v_mfma_f32_16x16x32_bf16 v[216:219], a[132:135], a[52:55], v[216:219]
    ds_read_b64_tr_b16 a[152:153], v21 offset:50208
    v_mfma_f32_16x16x32_bf16 v[220:223], a[128:131], a[56:59], v[220:223]
    ds_read_b64_tr_b16 a[154:155], v21 offset:51232
    v_mfma_f32_16x16x32_bf16 v[220:223], a[132:135], a[60:63], v[220:223]
    s_waitcnt lgkmcnt(5)
    ds_read_b64_tr_b16 a[156:157], v21 offset:52256
    v_smfmac_f32_16x16x64_bf16 a[96:99], v[8:11], a[80:87], v5
    ds_read_b64_tr_b16 a[158:159], v21 offset:53280
    v_mfma_f32_16x16x32_bf16 v[72:75], a[136:139], a[32:35], v[72:75]
    s_waitcnt vmcnt(8)
    ds_read_b64_tr_b16 a[160:161], v21 offset:53504
    v_mfma_f32_16x16x32_bf16 v[72:75], a[140:143], a[36:39], v[72:75]
    ds_read_b64_tr_b16 a[162:163], v21 offset:53760
    v_mfma_f32_16x16x32_bf16 v[76:79], a[136:139], a[40:43], v[76:79]
    ds_read_b64_tr_b16 a[164:165], v21 offset:54016
    v_mfma_f32_16x16x32_bf16 v[76:79], a[140:143], a[44:47], v[76:79]
    s_waitcnt lgkmcnt(6)
    ds_read_b64_tr_b16 a[166:167], v21 offset:54272
    v_mfma_f32_16x16x32_bf16 v[224:227], a[144:147], a[32:35], v[224:227]
    ds_read_b64_tr_b16 a[168:169], v21 offset:53536
    v_mfma_f32_16x16x32_bf16 v[224:227], a[148:151], a[36:39], v[224:227]
    ds_read_b64_tr_b16 a[170:171], v21 offset:53792
    v_mfma_f32_16x16x32_bf16 v[228:231], a[144:147], a[40:43], v[228:231]
    ds_read_b64_tr_b16 a[172:173], v21 offset:54048
    v_mfma_f32_16x16x32_bf16 v[228:231], a[148:151], a[44:47], v[228:231]
    ds_read_b64_tr_b16 a[174:175], v21 offset:54304
    v_mfma_f32_16x16x32_bf16 v[232:235], a[144:147], a[48:51], v[232:235]
    ds_read_b128 a[0:3], v18 offset:0
    v_mfma_f32_16x16x32_bf16 v[232:235], a[148:151], a[52:55], v[232:235]
    ds_read_b128 a[4:7], v18 offset:1024
    v_mfma_f32_16x16x32_bf16 v[236:239], a[144:147], a[56:59], v[236:239]
    ds_read_b128 a[8:11], v18 offset:2048
    v_mfma_f32_16x16x32_bf16 v[236:239], a[148:151], a[60:63], v[236:239]
    s_waitcnt lgkmcnt(6)
    ds_read_b128 a[12:15], v18 offset:3072
    v_mfma_f32_16x16x32_bf16 v[240:243], a[152:155], a[32:35], v[240:243]
    ds_read_b128 a[16:19], v18 offset:4096
    v_mfma_f32_16x16x32_bf16 v[240:243], a[156:159], a[36:39], v[240:243]
    ds_read_b128 a[20:23], v18 offset:5120
    v_mfma_f32_16x16x32_bf16 v[244:247], a[152:155], a[40:43], v[244:247]
    ds_read_b128 a[24:27], v18 offset:6144
    v_mfma_f32_16x16x32_bf16 v[244:247], a[156:159], a[44:47], v[244:247]
    ds_read_b128 a[28:31], v18 offset:7168
    v_mfma_f32_16x16x32_bf16 v[248:251], a[152:155], a[48:51], v[248:251]
    v_mfma_f32_16x16x32_bf16 v[248:251], a[156:159], a[52:55], v[248:251]
    v_mfma_f32_16x16x32_bf16 v[252:255], a[152:155], a[56:59], v[252:255]
    v_mfma_f32_16x16x32_bf16 v[252:255], a[156:159], a[60:63], v[252:255]
    v_mfma_f32_16x16x32_bf16 v[96:99], a[160:163], a[32:35], v[96:99]
    v_mfma_f32_16x16x32_bf16 v[96:99], a[164:167], a[36:39], v[96:99]
    v_mfma_f32_16x16x32_bf16 v[100:103], a[160:163], a[40:43], v[100:103]
    s_waitcnt lgkmcnt(0)
    s_barrier
    v_mfma_f32_16x16x32_bf16 v[100:103], a[164:167], a[44:47], v[100:103]
    ds_read_b64_tr_b16 a[128:129], v21 offset:0
    v_mfma_f32_16x16x32_bf16 v[104:107], a[160:163], a[48:51], v[104:107]
    ds_read_b64_tr_b16 a[130:131], v21 offset:1024
    v_mfma_f32_16x16x32_bf16 v[104:107], a[164:167], a[52:55], v[104:107]
    ds_read_b64_tr_b16 a[132:133], v21 offset:2048
    v_mfma_f32_16x16x32_bf16 v[108:111], a[160:163], a[56:59], v[108:111]
    ds_read_b64_tr_b16 a[134:135], v21 offset:3072
    v_mfma_f32_16x16x32_bf16 v[108:111], a[164:167], a[60:63], v[108:111]
    s_add_u32 m0, s95, 32832
    ds_read_b64_tr_b16 a[136:137], v21 offset:32
    v_mfma_f32_16x16x32_bf16 v[112:115], a[168:171], a[32:35], v[112:115]
    buffer_load_dwordx4 v17, s[16:19], s54 offen offset:0 lds
    v_mfma_f32_16x16x32_bf16 v[112:115], a[172:175], a[36:39], v[112:115]
    ds_read_b64_tr_b16 a[138:139], v21 offset:1056
    v_mfma_f32_16x16x32_bf16 v[116:119], a[168:171], a[40:43], v[116:119]
    ds_read_b64_tr_b16 a[140:141], v21 offset:2080
    v_mfma_f32_16x16x32_bf16 v[116:119], a[172:175], a[44:47], v[116:119]
    s_add_u32 m0, s95, 33792
    ds_read_b64_tr_b16 a[142:143], v21 offset:3104
    v_mfma_f32_16x16x32_bf16 v[120:123], a[168:171], a[48:51], v[120:123]
    buffer_load_dwordx4 v17, s[16:19], s54 offen offset:64 lds
    v_mfma_f32_16x16x32_bf16 v[120:123], a[172:175], a[52:55], v[120:123]
    ds_read_b64_tr_b16 a[144:145], v21 offset:256
    v_mfma_f32_16x16x32_bf16 v[124:127], a[168:171], a[56:59], v[124:127]
    ds_read_b64_tr_b16 a[146:147], v21 offset:1280
    v_mfma_f32_16x16x32_bf16 v[124:127], a[172:175], a[60:63], v[124:127]
    s_waitcnt lgkmcnt(5)
    s_add_u32 m0, s94, 36928
    ds_read_b64_tr_b16 a[148:149], v21 offset:2304
    v_mfma_f32_16x16x32_bf16 v[128:131], a[128:131], a[0:3], v[128:131]
    buffer_load_dwordx4 v16, s[16:19], s55 offen offset:0 lds
    v_mfma_f32_16x16x32_bf16 v[128:131], a[132:135], a[4:7], v[128:131]
    ds_read_b64_tr_b16 a[150:151], v21 offset:3328
    v_mfma_f32_16x16x32_bf16 v[132:135], a[128:131], a[8:11], v[132:135]
    ds_read_b64_tr_b16 a[152:153], v21 offset:5120
    v_mfma_f32_16x16x32_bf16 v[132:135], a[132:135], a[12:15], v[132:135]
    s_add_u32 m0, s94, 37888
    ds_read_b64_tr_b16 a[154:155], v21 offset:5376
    v_mfma_f32_16x16x32_bf16 v[136:139], a[128:131], a[16:19], v[136:139]
    buffer_load_dwordx4 v16, s[16:19], s55 offen offset:64 lds
    v_mfma_f32_16x16x32_bf16 v[136:139], a[132:135], a[20:23], v[136:139]
    ds_read_b64_tr_b16 a[156:157], v21 offset:5632
    v_mfma_f32_16x16x32_bf16 v[140:143], a[128:131], a[24:27], v[140:143]
    ds_read_b64_tr_b16 a[158:159], v21 offset:5888
    v_mfma_f32_16x16x32_bf16 v[140:143], a[132:135], a[28:31], v[140:143]
    s_waitcnt lgkmcnt(5)
    s_add_u32 m0, s95, 36928
    ds_read_b64_tr_b16 a[160:161], v21 offset:288
    v_mfma_f32_16x16x32_bf16 v[144:147], a[136:139], a[0:3], v[144:147]
    buffer_load_dwordx4 v17, s[16:19], s55 offen offset:0 lds
    v_mfma_f32_16x16x32_bf16 v[144:147], a[140:143], a[4:7], v[144:147]
    ds_read_b64_tr_b16 a[162:163], v21 offset:1312
    v_mfma_f32_16x16x32_bf16 v[148:151], a[136:139], a[8:11], v[148:151]
    ds_read_b64_tr_b16 a[164:165], v21 offset:2336
    v_mfma_f32_16x16x32_bf16 v[148:151], a[140:143], a[12:15], v[148:151]
    s_add_u32 m0, s95, 37888
    ds_read_b64_tr_b16 a[166:167], v21 offset:3360
    v_mfma_f32_16x16x32_bf16 v[152:155], a[136:139], a[16:19], v[152:155]
    buffer_load_dwordx4 v17, s[16:19], s55 offen offset:64 lds
    v_mfma_f32_16x16x32_bf16 v[152:155], a[140:143], a[20:23], v[152:155]
    ds_read_b64_tr_b16 a[64:65], v22 offset:0
    v_mfma_f32_16x16x32_bf16 v[156:159], a[136:139], a[24:27], v[156:159]
    ds_read_b64_tr_b16 a[66:67], v22 offset:1024
    v_mfma_f32_16x16x32_bf16 v[156:159], a[140:143], a[28:31], v[156:159]
    s_lshl_b32 s59, s38, 5
    ds_read_b64_tr_b16 a[68:69], v22 offset:2048
    v_mfma_f32_16x16x32_bf16 v[160:163], a[144:147], a[0:3], v[160:163]
    s_waitcnt lgkmcnt(5)
    buffer_load_dword v1, off, s[32:35], s59 offset:4 sc1
    v_mfma_f32_16x16x32_bf16 v[160:163], a[148:151], a[4:7], v[160:163]
    ds_read_b64_tr_b16 a[70:71], v22 offset:3072
    v_mfma_f32_16x16x32_bf16 v[164:167], a[144:147], a[8:11], v[164:167]
    s_mov_b32 s58, 0
    ds_read_b64_tr_b16 a[168:169], v21 offset:512
    v_mfma_f32_16x16x32_bf16 v[164:167], a[148:151], a[12:15], v[164:167]
    s_add_u32 m0, s40, 0
    ds_read_b64_tr_b16 a[170:171], v21 offset:1536
    v_mfma_f32_16x16x32_bf16 v[168:171], a[144:147], a[16:19], v[168:171]
    buffer_load_dwordx4 v4, s[4:7], s58 offen offset:0 lds
    v_mfma_f32_16x16x32_bf16 v[168:171], a[148:151], a[20:23], v[168:171]
    ds_read_b64_tr_b16 a[172:173], v21 offset:2560
    v_mfma_f32_16x16x32_bf16 v[172:175], a[144:147], a[24:27], v[172:175]
    ds_read_b64_tr_b16 a[174:175], v21 offset:3584
    v_mfma_f32_16x16x32_bf16 v[172:175], a[148:151], a[28:31], v[172:175]
    ds_read_b64_tr_b16 a[72:73], v22 offset:32
    v_mfma_f32_16x16x32_bf16 v[64:67], a[152:155], a[0:3], v[64:67]
    buffer_load_dwordx4 v4, s[4:7], s58 offen offset:1024 lds
    v_mfma_f32_16x16x32_bf16 v[64:67], a[156:159], a[4:7], v[64:67]
    ds_read_b64_tr_b16 a[74:75], v22 offset:1056
    v_mfma_f32_16x16x32_bf16 v[68:71], a[152:155], a[8:11], v[68:71]
    ds_read_b64_tr_b16 a[76:77], v22 offset:2080
    v_mfma_f32_16x16x32_bf16 v[68:71], a[156:159], a[12:15], v[68:71]
    ds_read_b64_tr_b16 a[78:79], v22 offset:3104
    v_mfma_f32_16x16x32_bf16 v[176:179], a[160:163], a[0:3], v[176:179]
    s_waitcnt lgkmcnt(5)
    buffer_load_dwordx4 v4, s[4:7], s58 offen offset:2048 lds
    v_mfma_f32_16x16x32_bf16 v[176:179], a[164:167], a[4:7], v[176:179]
    ds_read_b64_tr_b16 a[128:129], v21 offset:544
    v_mfma_f32_16x16x32_bf16 v[180:183], a[160:163], a[8:11], v[180:183]
    ds_read_b64_tr_b16 a[130:131], v21 offset:1568
    v_mfma_f32_16x16x32_bf16 v[180:183], a[164:167], a[12:15], v[180:183]
    ds_read_b64_tr_b16 a[132:133], v21 offset:2592
    v_mfma_f32_16x16x32_bf16 v[184:187], a[160:163], a[16:19], v[184:187]
    buffer_load_dwordx4 v4, s[4:7], s58 offen offset:3072 lds
    v_mfma_f32_16x16x32_bf16 v[184:187], a[164:167], a[20:23], v[184:187]
    ds_read_b64_tr_b16 a[134:135], v21 offset:3616
    v_mfma_f32_16x16x32_bf16 v[188:191], a[160:163], a[24:27], v[188:191]
    ds_read_b64_tr_b16 a[80:81], v23 offset:4096
    v_mfma_f32_16x16x32_bf16 v[188:191], a[164:167], a[28:31], v[188:191]
    s_mov_b32 s58, 16384
    ds_read_b64_tr_b16 a[82:83], v23 offset:4352
    v_smfmac_f32_16x16x64_bf16 a[88:91], v[8:11], a[64:71], v5
    s_add_u32 m0, s40, 16416
    ds_read_b64_tr_b16 a[84:85], v23 offset:4608
    v_mfma_f32_16x16x32_bf16 v[192:195], a[168:171], a[0:3], v[192:195]
    s_waitcnt lgkmcnt(5)
    buffer_load_dwordx4 v4, s[4:7], s58 offen offset:0 lds
    v_mfma_f32_16x16x32_bf16 v[192:195], a[172:175], a[4:7], v[192:195]
    ds_read_b64_tr_b16 a[86:87], v23 offset:4864
    v_mfma_f32_16x16x32_bf16 v[196:199], a[168:171], a[8:11], v[196:199]
    ds_read_b64_tr_b16 a[136:137], v21 offset:5152
    v_mfma_f32_16x16x32_bf16 v[196:199], a[172:175], a[12:15], v[196:199]
    ds_read_b64_tr_b16 a[138:139], v21 offset:5408
    v_mfma_f32_16x16x32_bf16 v[200:203], a[168:171], a[16:19], v[200:203]
    buffer_load_dwordx4 v4, s[4:7], s58 offen offset:1024 lds
    v_mfma_f32_16x16x32_bf16 v[200:203], a[172:175], a[20:23], v[200:203]
    ds_read_b64_tr_b16 a[140:141], v21 offset:5664
    v_mfma_f32_16x16x32_bf16 v[204:207], a[168:171], a[24:27], v[204:207]
    ds_read_b64_tr_b16 a[142:143], v21 offset:5920
    v_mfma_f32_16x16x32_bf16 v[204:207], a[172:175], a[28:31], v[204:207]
    ds_read_b64_tr_b16 a[144:145], v21 offset:768
    v_smfmac_f32_16x16x64_bf16 a[92:95], v[8:11], a[72:79], v5
    ds_read_b64_tr_b16 a[146:147], v21 offset:1792
    v_mfma_f32_16x16x32_bf16 v[208:211], a[128:131], a[0:3], v[208:211]
    s_waitcnt lgkmcnt(5)
    buffer_load_dwordx4 v4, s[4:7], s58 offen offset:2048 lds
    v_mfma_f32_16x16x32_bf16 v[208:211], a[132:135], a[4:7], v[208:211]
    ds_read_b64_tr_b16 a[148:149], v21 offset:2816
    v_mfma_f32_16x16x32_bf16 v[212:215], a[128:131], a[8:11], v[212:215]
    ds_read_b64_tr_b16 a[150:151], v21 offset:3840
    v_mfma_f32_16x16x32_bf16 v[212:215], a[132:135], a[12:15], v[212:215]
    ds_read_b64_tr_b16 a[152:153], v21 offset:800
    v_mfma_f32_16x16x32_bf16 v[216:219], a[128:131], a[16:19], v[216:219]
    buffer_load_dwordx4 v4, s[4:7], s58 offen offset:3072 lds
    v_mfma_f32_16x16x32_bf16 v[216:219], a[132:135], a[20:23], v[216:219]
    ds_read_b64_tr_b16 a[154:155], v21 offset:1824
    v_mfma_f32_16x16x32_bf16 v[220:223], a[128:131], a[24:27], v[220:223]
    ds_read_b64_tr_b16 a[156:157], v21 offset:2848
    v_mfma_f32_16x16x32_bf16 v[220:223], a[132:135], a[28:31], v[220:223]
    ds_read_b64_tr_b16 a[158:159], v21 offset:3872
    v_smfmac_f32_16x16x64_bf16 a[96:99], v[8:11], a[80:87], v5
    s_waitcnt lgkmcnt(5)
    ds_read_b64_tr_b16 a[160:161], v21 offset:4096
    v_mfma_f32_16x16x32_bf16 v[72:75], a[136:139], a[0:3], v[72:75]
    s_waitcnt vmcnt(9)
    ds_read_b64_tr_b16 a[162:163], v21 offset:4352
    v_mfma_f32_16x16x32_bf16 v[72:75], a[140:143], a[4:7], v[72:75]
    ds_read_b64_tr_b16 a[164:165], v21 offset:4608
    v_mfma_f32_16x16x32_bf16 v[76:79], a[136:139], a[8:11], v[76:79]
    ds_read_b64_tr_b16 a[166:167], v21 offset:4864
    v_mfma_f32_16x16x32_bf16 v[76:79], a[140:143], a[12:15], v[76:79]
    ds_read_b64_tr_b16 a[168:169], v21 offset:4128
    v_mfma_f32_16x16x32_bf16 v[224:227], a[144:147], a[0:3], v[224:227]
    s_waitcnt lgkmcnt(6)
    ds_read_b64_tr_b16 a[170:171], v21 offset:4384
    v_mfma_f32_16x16x32_bf16 v[224:227], a[148:151], a[4:7], v[224:227]
    ds_read_b64_tr_b16 a[172:173], v21 offset:4640
    v_mfma_f32_16x16x32_bf16 v[228:231], a[144:147], a[8:11], v[228:231]
    ds_read_b64_tr_b16 a[174:175], v21 offset:4896
    v_mfma_f32_16x16x32_bf16 v[228:231], a[148:151], a[12:15], v[228:231]
    ds_read_b128 a[32:35], v18 offset:32832
    v_mfma_f32_16x16x32_bf16 v[232:235], a[144:147], a[16:19], v[232:235]
    ds_read_b128 a[36:39], v18 offset:33856
    v_mfma_f32_16x16x32_bf16 v[232:235], a[148:151], a[20:23], v[232:235]
    ds_read_b128 a[40:43], v18 offset:34880
    v_mfma_f32_16x16x32_bf16 v[236:239], a[144:147], a[24:27], v[236:239]
    ds_read_b128 a[44:47], v18 offset:35904
    v_mfma_f32_16x16x32_bf16 v[236:239], a[148:151], a[28:31], v[236:239]
    ds_read_b128 a[48:51], v18 offset:36928
    v_mfma_f32_16x16x32_bf16 v[240:243], a[152:155], a[0:3], v[240:243]
    s_waitcnt lgkmcnt(6)
    ds_read_b128 a[52:55], v18 offset:37952
    v_mfma_f32_16x16x32_bf16 v[240:243], a[156:159], a[4:7], v[240:243]
    ds_read_b128 a[56:59], v18 offset:38976
    v_mfma_f32_16x16x32_bf16 v[244:247], a[152:155], a[8:11], v[244:247]
    ds_read_b128 a[60:63], v18 offset:40000
    v_mfma_f32_16x16x32_bf16 v[244:247], a[156:159], a[12:15], v[244:247]
    v_mfma_f32_16x16x32_bf16 v[248:251], a[152:155], a[16:19], v[248:251]
    v_mfma_f32_16x16x32_bf16 v[248:251], a[156:159], a[20:23], v[248:251]
    v_mfma_f32_16x16x32_bf16 v[252:255], a[152:155], a[24:27], v[252:255]
    v_mfma_f32_16x16x32_bf16 v[252:255], a[156:159], a[28:31], v[252:255]
    v_mfma_f32_16x16x32_bf16 v[96:99], a[160:163], a[0:3], v[96:99]
    v_mfma_f32_16x16x32_bf16 v[96:99], a[164:167], a[4:7], v[96:99]
    v_mfma_f32_16x16x32_bf16 v[100:103], a[160:163], a[8:11], v[100:103]
    s_waitcnt lgkmcnt(0)
    s_barrier
    v_mfma_f32_16x16x32_bf16 v[100:103], a[164:167], a[12:15], v[100:103]
    ds_read_b64_tr_b16 a[128:129], v21 offset:24704
    v_mfma_f32_16x16x32_bf16 v[104:107], a[160:163], a[16:19], v[104:107]
    s_waitcnt vmcnt(8)
    v_cmp_le_u32 vcc, 32, v1
    s_nop 0
    s_cmp_eq_u64 vcc, -1
    s_cbranch_scc0 L_spin_st
L_ok_st:
    v_mfma_f32_16x16x32_bf16 v[104:107], a[164:167], a[20:23], v[104:107]
    ds_read_b64_tr_b16 a[130:131], v21 offset:25728
    v_mfma_f32_16x16x32_bf16 v[108:111], a[160:163], a[24:27], v[108:111]
    ds_read_b64_tr_b16 a[132:133], v21 offset:26752
    v_mfma_f32_16x16x32_bf16 v[108:111], a[164:167], a[28:31], v[108:111]
    s_lshl_b32 s58, s38, 2
    ds_read_b64_tr_b16 a[134:135], v21 offset:27776
    v_mfma_f32_16x16x32_bf16 v[112:115], a[168:171], a[0:3], v[112:115]
    s_add_u32 s58, s58, s36
    ds_read_b64_tr_b16 a[136:137], v21 offset:24736
    v_mfma_f32_16x16x32_bf16 v[112:115], a[172:175], a[4:7], v[112:115]
    s_lshl_b32 s58, s58, 9
    ds_read_b64_tr_b16 a[138:139], v21 offset:25760
    v_mfma_f32_16x16x32_bf16 v[116:119], a[168:171], a[8:11], v[116:119]
    s_add_u32 s58, s58, 25231360
    ds_read_b64_tr_b16 a[140:141], v21 offset:26784
    v_mfma_f32_16x16x32_bf16 v[116:119], a[172:175], a[12:15], v[116:119]
    buffer_load_dwordx2 v[48:49], v92, s[12:15], s58 offen offset:0 sc1
    v_mfma_f32_16x16x32_bf16 v[120:123], a[168:171], a[16:19], v[120:123]
    ds_read_b64_tr_b16 a[142:143], v21 offset:27808
    v_mfma_f32_16x16x32_bf16 v[120:123], a[172:175], a[20:23], v[120:123]
    ds_read_b64_tr_b16 a[144:145], v21 offset:28800
    v_mfma_f32_16x16x32_bf16 v[124:127], a[168:171], a[24:27], v[124:127]
    ds_read_b64_tr_b16 a[146:147], v21 offset:29056
    v_mfma_f32_16x16x32_bf16 v[124:127], a[172:175], a[28:31], v[124:127]
    s_waitcnt lgkmcnt(5)
    buffer_load_dwordx2 v[52:53], v92, s[12:15], s58 offen offset:128 sc1
    v_mfma_f32_16x16x32_bf16 v[128:131], a[128:131], a[32:35], v[128:131]
    ds_read_b64_tr_b16 a[148:149], v21 offset:29312
    v_mfma_f32_16x16x32_bf16 v[128:131], a[132:135], a[36:39], v[128:131]
    s_mov_b32 s42, 49152
    ds_read_b64_tr_b16 a[150:151], v21 offset:29568
    v_mfma_f32_16x16x32_bf16 v[132:135], a[128:131], a[40:43], v[132:135]
    s_lshl_b32 s85, s36, 13
    ds_read_b64_tr_b16 a[152:153], v21 offset:29824
    v_mfma_f32_16x16x32_bf16 v[132:135], a[132:135], a[44:47], v[132:135]
    s_sub_u32 s85, s85, 0x8000
    buffer_load_dwordx2 v[56:57], v93, s[12:15], s58 offen offset:0 sc1
    v_mfma_f32_16x16x32_bf16 v[136:139], a[128:131], a[48:51], v[136:139]
    s_sub_u32 s86, s84, 0x1000
    ds_read_b64_tr_b16 a[154:155], v21 offset:30080
    v_mfma_f32_16x16x32_bf16 v[136:139], a[132:135], a[52:55], v[136:139]
    s_and_b32 s52, s101, 1
    ds_read_b64_tr_b16 a[156:157], v21 offset:30336
    v_mfma_f32_16x16x32_bf16 v[140:143], a[128:131], a[56:59], v[140:143]
    s_mul_i32 s52, s52, 86016
    ds_read_b64_tr_b16 a[158:159], v21 offset:30592
    v_mfma_f32_16x16x32_bf16 v[140:143], a[132:135], a[60:63], v[140:143]
    s_waitcnt lgkmcnt(5)
    s_add_u32 s86, s86, s52
    buffer_load_dwordx2 v[60:61], v93, s[12:15], s58 offen offset:128 sc1
    v_mfma_f32_16x16x32_bf16 v[144:147], a[136:139], a[32:35], v[144:147]
    s_lshl_b32 s52, s52, 3
    ds_read_b64_tr_b16 a[64:65], v22 offset:24704
    v_mfma_f32_16x16x32_bf16 v[144:147], a[140:143], a[36:39], v[144:147]
    s_mov_b32 s59, 0
    ds_read_b64_tr_b16 a[66:67], v22 offset:25728
    v_mfma_f32_16x16x32_bf16 v[148:151], a[136:139], a[40:43], v[148:151]
    s_add_u32 m0, s41, 0
    ds_read_b64_tr_b16 a[68:69], v22 offset:26752
    v_mfma_f32_16x16x32_bf16 v[148:151], a[140:143], a[44:47], v[148:151]
    s_add_u32 s85, s85, s52
    buffer_load_dwordx4 v4, s[8:11], s59 offen offset:0 lds
    v_mfma_f32_16x16x32_bf16 v[152:155], a[136:139], a[48:51], v[152:155]
    s_mov_b32 s43, 7
    ds_read_b64_tr_b16 a[70:71], v22 offset:27776
    v_mfma_f32_16x16x32_bf16 v[152:155], a[140:143], a[52:55], v[152:155]
    s_mul_i32 s52, s101, 525312
    ds_read_b64_tr_b16 a[160:161], v21 offset:28832
    v_mfma_f32_16x16x32_bf16 v[156:159], a[136:139], a[56:59], v[156:159]
    s_mul_i32 s53, s36, 0
    ds_read_b64_tr_b16 a[162:163], v21 offset:29088
    v_mfma_f32_16x16x32_bf16 v[156:159], a[140:143], a[60:63], v[156:159]
    s_add_u32 s52, s52, s53
    buffer_load_dwordx4 v4, s[8:11], s59 offen offset:1024 lds
    v_mfma_f32_16x16x32_bf16 v[96:99], a[144:147], a[32:35], v[96:99]
    s_waitcnt lgkmcnt(4)
    s_add_u32 s52, s52, 33554432
    ds_read_b64_tr_b16 a[164:165], v21 offset:29344
    v_mfma_f32_16x16x32_bf16 v[96:99], a[148:151], a[36:39], v[96:99]
    s_add_u32 s16, s12, s52
    s_addc_u32 s17, s13, 0
    ds_read_b64_tr_b16 a[166:167], v21 offset:29600
    v_mfma_f32_16x16x32_bf16 v[100:103], a[144:147], a[40:43], v[100:103]
    s_mov_b32 s18, 524288
    ds_read_b64_tr_b16 a[72:73], v22 offset:24736
    v_mfma_f32_16x16x32_bf16 v[100:103], a[148:151], a[44:47], v[100:103]
    s_mov_b32 s19, 0x20000
    buffer_load_dwordx4 v4, s[8:11], s59 offen offset:2048 lds
    v_mfma_f32_16x16x32_bf16 v[104:107], a[144:147], a[48:51], v[104:107]
    s_lshl_b32 s52, s38, 2
    ds_read_b64_tr_b16 a[74:75], v22 offset:25760
    v_mfma_f32_16x16x32_bf16 v[104:107], a[148:151], a[52:55], v[104:107]
    s_add_u32 s52, s52, s36
    ds_read_b64_tr_b16 a[76:77], v22 offset:26784
    v_mfma_f32_16x16x32_bf16 v[108:111], a[144:147], a[56:59], v[108:111]
    s_mul_i32 s52, s52, 525312
    ds_read_b64_tr_b16 a[78:79], v22 offset:27808
    v_mfma_f32_16x16x32_bf16 v[108:111], a[148:151], a[60:63], v[108:111]
    s_lshr_b32 s53, s37, 3
    buffer_load_dwordx4 v4, s[8:11], s59 offen offset:3072 lds
    v_mfma_f32_16x16x32_bf16 v[64:67], a[152:155], a[32:35], v[64:67]
    s_mul_i32 s53, s53, 0
    ds_read_b64_tr_b16 a[168:169], v21 offset:24960
    v_mfma_f32_16x16x32_bf16 v[64:67], a[156:159], a[36:39], v[64:67]
    s_mov_b32 s59, 32768
    ds_read_b64_tr_b16 a[170:171], v21 offset:25984
    v_mfma_f32_16x16x32_bf16 v[68:71], a[152:155], a[40:43], v[68:71]
    s_add_u32 m0, s40, 32832
    ds_read_b64_tr_b16 a[172:173], v21 offset:27008
    v_mfma_f32_16x16x32_bf16 v[68:71], a[156:159], a[44:47], v[68:71]
    s_waitcnt lgkmcnt(5)
    s_add_u32 s52, s52, s53
    buffer_load_dwordx4 v4, s[4:7], s59 offen offset:0 lds
    v_smfmac_f32_16x16x64_bf16 a[88:91], v[8:11], a[64:71], v5
    s_add_u32 s52, s52, 33554432
    ds_read_b64_tr_b16 a[174:175], v21 offset:28032
    v_mfma_f32_16x16x32_bf16 v[112:115], a[160:163], a[32:35], v[112:115]
    s_add_u32 s20, s12, s52
    s_addc_u32 s21, s13, 0
    ds_read_b64_tr_b16 a[80:81], v23 offset:28800
    v_mfma_f32_16x16x32_bf16 v[112:115], a[164:167], a[36:39], v[112:115]
    s_mov_b32 s22, 524288
    ds_read_b64_tr_b16 a[82:83], v23 offset:29056
    v_mfma_f32_16x16x32_bf16 v[116:119], a[160:163], a[40:43], v[116:119]
    s_mov_b32 s23, 0x20000
    buffer_load_dwordx4 v4, s[4:7], s59 offen offset:1024 lds
    v_mfma_f32_16x16x32_bf16 v[116:119], a[164:167], a[44:47], v[116:119]
    s_mov_b32 s93, 64
    ds_read_b64_tr_b16 a[84:85], v23 offset:29312
    v_mfma_f32_16x16x32_bf16 v[120:123], a[160:163], a[48:51], v[120:123]
    s_and_b32 s52, s101, 1
    ds_read_b64_tr_b16 a[86:87], v23 offset:29568
    v_mfma_f32_16x16x32_bf16 v[120:123], a[164:167], a[52:55], v[120:123]
    s_mul_i32 s52, s52, 352256
    ds_read_b64_tr_b16 a[128:129], v21 offset:29856
    v_mfma_f32_16x16x32_bf16 v[124:127], a[160:163], a[56:59], v[124:127]
    s_sub_u32 s94, 176128, s52
    buffer_load_dwordx4 v4, s[4:7], s59 offen offset:2048 lds
    v_mfma_f32_16x16x32_bf16 v[124:127], a[164:167], a[60:63], v[124:127]
    s_waitcnt lgkmcnt(4)
    s_xor_b32 s52, s101, 1
    ds_read_b64_tr_b16 a[130:131], v21 offset:30112
    v_smfmac_f32_16x16x64_bf16 a[92:95], v[8:11], a[72:79], v5
    s_mul_i32 s52, s52, 525312
    ds_read_b64_tr_b16 a[132:133], v21 offset:30368
    v_mfma_f32_16x16x32_bf16 v[160:163], a[168:171], a[32:35], v[160:163]
    s_add_u32 s52, s52, 33554432
    ds_read_b64_tr_b16 a[134:135], v21 offset:30624
    v_mfma_f32_16x16x32_bf16 v[160:163], a[172:175], a[36:39], v[160:163]
    s_add_u32 s24, s12, s52
    s_addc_u32 s25, s13, 0
    buffer_load_dwordx4 v4, s[4:7], s59 offen offset:3072 lds
    v_mfma_f32_16x16x32_bf16 v[164:167], a[168:171], a[40:43], v[164:167]
    s_mov_b32 s26, 524288
    ds_read_b64_tr_b16 a[136:137], v21 offset:24992
    v_mfma_f32_16x16x32_bf16 v[164:167], a[172:175], a[44:47], v[164:167]
    s_mov_b32 s27, 0x20000
    ds_read_b64_tr_b16 a[138:139], v21 offset:26016
    v_mfma_f32_16x16x32_bf16 v[168:171], a[168:171], a[48:51], v[168:171]
    ds_read_b64_tr_b16 a[140:141], v21 offset:27040
    v_mfma_f32_16x16x32_bf16 v[168:171], a[172:175], a[52:55], v[168:171]
    ds_read_b64_tr_b16 a[142:143], v21 offset:28064
    v_mfma_f32_16x16x32_bf16 v[172:175], a[168:171], a[56:59], v[172:175]
    ds_read_b64_tr_b16 a[144:145], v21 offset:25216
    v_mfma_f32_16x16x32_bf16 v[172:175], a[172:175], a[60:63], v[172:175]
    s_waitcnt lgkmcnt(5)
    ds_read_b64_tr_b16 a[146:147], v21 offset:26240
    v_smfmac_f32_16x16x64_bf16 a[96:99], v[8:11], a[80:87], v5
    ds_read_b64_tr_b16 a[148:149], v21 offset:27264
    v_mfma_f32_16x16x32_bf16 v[72:75], a[128:131], a[32:35], v[72:75]
L_hop2:
    s_cbranch_execz L_hop6
    ds_read_b64_tr_b16 a[150:151], v21 offset:28288
    v_mfma_f32_16x16x32_bf16 v[72:75], a[132:135], a[36:39], v[72:75]
    ds_read_b64_tr_b16 a[152:153], v21 offset:25248
    v_mfma_f32_16x16x32_bf16 v[76:79], a[128:131], a[40:43], v[76:79]
    ds_read_b64_tr_b16 a[154:155], v21 offset:26272
    v_mfma_f32_16x16x32_bf16 v[76:79], a[132:135], a[44:47], v[76:79]
    s_waitcnt lgkmcnt(6)
    ds_read_b64_tr_b16 a[156:157], v21 offset:27296
    v_mfma_f32_16x16x32_bf16 v[176:179], a[136:139], a[32:35], v[176:179]
    ds_read_b64_tr_b16 a[158:159], v21 offset:28320
    v_mfma_f32_16x16x32_bf16 v[176:179], a[140:143], a[36:39], v[176:179]
    ds_read_b64_tr_b16 a[160:161], v21 offset:25472
    v_accvgpr_read_b32 v28, a88
    v_mfma_f32_16x16x32_bf16 v[180:183], a[136:139], a[40:43], v[180:183]
    ds_read_b64_tr_b16 a[162:163], v21 offset:26496
    v_accvgpr_read_b32 v31, a89
    v_mfma_f32_16x16x32_bf16 v[180:183], a[140:143], a[44:47], v[180:183]
    v_add_f32 v28, v28, v31
    v_accvgpr_read_b32 v29, a92
    v_mfma_f32_16x16x32_bf16 v[184:187], a[136:139], a[48:51], v[184:187]
    ds_read_b64_tr_b16 a[164:165], v21 offset:27520
    v_accvgpr_read_b32 v31, a93
    v_mfma_f32_16x16x32_bf16 v[184:187], a[140:143], a[52:55], v[184:187]
    v_add_f32_e64 v29, v29, v31
    v_accvgpr_read_b32 v30, a96
    v_mfma_f32_16x16x32_bf16 v[188:191], a[136:139], a[56:59], v[188:191]
    ds_read_b64_tr_b16 a[166:167], v21 offset:28544
    v_accvgpr_read_b32 v31, a97
    v_mfma_f32_16x16x32_bf16 v[188:191], a[140:143], a[60:63], v[188:191]
    s_waitcnt lgkmcnt(4)
    ds_read_b64_tr_b16 a[168:169], v21 offset:25504
    v_add_f32 v30, v30, v31
    v_mfma_f32_16x16x32_bf16 v[192:195], a[144:147], a[32:35], v[192:195]
    ds_read_b64_tr_b16 a[170:171], v21 offset:26528
    v_mfma_f32_16x16x32_bf16 v[192:195], a[148:151], a[36:39], v[192:195]
    ds_read_b64_tr_b16 a[172:173], v21 offset:27552
    ds_write_b32 v24, v28
    v_mfma_f32_16x16x32_bf16 v[196:199], a[144:147], a[40:43], v[196:199]
    ds_read_b64_tr_b16 a[174:175], v21 offset:28576
    ds_write_b32 v24, v29 offset:64
    v_mfma_f32_16x16x32_bf16 v[196:199], a[148:151], a[44:47], v[196:199]
    ds_write_b32 v25, v30
    v_mfma_f32_16x16x32_bf16 v[200:203], a[144:147], a[48:51], v[200:203]
    v_mfma_f32_16x16x32_bf16 v[200:203], a[148:151], a[52:55], v[200:203]
    v_mfma_f32_16x16x32_bf16 v[204:207], a[144:147], a[56:59], v[204:207]
    s_waitcnt vmcnt(16) lgkmcnt(0)
    s_barrier
    v_mfma_f32_16x16x32_bf16 v[204:207], a[148:151], a[60:63], v[204:207]
    s_mov_b32 s59, 16384
    ds_read_b128 v[28:31], v26 offset:512
    v_mfma_f32_16x16x32_bf16 v[208:211], a[152:155], a[32:35], v[208:211]
    s_add_u32 m0, s41, 16512
    ds_read_b128 v[88:91], v26 offset:576
    v_mfma_f32_16x16x32_bf16 v[208:211], a[156:159], a[36:39], v[208:211]
    buffer_load_dwordx4 v4, s[8:11], s59 offen offset:0 lds
    v_mfma_f32_16x16x32_bf16 v[212:215], a[152:155], a[40:43], v[212:215]
    ds_read_b128 v[16:19], v26 offset:640
    v_mfma_f32_16x16x32_bf16 v[212:215], a[156:159], a[44:47], v[212:215]
    ds_read_b128 v[20:23], v26 offset:704
    v_mfma_f32_16x16x32_bf16 v[216:219], a[152:155], a[48:51], v[216:219]
    ds_read_b128 a[64:67], v2 offset:0
    v_mfma_f32_16x16x32_bf16 v[216:219], a[156:159], a[52:55], v[216:219]
    ds_read_b128 a[68:71], v2 offset:256
    v_mfma_f32_16x16x32_bf16 v[220:223], a[152:155], a[56:59], v[220:223]
    buffer_load_dwordx4 v4, s[8:11], s59 offen offset:1024 lds
    v_mfma_f32_16x16x32_bf16 v[220:223], a[156:159], a[60:63], v[220:223]
    ds_read_b128 a[72:75], v2 offset:512
    v_mfma_f32_16x16x32_bf16 v[224:227], a[160:163], a[32:35], v[224:227]
    ds_read_b128 a[76:79], v2 offset:768
    v_mfma_f32_16x16x32_bf16 v[224:227], a[164:167], a[36:39], v[224:227]
    ds_read_b128 a[92:95], v2 offset:1792
    v_mfma_f32_16x16x32_bf16 v[228:231], a[160:163], a[40:43], v[228:231]
    ds_read_b128 a[88:91], v2 offset:1536
    v_mfma_f32_16x16x32_bf16 v[228:231], a[164:167], a[44:47], v[228:231]
    buffer_load_dwordx4 v4, s[8:11], s59 offen offset:2048 lds
    v_mfma_f32_16x16x32_bf16 v[232:235], a[160:163], a[48:51], v[232:235]
    ds_read_b128 a[84:87], v2 offset:1280
    v_mfma_f32_16x16x32_bf16 v[232:235], a[164:167], a[52:55], v[232:235]
    ds_read_b128 a[80:83], v2 offset:1024
    v_mfma_f32_16x16x32_bf16 v[236:239], a[160:163], a[56:59], v[236:239]
    ds_read_b128 a[96:99], v2 offset:2048
    v_mfma_f32_16x16x32_bf16 v[236:239], a[164:167], a[60:63], v[236:239]
    ds_read_b128 a[100:103], v2 offset:2304
    v_mfma_f32_16x16x32_bf16 v[240:243], a[168:171], a[32:35], v[240:243]
    buffer_load_dwordx4 v4, s[8:11], s59 offen offset:3072 lds
    v_mfma_f32_16x16x32_bf16 v[240:243], a[172:175], a[36:39], v[240:243]
    ds_read_b128 a[104:107], v2 offset:2560
    v_mfma_f32_16x16x32_bf16 v[244:247], a[168:171], a[40:43], v[244:247]
    ds_read_b128 a[108:111], v2 offset:2816
    v_mfma_f32_16x16x32_bf16 v[244:247], a[172:175], a[44:47], v[244:247]
    s_waitcnt vmcnt(15)
    ds_read_b128 a[124:127], v2 offset:3840
    v_mul_f32 v50, 0x3e0293ee, v49
    v_mfma_f32_16x16x32_bf16 v[248:251], a[168:171], a[48:51], v[248:251]
    s_waitcnt vmcnt(14)
    ds_read_b128 a[120:123], v2 offset:3584
    v_mul_f32 v54, 0x3e0293ee, v53
    v_mfma_f32_16x16x32_bf16 v[248:251], a[172:175], a[52:55], v[248:251]
    s_waitcnt vmcnt(13)
    ds_read_b128 a[116:119], v2 offset:3328
    v_mul_f32 v58, 0x3e0293ee, v57
    v_mfma_f32_16x16x32_bf16 v[252:255], a[168:171], a[56:59], v[252:255]
    s_waitcnt vmcnt(12)
    ds_read_b128 a[112:115], v2 offset:3072
    v_mul_f32 v62, 0x3e0293ee, v61
    v_mfma_f32_16x16x32_bf16 v[252:255], a[172:175], a[60:63], v[252:255]
    s_waitcnt lgkmcnt(6)
    s_nop 0
    s_mov_b32 s54, 0xbdd2d3e8
    s_mov_b32 s55, 0xc0135761
    v_pk_fma_f32 v[96:97], v[28:29], v[48:49], v[96:97] op_sel_hi:[1,0,1]
    v_pk_fma_f32 v[98:99], v[30:31], v[48:49], v[98:99] op_sel_hi:[1,0,1]
    v_pk_fma_f32 v[100:101], v[28:29], v[52:53], v[100:101] op_sel_hi:[1,0,1]
    v_pk_fma_f32 v[102:103], v[30:31], v[52:53], v[102:103] op_sel_hi:[1,0,1]
    v_pk_fma_f32 v[104:105], v[28:29], v[56:57], v[104:105] op_sel_hi:[1,0,1]
    v_pk_fma_f32 v[106:107], v[30:31], v[56:57], v[106:107] op_sel_hi:[1,0,1]
    v_pk_fma_f32 v[108:109], v[28:29], v[60:61], v[108:109] op_sel_hi:[1,0,1]
    v_pk_fma_f32 v[110:111], v[30:31], v[60:61], v[110:111] op_sel_hi:[1,0,1]
    v_pk_fma_f32 v[112:113], v[88:89], v[48:49], v[112:113] op_sel_hi:[1,0,1]
    v_pk_fma_f32 v[114:115], v[90:91], v[48:49], v[114:115] op_sel_hi:[1,0,1]
    v_pk_fma_f32 v[116:117], v[88:89], v[52:53], v[116:117] op_sel_hi:[1,0,1]
    v_pk_fma_f32 v[118:119], v[90:91], v[52:53], v[118:119] op_sel_hi:[1,0,1]
    v_pk_fma_f32 v[120:121], v[88:89], v[56:57], v[120:121] op_sel_hi:[1,0,1]
    v_pk_fma_f32 v[122:123], v[90:91], v[56:57], v[122:123] op_sel_hi:[1,0,1]
    v_pk_fma_f32 v[124:125], v[88:89], v[60:61], v[124:125] op_sel_hi:[1,0,1]
    v_pk_fma_f32 v[126:127], v[90:91], v[60:61], v[126:127] op_sel_hi:[1,0,1]
    v_pk_fma_f32 v[64:65], v[16:17], v[48:49], v[64:65] op_sel_hi:[1,0,1]
    v_pk_fma_f32 v[66:67], v[18:19], v[48:49], v[66:67] op_sel_hi:[1,0,1]
    v_pk_fma_f32 v[68:69], v[16:17], v[52:53], v[68:69] op_sel_hi:[1,0,1]
    v_pk_fma_f32 v[70:71], v[18:19], v[52:53], v[70:71] op_sel_hi:[1,0,1]
    v_pk_fma_f32 v[72:73], v[20:21], v[48:49], v[72:73] op_sel_hi:[1,0,1]
    v_pk_fma_f32 v[74:75], v[22:23], v[48:49], v[74:75] op_sel_hi:[1,0,1]
    v_pk_fma_f32 v[76:77], v[20:21], v[52:53], v[76:77] op_sel_hi:[1,0,1]
    v_pk_fma_f32 v[78:79], v[22:23], v[52:53], v[78:79] op_sel_hi:[1,0,1]
    v_pk_fma_f32 v[96:97], v[96:97], v[48:49], v[32:33] op_sel:[0,1,0] op_sel_hi:[1,1,1]
    v_pk_fma_f32 v[98:99], v[98:99], v[48:49], v[34:35] op_sel:[0,1,0] op_sel_hi:[1,1,1]
    v_pk_fma_f32 v[100:101], v[100:101], v[52:53], v[32:33] op_sel:[0,1,0] op_sel_hi:[1,1,1]
    v_pk_fma_f32 v[102:103], v[102:103], v[52:53], v[34:35] op_sel:[0,1,0] op_sel_hi:[1,1,1]
    v_pk_fma_f32 v[104:105], v[104:105], v[56:57], v[32:33] op_sel:[0,1,0] op_sel_hi:[1,1,1]
    v_pk_fma_f32 v[106:107], v[106:107], v[56:57], v[34:35] op_sel:[0,1,0] op_sel_hi:[1,1,1]
    v_pk_fma_f32 v[108:109], v[108:109], v[60:61], v[32:33] op_sel:[0,1,0] op_sel_hi:[1,1,1]
    v_pk_fma_f32 v[110:111], v[110:111], v[60:61], v[34:35] op_sel:[0,1,0] op_sel_hi:[1,1,1]
    v_pk_fma_f32 v[112:113], v[112:113], v[48:49], v[36:37] op_sel:[0,1,0] op_sel_hi:[1,1,1]
    v_pk_fma_f32 v[114:115], v[114:115], v[48:49], v[38:39] op_sel:[0,1,0] op_sel_hi:[1,1,1]
    v_pk_fma_f32 v[116:117], v[116:117], v[52:53], v[36:37] op_sel:[0,1,0] op_sel_hi:[1,1,1]
    v_pk_fma_f32 v[118:119], v[118:119], v[52:53], v[38:39] op_sel:[0,1,0] op_sel_hi:[1,1,1]
    v_pk_fma_f32 v[120:121], v[120:121], v[56:57], v[36:37] op_sel:[0,1,0] op_sel_hi:[1,1,1]
    v_pk_fma_f32 v[122:123], v[122:123], v[56:57], v[38:39] op_sel:[0,1,0] op_sel_hi:[1,1,1]
    v_pk_fma_f32 v[124:125], v[124:125], v[60:61], v[36:37] op_sel:[0,1,0] op_sel_hi:[1,1,1]
    v_pk_fma_f32 v[126:127], v[126:127], v[60:61], v[38:39] op_sel:[0,1,0] op_sel_hi:[1,1,1]
    v_pk_fma_f32 v[64:65], v[64:65], v[48:49], v[40:41] op_sel:[0,1,0] op_sel_hi:[1,1,1]
    v_pk_fma_f32 v[66:67], v[66:67], v[48:49], v[42:43] op_sel:[0,1,0] op_sel_hi:[1,1,1]
    v_pk_fma_f32 v[68:69], v[68:69], v[52:53], v[40:41] op_sel:[0,1,0] op_sel_hi:[1,1,1]
    v_pk_fma_f32 v[70:71], v[70:71], v[52:53], v[42:43] op_sel:[0,1,0] op_sel_hi:[1,1,1]
    v_pk_fma_f32 v[72:73], v[72:73], v[48:49], v[44:45] op_sel:[0,1,0] op_sel_hi:[1,1,1]
    v_pk_fma_f32 v[74:75], v[74:75], v[48:49], v[46:47] op_sel:[0,1,0] op_sel_hi:[1,1,1]
    v_pk_fma_f32 v[76:77], v[76:77], v[52:53], v[44:45] op_sel:[0,1,0] op_sel_hi:[1,1,1]
    v_pk_fma_f32 v[78:79], v[78:79], v[52:53], v[46:47] op_sel:[0,1,0] op_sel_hi:[1,1,1]
    v_pk_mul_f32 v[32:33], v[96:97], v[96:97]
    v_pk_mul_f32 v[34:35], v[98:99], v[98:99]
    v_pk_mul_f32 v[36:37], v[112:113], v[112:113]
    v_pk_mul_f32 v[38:39], v[114:115], v[114:115]
    v_pk_mul_f32 v[40:41], v[100:101], v[100:101]
    v_pk_mul_f32 v[42:43], v[102:103], v[102:103]
    v_pk_mul_f32 v[44:45], v[116:117], v[116:117]
    v_pk_mul_f32 v[46:47], v[118:119], v[118:119]
    v_pk_fma_f32 v[32:33], v[32:33], s[54:55], s[54:55] op_sel:[0,0,1] op_sel_hi:[1,0,1]
    v_pk_fma_f32 v[34:35], v[34:35], s[54:55], s[54:55] op_sel:[0,0,1] op_sel_hi:[1,0,1]
    v_pk_fma_f32 v[36:37], v[36:37], s[54:55], s[54:55] op_sel:[0,0,1] op_sel_hi:[1,0,1]
    v_pk_fma_f32 v[38:39], v[38:39], s[54:55], s[54:55] op_sel:[0,0,1] op_sel_hi:[1,0,1]
    v_pk_fma_f32 v[40:41], v[40:41], s[54:55], s[54:55] op_sel:[0,0,1] op_sel_hi:[1,0,1]
    v_pk_fma_f32 v[42:43], v[42:43], s[54:55], s[54:55] op_sel:[0,0,1] op_sel_hi:[1,0,1]
    v_pk_fma_f32 v[44:45], v[44:45], s[54:55], s[54:55] op_sel:[0,0,1] op_sel_hi:[1,0,1]
    v_pk_fma_f32 v[46:47], v[46:47], s[54:55], s[54:55] op_sel:[0,0,1] op_sel_hi:[1,0,1]
    v_pk_mul_f32 v[32:33], v[32:33], v[96:97]
    v_pk_mul_f32 v[34:35], v[34:35], v[98:99]
    v_pk_mul_f32 v[36:37], v[36:37], v[112:113]
    v_pk_mul_f32 v[38:39], v[38:39], v[114:115]
    v_pk_mul_f32 v[40:41], v[40:41], v[100:101]
    v_pk_mul_f32 v[42:43], v[42:43], v[102:103]
    v_pk_mul_f32 v[44:45], v[44:45], v[116:117]
    v_pk_mul_f32 v[46:47], v[46:47], v[118:119]
    v_exp_f32 v32, v32
    v_exp_f32 v33, v33
    v_exp_f32 v34, v34
    v_exp_f32 v35, v35
    v_exp_f32 v36, v36
    v_exp_f32 v37, v37
    v_exp_f32 v38, v38
    v_exp_f32 v39, v39
    v_exp_f32 v40, v40
    v_exp_f32 v41, v41
    v_exp_f32 v42, v42
    v_exp_f32 v43, v43
    v_exp_f32 v44, v44
    v_exp_f32 v45, v45
    v_exp_f32 v46, v46
    v_exp_f32 v47, v47
    v_pk_add_f32 v[32:33], v[32:33], 1.0 op_sel_hi:[1,0]
    v_pk_add_f32 v[34:35], v[34:35], 1.0 op_sel_hi:[1,0]
    v_pk_add_f32 v[36:37], v[36:37], 1.0 op_sel_hi:[1,0]
    v_pk_add_f32 v[38:39], v[38:39], 1.0 op_sel_hi:[1,0]
    v_pk_add_f32 v[40:41], v[40:41], 1.0 op_sel_hi:[1,0]
    v_pk_add_f32 v[42:43], v[42:43], 1.0 op_sel_hi:[1,0]
    v_pk_add_f32 v[44:45], v[44:45], 1.0 op_sel_hi:[1,0]
    v_pk_add_f32 v[46:47], v[46:47], 1.0 op_sel_hi:[1,0]
    v_rcp_f32 v32, v32
    v_rcp_f32 v33, v33
    v_rcp_f32 v34, v34
    v_rcp_f32 v35, v35
    v_rcp_f32 v36, v36
    v_rcp_f32 v37, v37
    v_rcp_f32 v38, v38
    v_rcp_f32 v39, v39
    v_rcp_f32 v40, v40
    v_rcp_f32 v41, v41
    v_rcp_f32 v42, v42
    v_rcp_f32 v43, v43
    v_rcp_f32 v44, v44
    v_rcp_f32 v45, v45
    v_rcp_f32 v46, v46
    v_rcp_f32 v47, v47
    v_pk_mul_f32 v[32:33], v[32:33], v[96:97]
    v_pk_mul_f32 v[34:35], v[34:35], v[98:99]
    v_pk_mul_f32 v[36:37], v[36:37], v[112:113]
    v_pk_mul_f32 v[38:39], v[38:39], v[114:115]
    v_pk_mul_f32 v[40:41], v[40:41], v[100:101]
    v_pk_mul_f32 v[42:43], v[42:43], v[102:103]
    v_pk_mul_f32 v[44:45], v[44:45], v[116:117]
    v_pk_mul_f32 v[46:47], v[46:47], v[118:119]
    v_cvt_pk_bf16_f32 v96, v32, v33
    v_cvt_pk_bf16_f32 v97, v34, v35
    v_cvt_pk_bf16_f32 v98, v36, v37
    v_cvt_pk_bf16_f32 v99, v38, v39
    v_cvt_pk_bf16_f32 v100, v40, v41
    v_cvt_pk_bf16_f32 v101, v42, v43
    v_cvt_pk_bf16_f32 v102, v44, v45
    v_cvt_pk_bf16_f32 v103, v46, v47
    s_waitcnt vmcnt(8)
    s_barrier
    buffer_store_dwordx4 v[96:99], v6, s[12:15], s87 offen offset:0 sc1
    buffer_store_dwordx4 v[100:103], v6, s[12:15], s87 offen offset:1024 sc1
    v_pk_mul_f32 v[32:33], v[104:105], v[104:105]
    v_pk_mul_f32 v[34:35], v[106:107], v[106:107]
    v_pk_mul_f32 v[36:37], v[120:121], v[120:121]
    v_pk_mul_f32 v[38:39], v[122:123], v[122:123]
    v_pk_mul_f32 v[40:41], v[108:109], v[108:109]
    v_pk_mul_f32 v[42:43], v[110:111], v[110:111]
    v_pk_mul_f32 v[44:45], v[124:125], v[124:125]
    v_pk_mul_f32 v[46:47], v[126:127], v[126:127]
    v_pk_fma_f32 v[32:33], v[32:33], s[54:55], s[54:55] op_sel:[0,0,1] op_sel_hi:[1,0,1]
    v_pk_fma_f32 v[34:35], v[34:35], s[54:55], s[54:55] op_sel:[0,0,1] op_sel_hi:[1,0,1]
    v_pk_fma_f32 v[36:37], v[36:37], s[54:55], s[54:55] op_sel:[0,0,1] op_sel_hi:[1,0,1]
    v_pk_fma_f32 v[38:39], v[38:39], s[54:55], s[54:55] op_sel:[0,0,1] op_sel_hi:[1,0,1]
    v_pk_fma_f32 v[40:41], v[40:41], s[54:55], s[54:55] op_sel:[0,0,1] op_sel_hi:[1,0,1]
    v_pk_fma_f32 v[42:43], v[42:43], s[54:55], s[54:55] op_sel:[0,0,1] op_sel_hi:[1,0,1]
    v_pk_fma_f32 v[44:45], v[44:45], s[54:55], s[54:55] op_sel:[0,0,1] op_sel_hi:[1,0,1]
    v_pk_fma_f32 v[46:47], v[46:47], s[54:55], s[54:55] op_sel:[0,0,1] op_sel_hi:[1,0,1]
    v_pk_mul_f32 v[32:33], v[32:33], v[104:105]
    v_pk_mul_f32 v[34:35], v[34:35], v[106:107]
    v_pk_mul_f32 v[36:37], v[36:37], v[120:121]
    v_pk_mul_f32 v[38:39], v[38:39], v[122:123]
    v_pk_mul_f32 v[40:41], v[40:41], v[108:109]
    v_pk_mul_f32 v[42:43], v[42:43], v[110:111]
    v_pk_mul_f32 v[44:45], v[44:45], v[124:125]
    v_pk_mul_f32 v[46:47], v[46:47], v[126:127]
    v_exp_f32 v32, v32
    v_exp_f32 v33, v33
    v_exp_f32 v34, v34
    v_exp_f32 v35, v35
    v_exp_f32 v36, v36
    v_exp_f32 v37, v37
    v_exp_f32 v38, v38
    v_exp_f32 v39, v39
    v_exp_f32 v40, v40
    v_exp_f32 v41, v41
    v_exp_f32 v42, v42
    v_exp_f32 v43, v43
    v_exp_f32 v44, v44
    v_exp_f32 v45, v45
    v_exp_f32 v46, v46
    v_exp_f32 v47, v47
    v_pk_add_f32 v[32:33], v[32:33], 1.0 op_sel_hi:[1,0]
    v_pk_add_f32 v[34:35], v[34:35], 1.0 op_sel_hi:[1,0]
    v_pk_add_f32 v[36:37], v[36:37], 1.0 op_sel_hi:[1,0]
    v_pk_add_f32 v[38:39], v[38:39], 1.0 op_sel_hi:[1,0]
    v_pk_add_f32 v[40:41], v[40:41], 1.0 op_sel_hi:[1,0]
    v_pk_add_f32 v[42:43], v[42:43], 1.0 op_sel_hi:[1,0]
    v_pk_add_f32 v[44:45], v[44:45], 1.0 op_sel_hi:[1,0]
    v_pk_add_f32 v[46:47], v[46:47], 1.0 op_sel_hi:[1,0]
    v_rcp_f32 v32, v32
    v_rcp_f32 v33, v33
    v_rcp_f32 v34, v34
    v_rcp_f32 v35, v35
    v_rcp_f32 v36, v36
    v_rcp_f32 v37, v37
    v_rcp_f32 v38, v38
    v_rcp_f32 v39, v39
    v_rcp_f32 v40, v40
    v_rcp_f32 v41, v41
    v_rcp_f32 v42, v42
    v_rcp_f32 v43, v43
    v_rcp_f32 v44, v44
    v_rcp_f32 v45, v45
    v_rcp_f32 v46, v46
    v_rcp_f32 v47, v47
    v_pk_mul_f32 v[32:33], v[32:33], v[104:105]
    v_pk_mul_f32 v[34:35], v[34:35], v[106:107]
    v_pk_mul_f32 v[36:37], v[36:37], v[120:121]
    v_pk_mul_f32 v[38:39], v[38:39], v[122:123]
    v_pk_mul_f32 v[40:41], v[40:41], v[108:109]
    v_pk_mul_f32 v[42:43], v[42:43], v[110:111]
    v_pk_mul_f32 v[44:45], v[44:45], v[124:125]
    v_pk_mul_f32 v[46:47], v[46:47], v[126:127]
    v_cvt_pk_bf16_f32 v104, v32, v33
    v_cvt_pk_bf16_f32 v105, v34, v35
    v_cvt_pk_bf16_f32 v106, v36, v37
    v_cvt_pk_bf16_f32 v107, v38, v39
    v_cvt_pk_bf16_f32 v108, v40, v41
    v_cvt_pk_bf16_f32 v109, v42, v43
    v_cvt_pk_bf16_f32 v110, v44, v45
    v_cvt_pk_bf16_f32 v111, v46, v47
    buffer_store_dwordx4 v[104:107], v7, s[12:15], s87 offen offset:0 sc1
    ds_read_b128 v[112:115], v26 offset:256
    ds_read_b128 v[116:119], v26 offset:320
    ds_read_b128 v[120:123], v26 offset:384
    ds_read_b128 v[124:127], v26 offset:448
    buffer_store_dwordx4 v[108:111], v7, s[12:15], s87 offen offset:1024 sc1
    ds_read_b128 v[96:99], v26 offset:0
    ds_read_b128 v[100:103], v26 offset:64
    ds_read_b128 v[104:107], v26 offset:128
    ds_read_b128 v[108:111], v26 offset:192
    v_pk_mul_f32 v[32:33], v[64:65], v[64:65]
    v_pk_mul_f32 v[34:35], v[66:67], v[66:67]
    v_pk_mul_f32 v[36:37], v[72:73], v[72:73]
    v_pk_mul_f32 v[38:39], v[74:75], v[74:75]
    v_pk_mul_f32 v[40:41], v[68:69], v[68:69]
    v_pk_mul_f32 v[42:43], v[70:71], v[70:71]
    v_pk_mul_f32 v[44:45], v[76:77], v[76:77]
    v_pk_mul_f32 v[46:47], v[78:79], v[78:79]
    v_pk_fma_f32 v[32:33], v[32:33], s[54:55], s[54:55] op_sel:[0,0,1] op_sel_hi:[1,0,1]
    v_pk_fma_f32 v[34:35], v[34:35], s[54:55], s[54:55] op_sel:[0,0,1] op_sel_hi:[1,0,1]
    v_pk_fma_f32 v[36:37], v[36:37], s[54:55], s[54:55] op_sel:[0,0,1] op_sel_hi:[1,0,1]
    v_pk_fma_f32 v[38:39], v[38:39], s[54:55], s[54:55] op_sel:[0,0,1] op_sel_hi:[1,0,1]
    v_pk_fma_f32 v[40:41], v[40:41], s[54:55], s[54:55] op_sel:[0,0,1] op_sel_hi:[1,0,1]
    v_pk_fma_f32 v[42:43], v[42:43], s[54:55], s[54:55] op_sel:[0,0,1] op_sel_hi:[1,0,1]
    v_pk_fma_f32 v[44:45], v[44:45], s[54:55], s[54:55] op_sel:[0,0,1] op_sel_hi:[1,0,1]
    v_pk_fma_f32 v[46:47], v[46:47], s[54:55], s[54:55] op_sel:[0,0,1] op_sel_hi:[1,0,1]
    v_pk_mul_f32 v[32:33], v[32:33], v[64:65]
    v_pk_mul_f32 v[34:35], v[34:35], v[66:67]
    v_pk_mul_f32 v[36:37], v[36:37], v[72:73]
    v_pk_mul_f32 v[38:39], v[38:39], v[74:75]
    v_pk_mul_f32 v[40:41], v[40:41], v[68:69]
    v_pk_mul_f32 v[42:43], v[42:43], v[70:71]
    v_pk_mul_f32 v[44:45], v[44:45], v[76:77]
    v_pk_mul_f32 v[46:47], v[46:47], v[78:79]
    v_exp_f32 v32, v32
    v_exp_f32 v33, v33
    v_exp_f32 v34, v34
    v_exp_f32 v35, v35
    v_exp_f32 v36, v36
    v_exp_f32 v37, v37
    v_exp_f32 v38, v38
    v_exp_f32 v39, v39
    v_exp_f32 v40, v40
    v_exp_f32 v41, v41
    v_exp_f32 v42, v42
    v_exp_f32 v43, v43
    v_exp_f32 v44, v44
    v_exp_f32 v45, v45
    v_exp_f32 v46, v46
    v_exp_f32 v47, v47
    v_pk_add_f32 v[32:33], v[32:33], 1.0 op_sel_hi:[1,0]
    v_pk_add_f32 v[34:35], v[34:35], 1.0 op_sel_hi:[1,0]
    v_pk_add_f32 v[36:37], v[36:37], 1.0 op_sel_hi:[1,0]
    v_pk_add_f32 v[38:39], v[38:39], 1.0 op_sel_hi:[1,0]
    v_pk_add_f32 v[40:41], v[40:41], 1.0 op_sel_hi:[1,0]
    v_pk_add_f32 v[42:43], v[42:43], 1.0 op_sel_hi:[1,0]
    v_pk_add_f32 v[44:45], v[44:45], 1.0 op_sel_hi:[1,0]
    v_pk_add_f32 v[46:47], v[46:47], 1.0 op_sel_hi:[1,0]
    v_rcp_f32 v32, v32
    v_rcp_f32 v33, v33
    v_rcp_f32 v34, v34
    v_rcp_f32 v35, v35
    v_rcp_f32 v36, v36
    v_rcp_f32 v37, v37
    v_rcp_f32 v38, v38
    v_rcp_f32 v39, v39
    v_rcp_f32 v40, v40
    v_rcp_f32 v41, v41
    v_rcp_f32 v42, v42
    v_rcp_f32 v43, v43
    v_rcp_f32 v44, v44
    v_rcp_f32 v45, v45
    v_rcp_f32 v46, v46
    v_rcp_f32 v47, v47
    v_pk_mul_f32 v[32:33], v[32:33], v[64:65]
    v_pk_mul_f32 v[34:35], v[34:35], v[66:67]
    v_pk_mul_f32 v[36:37], v[36:37], v[72:73]
    v_pk_mul_f32 v[38:39], v[38:39], v[74:75]
    v_pk_mul_f32 v[40:41], v[40:41], v[68:69]
    v_pk_mul_f32 v[42:43], v[42:43], v[70:71]
    v_pk_mul_f32 v[44:45], v[44:45], v[76:77]
    v_pk_mul_f32 v[46:47], v[46:47], v[78:79]
    v_cvt_pk_bf16_f32 v64, v32, v33
    v_cvt_pk_bf16_f32 v65, v34, v35
    v_cvt_pk_bf16_f32 v66, v36, v37
    v_cvt_pk_bf16_f32 v67, v38, v39
    v_cvt_pk_bf16_f32 v68, v40, v41
    v_cvt_pk_bf16_f32 v69, v42, v43
    v_cvt_pk_bf16_f32 v70, v44, v45
    v_cvt_pk_bf16_f32 v71, v46, v47
    v_mov_b32 v1, 0x10000000
    buffer_store_dwordx4 v[64:67], v27, s[12:15], s88 offen offset:0 sc1
    buffer_store_dwordx4 v[68:71], v27, s[12:15], s88 offen offset:1024 sc1
    v_lshrrev_b32 v90, 4, v0
    v_lshlrev_b32 v90, 3, v90
    s_waitcnt lgkmcnt(3)
    v_pk_fma_f32 v[128:129], v[96:97], v[48:49], v[128:129] op_sel_hi:[1,0,1]
    v_pk_fma_f32 v[130:131], v[98:99], v[48:49], v[130:131] op_sel_hi:[1,0,1]
    s_waitcnt lgkmcnt(2)
    v_pk_fma_f32 v[144:145], v[100:101], v[48:49], v[144:145] op_sel_hi:[1,0,1]
    v_pk_fma_f32 v[146:147], v[102:103], v[48:49], v[146:147] op_sel_hi:[1,0,1]
    s_waitcnt lgkmcnt(1)
    v_pk_fma_f32 v[160:161], v[104:105], v[48:49], v[160:161] op_sel_hi:[1,0,1]
    v_pk_fma_f32 v[162:163], v[106:107], v[48:49], v[162:163] op_sel_hi:[1,0,1]
    s_waitcnt lgkmcnt(0)
    v_pk_fma_f32 v[176:177], v[108:109], v[48:49], v[176:177] op_sel_hi:[1,0,1]
    v_pk_fma_f32 v[178:179], v[110:111], v[48:49], v[178:179] op_sel_hi:[1,0,1]
    v_pk_fma_f32 v[192:193], v[112:113], v[48:49], v[192:193] op_sel_hi:[1,0,1]
    v_pk_fma_f32 v[194:195], v[114:115], v[48:49], v[194:195] op_sel_hi:[1,0,1]
    v_pk_fma_f32 v[208:209], v[116:117], v[48:49], v[208:209] op_sel_hi:[1,0,1]
    v_pk_fma_f32 v[210:211], v[118:119], v[48:49], v[210:211] op_sel_hi:[1,0,1]
    v_pk_fma_f32 v[224:225], v[120:121], v[48:49], v[224:225] op_sel_hi:[1,0,1]
    v_pk_fma_f32 v[226:227], v[122:123], v[48:49], v[226:227] op_sel_hi:[1,0,1]
    v_pk_fma_f32 v[240:241], v[124:125], v[48:49], v[240:241] op_sel_hi:[1,0,1]
    v_pk_fma_f32 v[242:243], v[126:127], v[48:49], v[242:243] op_sel_hi:[1,0,1]
    v_pk_mul_f32 v[128:129], v[128:129], v[50:51] op_sel_hi:[1,0]
    v_pk_mul_f32 v[130:131], v[130:131], v[50:51] op_sel_hi:[1,0]
    v_pk_mul_f32 v[144:145], v[144:145], v[50:51] op_sel_hi:[1,0]
    v_pk_mul_f32 v[146:147], v[146:147], v[50:51] op_sel_hi:[1,0]
    v_pk_mul_f32 v[160:161], v[160:161], v[50:51] op_sel_hi:[1,0]
    v_pk_mul_f32 v[162:163], v[162:163], v[50:51] op_sel_hi:[1,0]
    v_pk_mul_f32 v[176:177], v[176:177], v[50:51] op_sel_hi:[1,0]
    v_pk_mul_f32 v[178:179], v[178:179], v[50:51] op_sel_hi:[1,0]
    v_pk_mul_f32 v[192:193], v[192:193], v[50:51] op_sel_hi:[1,0]
    v_pk_mul_f32 v[194:195], v[194:195], v[50:51] op_sel_hi:[1,0]
    v_pk_mul_f32 v[208:209], v[208:209], v[50:51] op_sel_hi:[1,0]
    v_pk_mul_f32 v[210:211], v[210:211], v[50:51] op_sel_hi:[1,0]
    v_pk_mul_f32 v[224:225], v[224:225], v[50:51] op_sel_hi:[1,0]
    v_pk_mul_f32 v[226:227], v[226:227], v[50:51] op_sel_hi:[1,0]
    v_pk_mul_f32 v[240:241], v[240:241], v[50:51] op_sel_hi:[1,0]
    v_pk_mul_f32 v[242:243], v[242:243], v[50:51] op_sel_hi:[1,0]
    v_cvt_pk_bf16_f32 v32, v128, v129
    v_cvt_pk_bf16_f32 v34, v144, v145
    v_cvt_pk_bf16_f32 v33, v130, v131
    v_cvt_pk_bf16_f32 v35, v146, v147
    v_cvt_pk_bf16_f32 v36, v160, v161
    v_cvt_pk_bf16_f32 v38, v176, v177
    v_cvt_pk_bf16_f32 v37, v162, v163
    v_cvt_pk_bf16_f32 v39, v178, v179
    v_cvt_pk_bf16_f32 v40, v192, v193
    v_cvt_pk_bf16_f32 v42, v208, v209
    v_cvt_pk_bf16_f32 v41, v194, v195
    v_cvt_pk_bf16_f32 v43, v210, v211
    v_cvt_pk_bf16_f32 v44, v224, v225
    v_cvt_pk_bf16_f32 v46, v240, v241
    v_cvt_pk_bf16_f32 v45, v226, v227
    v_cvt_pk_bf16_f32 v47, v242, v243
    v_permlane16_swap_b32 v32, v34
    v_permlane16_swap_b32 v33, v35
    v_permlane16_swap_b32 v36, v38
    v_permlane16_swap_b32 v37, v39
    v_permlane16_swap_b32 v40, v42
    v_permlane16_swap_b32 v41, v43
    v_permlane16_swap_b32 v44, v46
    v_permlane16_swap_b32 v45, v47
    v_accvgpr_write_b32 a0, v32
    v_accvgpr_write_b32 a1, v33
    v_accvgpr_write_b32 a2, v34
    v_accvgpr_write_b32 a3, v35
    v_accvgpr_write_b32 a4, v36
    v_accvgpr_write_b32 a5, v37
    v_accvgpr_write_b32 a6, v38
    v_accvgpr_write_b32 a7, v39
    v_accvgpr_write_b32 a8, v40
    v_accvgpr_write_b32 a9, v41
    v_accvgpr_write_b32 a10, v42
    v_accvgpr_write_b32 a11, v43
    v_accvgpr_write_b32 a12, v44
    v_accvgpr_write_b32 a13, v45
    v_accvgpr_write_b32 a14, v46
    v_accvgpr_write_b32 a15, v47
    v_pk_fma_f32 v[132:133], v[96:97], v[52:53], v[132:133] op_sel_hi:[1,0,1]
    v_pk_fma_f32 v[134:135], v[98:99], v[52:53], v[134:135] op_sel_hi:[1,0,1]
    v_pk_fma_f32 v[148:149], v[100:101], v[52:53], v[148:149] op_sel_hi:[1,0,1]
    v_pk_fma_f32 v[150:151], v[102:103], v[52:53], v[150:151] op_sel_hi:[1,0,1]
    v_pk_fma_f32 v[164:165], v[104:105], v[52:53], v[164:165] op_sel_hi:[1,0,1]
    v_pk_fma_f32 v[166:167], v[106:107], v[52:53], v[166:167] op_sel_hi:[1,0,1]
    v_pk_fma_f32 v[180:181], v[108:109], v[52:53], v[180:181] op_sel_hi:[1,0,1]
    v_pk_fma_f32 v[182:183], v[110:111], v[52:53], v[182:183] op_sel_hi:[1,0,1]
    v_pk_fma_f32 v[196:197], v[112:113], v[52:53], v[196:197] op_sel_hi:[1,0,1]
    v_pk_fma_f32 v[198:199], v[114:115], v[52:53], v[198:199] op_sel_hi:[1,0,1]
    v_pk_fma_f32 v[212:213], v[116:117], v[52:53], v[212:213] op_sel_hi:[1,0,1]
    v_pk_fma_f32 v[214:215], v[118:119], v[52:53], v[214:215] op_sel_hi:[1,0,1]
    v_pk_fma_f32 v[228:229], v[120:121], v[52:53], v[228:229] op_sel_hi:[1,0,1]
    v_pk_fma_f32 v[230:231], v[122:123], v[52:53], v[230:231] op_sel_hi:[1,0,1]
    v_pk_fma_f32 v[244:245], v[124:125], v[52:53], v[244:245] op_sel_hi:[1,0,1]
    v_pk_fma_f32 v[246:247], v[126:127], v[52:53], v[246:247] op_sel_hi:[1,0,1]
    v_pk_mul_f32 v[132:133], v[132:133], v[54:55] op_sel_hi:[1,0]
    v_pk_mul_f32 v[134:135], v[134:135], v[54:55] op_sel_hi:[1,0]
    v_pk_mul_f32 v[148:149], v[148:149], v[54:55] op_sel_hi:[1,0]
    v_pk_mul_f32 v[150:151], v[150:151], v[54:55] op_sel_hi:[1,0]
    v_pk_mul_f32 v[164:165], v[164:165], v[54:55] op_sel_hi:[1,0]
    v_pk_mul_f32 v[166:167], v[166:167], v[54:55] op_sel_hi:[1,0]
    v_pk_mul_f32 v[180:181], v[180:181], v[54:55] op_sel_hi:[1,0]
    v_pk_mul_f32 v[182:183], v[182:183], v[54:55] op_sel_hi:[1,0]
    v_pk_mul_f32 v[196:197], v[196:197], v[54:55] op_sel_hi:[1,0]
    v_pk_mul_f32 v[198:199], v[198:199], v[54:55] op_sel_hi:[1,0]
    v_pk_mul_f32 v[212:213], v[212:213], v[54:55] op_sel_hi:[1,0]
    v_pk_mul_f32 v[214:215], v[214:215], v[54:55] op_sel_hi:[1,0]
    v_pk_mul_f32 v[228:229], v[228:229], v[54:55] op_sel_hi:[1,0]
    v_pk_mul_f32 v[230:231], v[230:231], v[54:55] op_sel_hi:[1,0]
    v_pk_mul_f32 v[244:245], v[244:245], v[54:55] op_sel_hi:[1,0]
    v_pk_mul_f32 v[246:247], v[246:247], v[54:55] op_sel_hi:[1,0]
    v_mfma_f32_16x16x32_bf16 v[128:131], a[64:67], a[0:3], 0
    s_add_u32 m0, s81, 0
    s_nop 0
    buffer_load_dwordx4 v1, s[68:71], 0 offen lds
    ds_read_b64_tr_b16 a[128:129], v3 offset:0
    v_cvt_pk_bf16_f32 v32, v132, v133
    v_cvt_pk_bf16_f32 v34, v148, v149
    v_cvt_pk_bf16_f32 v33, v134, v135
    v_mfma_f32_16x16x32_bf16 v[128:131], a[68:71], a[4:7], v[128:131]
    ds_read_b64_tr_b16 a[130:131], v3 offset:1024
    ds_read_b64_tr_b16 a[160:161], v3 offset:2048
    v_cvt_pk_bf16_f32 v35, v150, v151
    v_cvt_pk_bf16_f32 v36, v164, v165
    v_cvt_pk_bf16_f32 v38, v180, v181
    v_mfma_f32_16x16x32_bf16 v[128:131], a[72:75], a[8:11], v[128:131]
    buffer_load_dwordx2 v[72:73], v90, s[76:79], 0 offen offset:0
    ds_read_b64_tr_b16 a[162:163], v3 offset:3072
    v_cvt_pk_bf16_f32 v37, v166, v167
    v_cvt_pk_bf16_f32 v39, v182, v183
    v_cvt_pk_bf16_f32 v40, v196, v197
    v_mfma_f32_16x16x32_bf16 v[128:131], a[76:79], a[12:15], v[128:131]
    ds_read_b64_tr_b16 a[164:165], v3 offset:2080
    v_cvt_pk_bf16_f32 v42, v212, v213
    v_cvt_pk_bf16_f32 v41, v198, v199
    v_cvt_pk_bf16_f32 v43, v214, v215
    v_mfma_f32_16x16x32_bf16 v[144:147], a[92:95], a[12:15], 0
    ds_read_b64_tr_b16 a[166:167], v3 offset:3104
    v_cvt_pk_bf16_f32 v44, v228, v229
    v_cvt_pk_bf16_f32 v46, v244, v245
    v_cvt_pk_bf16_f32 v45, v230, v231
    v_mfma_f32_16x16x32_bf16 v[144:147], a[88:91], a[8:11], v[144:147]
    buffer_load_dwordx2 v[74:75], v90, s[76:79], 0 offen offset:32
    v_cvt_pk_bf16_f32 v47, v246, v247
    v_permlane16_swap_b32 v32, v34
    v_mfma_f32_16x16x32_bf16 v[144:147], a[84:87], a[4:7], v[144:147]
    ds_read_b64_tr_b16 a[132:133], v3 offset:32
    v_permlane16_swap_b32 v33, v35
    v_permlane16_swap_b32 v36, v38
    v_mfma_f32_16x16x32_bf16 v[144:147], a[80:83], a[0:3], v[144:147]
    ds_read_b64_tr_b16 a[134:135], v3 offset:1056
    v_permlane16_swap_b32 v37, v39
    v_mfma_f32_16x16x32_bf16 v[160:163], a[96:99], a[0:3], 0
    ds_read_b64_tr_b16 a[136:137], v3 offset:256
    v_permlane16_swap_b32 v40, v42
    v_permlane16_swap_b32 v41, v43
    v_mfma_f32_16x16x32_bf16 v[160:163], a[100:103], a[4:7], v[160:163]
    buffer_load_dwordx2 v[76:77], v90, s[76:79], 0 offen offset:64
    v_permlane16_swap_b32 v44, v46
    v_mfma_f32_16x16x32_bf16 v[160:163], a[104:107], a[8:11], v[160:163]
    ds_read_b64_tr_b16 a[138:139], v3 offset:1280
    v_permlane16_swap_b32_e64 v45, v47
    v_accvgpr_write_b32 a16, v32
    v_mfma_f32_16x16x32_bf16 v[160:163], a[108:111], a[12:15], v[160:163]
L_hop3:
    s_cbranch_execz L_hop7
    ds_read_b64_tr_b16 a[168:169], v3 offset:2304
    v_accvgpr_write_b32 a17, v33
    v_accvgpr_write_b32 a18, v34
    v_accvgpr_write_b32 a19, v35
    v_mfma_f32_16x16x32_bf16 v[176:179], a[124:127], a[12:15], 0
    ds_read_b64_tr_b16 a[170:171], v3 offset:3328
    v_accvgpr_write_b32 a20, v36
    v_accvgpr_write_b32 a21, v37
    v_accvgpr_write_b32 a22, v38
    v_mfma_f32_16x16x32_bf16 v[176:179], a[120:123], a[8:11], v[176:179]
    buffer_load_dwordx2 v[78:79], v90, s[76:79], 0 offen offset:96
    v_accvgpr_write_b32 a23, v39
    v_accvgpr_write_b32 a24, v40
    v_accvgpr_write_b32 a25, v41
    v_mfma_f32_16x16x32_bf16 v[176:179], a[116:119], a[4:7], v[176:179]
    ds_read_b64_tr_b16 a[172:173], v3 offset:2336
    v_accvgpr_write_b32 a26, v42
    v_accvgpr_write_b32 a27, v43
    v_accvgpr_write_b32 a28, v44
    v_mfma_f32_16x16x32_bf16 v[176:179], a[112:115], a[0:3], v[176:179]
    ds_read_b64_tr_b16 a[174:175], v3 offset:3360
    v_accvgpr_write_b32 a29, v45
    v_accvgpr_write_b32 a30, v46
    v_accvgpr_write_b32 a31, v47
    v_pk_fma_f32 v[136:137], v[96:97], v[56:57], v[136:137] op_sel_hi:[1,0,1]
    v_pk_fma_f32 v[138:139], v[98:99], v[56:57], v[138:139] op_sel_hi:[1,0,1]
    v_pk_fma_f32 v[152:153], v[100:101], v[56:57], v[152:153] op_sel_hi:[1,0,1]
    v_pk_fma_f32 v[154:155], v[102:103], v[56:57], v[154:155] op_sel_hi:[1,0,1]
    v_pk_fma_f32 v[168:169], v[104:105], v[56:57], v[168:169] op_sel_hi:[1,0,1]
    v_pk_fma_f32 v[170:171], v[106:107], v[56:57], v[170:171] op_sel_hi:[1,0,1]
    v_pk_fma_f32 v[184:185], v[108:109], v[56:57], v[184:185] op_sel_hi:[1,0,1]
    v_pk_fma_f32 v[186:187], v[110:111], v[56:57], v[186:187] op_sel_hi:[1,0,1]
    v_pk_fma_f32 v[200:201], v[112:113], v[56:57], v[200:201] op_sel_hi:[1,0,1]
    v_pk_fma_f32 v[202:203], v[114:115], v[56:57], v[202:203] op_sel_hi:[1,0,1]
    v_pk_fma_f32 v[216:217], v[116:117], v[56:57], v[216:217] op_sel_hi:[1,0,1]
    v_pk_fma_f32 v[218:219], v[118:119], v[56:57], v[218:219] op_sel_hi:[1,0,1]
    v_pk_fma_f32 v[232:233], v[120:121], v[56:57], v[232:233] op_sel_hi:[1,0,1]
    v_pk_fma_f32 v[234:235], v[122:123], v[56:57], v[234:235] op_sel_hi:[1,0,1]
    v_pk_fma_f32 v[248:249], v[124:125], v[56:57], v[248:249] op_sel_hi:[1,0,1]
    v_pk_fma_f32 v[250:251], v[126:127], v[56:57], v[250:251] op_sel_hi:[1,0,1]
    v_pk_mul_f32 v[136:137], v[136:137], v[58:59] op_sel_hi:[1,0]
    v_pk_mul_f32 v[138:139], v[138:139], v[58:59] op_sel_hi:[1,0]
    v_pk_mul_f32 v[152:153], v[152:153], v[58:59] op_sel_hi:[1,0]
    v_pk_mul_f32 v[154:155], v[154:155], v[58:59] op_sel_hi:[1,0]
    v_pk_mul_f32 v[168:169], v[168:169], v[58:59] op_sel_hi:[1,0]
    v_pk_mul_f32 v[170:171], v[170:171], v[58:59] op_sel_hi:[1,0]
    v_pk_mul_f32 v[184:185], v[184:185], v[58:59] op_sel_hi:[1,0]
    v_pk_mul_f32 v[186:187], v[186:187], v[58:59] op_sel_hi:[1,0]
    v_pk_mul_f32 v[200:201], v[200:201], v[58:59] op_sel_hi:[1,0]
    v_pk_mul_f32 v[202:203], v[202:203], v[58:59] op_sel_hi:[1,0]
    v_pk_mul_f32 v[216:217], v[216:217], v[58:59] op_sel_hi:[1,0]
    v_pk_mul_f32 v[218:219], v[218:219], v[58:59] op_sel_hi:[1,0]
    v_pk_mul_f32 v[232:233], v[232:233], v[58:59] op_sel_hi:[1,0]
    v_pk_mul_f32 v[234:235], v[234:235], v[58:59] op_sel_hi:[1,0]
    v_pk_mul_f32 v[248:249], v[248:249], v[58:59] op_sel_hi:[1,0]
    v_pk_mul_f32 v[250:251], v[250:251], v[58:59] op_sel_hi:[1,0]
    v_mfma_f32_16x16x32_bf16 v[132:135], a[64:67], a[16:19], 0
    ds_read_b64_tr_b16 a[140:141], v3 offset:288
    ds_read_b64_tr_b16 a[142:143], v3 offset:1312
    v_max_f32 v88, v128, v129
    v_cvt_pk_bf16_f32 v32, v136, v137
    v_cvt_pk_bf16_f32 v34, v152, v153
    v_max_f32 v89, v160, v161
    v_cvt_pk_bf16_f32 v33, v138, v139
    v_max3_f32 v88, v130, v131, v88
    v_mfma_f32_16x16x32_bf16 v[132:135], a[68:71], a[20:23], v[132:135]
    ds_read_b64_tr_b16 a[144:145], v3 offset:512
    ds_read_b64_tr_b16 a[146:147], v3 offset:1536
    v_cvt_pk_bf16_f32 v35, v154, v155
    v_max3_f32 v89, v162, v163, v89
    v_cvt_pk_bf16_f32 v36, v168, v169
    v_max3_f32 v88, v144, v145, v88
    v_cvt_pk_bf16_f32 v38, v184, v185
    v_mfma_f32_16x16x32_bf16 v[132:135], a[72:75], a[24:27], v[132:135]
    ds_read_b64_tr_b16 a[176:177], v3 offset:2560
    v_max3_f32 v89, v176, v177, v89
    v_cvt_pk_bf16_f32 v37, v170, v171
    v_max3_f32 v88, v146, v147, v88
    v_cvt_pk_bf16_f32 v39, v186, v187
    v_max3_f32 v89, v178, v179, v89
    v_cvt_pk_bf16_f32 v40, v200, v201
    v_mfma_f32_16x16x32_bf16 v[132:135], a[76:79], a[28:31], v[132:135]
    ds_read_b64_tr_b16 a[178:179], v3 offset:3584
    v_max_f32 v88, v88, v89
    v_cvt_pk_bf16_f32 v42, v216, v217
    v_mov_b32 v89, v88
    v_cvt_pk_bf16_f32 v41, v202, v203
    v_cvt_pk_bf16_f32 v43, v218, v219
    v_mfma_f32_16x16x32_bf16 v[148:151], a[92:95], a[28:31], 0
    ds_read_b64_tr_b16 a[180:181], v3 offset:2592
    v_permlane32_swap_b32 v88, v89
    v_cvt_pk_bf16_f32 v44, v232, v233
    v_max_f32 v88, v88, v89
    v_cvt_pk_bf16_f32 v46, v248, v249
    v_mfma_f32_16x16x32_bf16 v[148:151], a[88:91], a[24:27], v[148:151]
    ds_read_b64_tr_b16 a[182:183], v3 offset:3616
    v_mov_b32 v89, v88
    v_cvt_pk_bf16_f32 v45, v234, v235
    s_nop 0
    v_permlane16_swap_b32 v88, v89
    v_cvt_pk_bf16_f32 v47, v250, v251
    v_max_f32 v88, v88, v89
    v_mfma_f32_16x16x32_bf16 v[148:151], a[84:87], a[20:23], v[148:151]
    ds_read_b64_tr_b16 a[148:149], v3 offset:544
    v_permlane16_swap_b32 v32, v34
    v_floor_f32 v88, v88
    v_permlane16_swap_b32_e64 v33, v35
    v_mfma_f32_16x16x32_bf16 v[148:151], a[80:83], a[16:19], v[148:151]
    ds_read_b64_tr_b16 a[150:151], v3 offset:1568
    v_sub_f32 v16, -v88, s51
    v_permlane16_swap_b32 v36, v38
    v_add_f32 v128, v128, v16
    v_permlane16_swap_b32 v37, v39
    v_mfma_f32_16x16x32_bf16 v[164:167], a[96:99], a[16:19], 0
    ds_read_b64_tr_b16 a[152:153], v3 offset:768
    v_add_f32 v129, v129, v16
    v_permlane16_swap_b32 v40, v42
    v_permlane16_swap_b32 v41, v43
    v_mfma_f32_16x16x32_bf16 v[164:167], a[100:103], a[20:23], v[164:167]
    ds_read_b64_tr_b16 a[154:155], v3 offset:1792
    v_add_f32 v130, v130, v16
    v_permlane16_swap_b32 v44, v46
    v_add_f32 v131, v131, v16
    v_permlane16_swap_b32 v45, v47
    v_mfma_f32_16x16x32_bf16 v[164:167], a[104:107], a[24:27], v[164:167]
    ds_read_b64_tr_b16 a[184:185], v3 offset:2816
    v_add_f32 v144, v144, v16
    v_accvgpr_write_b32 a32, v32
    v_add_f32 v145, v145, v16
    v_accvgpr_write_b32 a33, v33
    v_add_f32_e64 v146, v146, v16
    v_mfma_f32_16x16x32_bf16 v[164:167], a[108:111], a[28:31], v[164:167]
    ds_read_b64_tr_b16 a[186:187], v3 offset:3840
    v_accvgpr_write_b32 a34, v34
    v_add_f32 v147, v147, v16
    v_accvgpr_write_b32 a35, v35
    v_add_f32 v160, v160, v16
    v_accvgpr_write_b32 a36, v36
    v_mfma_f32_16x16x32_bf16 v[180:183], a[124:127], a[28:31], 0
    ds_read_b64_tr_b16 a[188:189], v3 offset:2848
    v_add_f32 v161, v161, v16
    v_accvgpr_write_b32 a37, v37
    v_add_f32 v162, v162, v16
    v_accvgpr_write_b32 a38, v38
    v_accvgpr_write_b32 a39, v39
    v_mfma_f32_16x16x32_bf16 v[180:183], a[120:123], a[24:27], v[180:183]
    ds_read_b64_tr_b16 a[190:191], v3 offset:3872
    v_add_f32 v163, v163, v16
    v_accvgpr_write_b32 a40, v40
    v_add_f32 v176, v176, v16
    v_accvgpr_write_b32 a41, v41
    v_add_f32_e64 v177, v177, v16
    v_accvgpr_write_b32 a42, v42
    v_mfma_f32_16x16x32_bf16 v[180:183], a[116:119], a[20:23], v[180:183]
    ds_read_b64_tr_b16 a[156:157], v3 offset:800
    v_add_f32 v178, v178, v16
    v_accvgpr_write_b32 a43, v43
    v_add_f32 v179, v179, v16
    v_accvgpr_write_b32 a44, v44
    v_mov_b32_e64 v17, v16
    v_mfma_f32_16x16x32_bf16 v[180:183], a[112:115], a[16:19], v[180:183]
    ds_read_b64_tr_b16 a[158:159], v3 offset:1824
    v_accvgpr_write_b32 a45, v45
    v_mov_b32 v18, v16
    v_accvgpr_write_b32 a46, v46
    v_mov_b32 v19, v16
    v_accvgpr_write_b32 a47, v47
    v_pk_fma_f32 v[140:141], v[96:97], v[60:61], v[140:141] op_sel_hi:[1,0,1]
    v_pk_fma_f32 v[142:143], v[98:99], v[60:61], v[142:143] op_sel_hi:[1,0,1]
    v_pk_fma_f32 v[156:157], v[100:101], v[60:61], v[156:157] op_sel_hi:[1,0,1]
    v_pk_fma_f32 v[158:159], v[102:103], v[60:61], v[158:159] op_sel_hi:[1,0,1]
    v_pk_fma_f32 v[172:173], v[104:105], v[60:61], v[172:173] op_sel_hi:[1,0,1]
    v_pk_fma_f32 v[174:175], v[106:107], v[60:61], v[174:175] op_sel_hi:[1,0,1]
    v_pk_fma_f32 v[188:189], v[108:109], v[60:61], v[188:189] op_sel_hi:[1,0,1]
    v_pk_fma_f32 v[190:191], v[110:111], v[60:61], v[190:191] op_sel_hi:[1,0,1]
    v_pk_fma_f32 v[204:205], v[112:113], v[60:61], v[204:205] op_sel_hi:[1,0,1]
    v_pk_fma_f32 v[206:207], v[114:115], v[60:61], v[206:207] op_sel_hi:[1,0,1]
    v_pk_fma_f32 v[220:221], v[116:117], v[60:61], v[220:221] op_sel_hi:[1,0,1]
    v_pk_fma_f32 v[222:223], v[118:119], v[60:61], v[222:223] op_sel_hi:[1,0,1]
    v_pk_fma_f32 v[236:237], v[120:121], v[60:61], v[236:237] op_sel_hi:[1,0,1]
    v_pk_fma_f32 v[238:239], v[122:123], v[60:61], v[238:239] op_sel_hi:[1,0,1]
    v_pk_fma_f32 v[252:253], v[124:125], v[60:61], v[252:253] op_sel_hi:[1,0,1]
    v_pk_fma_f32 v[254:255], v[126:127], v[60:61], v[254:255] op_sel_hi:[1,0,1]
    v_pk_mul_f32 v[140:141], v[140:141], v[62:63] op_sel_hi:[1,0]
    v_pk_mul_f32 v[142:143], v[142:143], v[62:63] op_sel_hi:[1,0]
    v_pk_mul_f32 v[156:157], v[156:157], v[62:63] op_sel_hi:[1,0]
    v_pk_mul_f32 v[158:159], v[158:159], v[62:63] op_sel_hi:[1,0]
    v_pk_mul_f32 v[172:173], v[172:173], v[62:63] op_sel_hi:[1,0]
    v_pk_mul_f32 v[174:175], v[174:175], v[62:63] op_sel_hi:[1,0]
    v_pk_mul_f32 v[188:189], v[188:189], v[62:63] op_sel_hi:[1,0]
    v_pk_mul_f32 v[190:191], v[190:191], v[62:63] op_sel_hi:[1,0]
    v_pk_mul_f32 v[204:205], v[204:205], v[62:63] op_sel_hi:[1,0]
    v_pk_mul_f32 v[206:207], v[206:207], v[62:63] op_sel_hi:[1,0]
    v_pk_mul_f32 v[220:221], v[220:221], v[62:63] op_sel_hi:[1,0]
    v_pk_mul_f32 v[222:223], v[222:223], v[62:63] op_sel_hi:[1,0]
    v_pk_mul_f32 v[236:237], v[236:237], v[62:63] op_sel_hi:[1,0]
    v_pk_mul_f32 v[238:239], v[238:239], v[62:63] op_sel_hi:[1,0]
    v_pk_mul_f32 v[252:253], v[252:253], v[62:63] op_sel_hi:[1,0]
    v_pk_mul_f32 v[254:255], v[254:255], v[62:63] op_sel_hi:[1,0]
    s_lshl_b32 s52, s38, 5
    v_mov_b32 v90, 1
    s_waitcnt vmcnt(4) lgkmcnt(0)
    s_barrier
    buffer_atomic_add v90, v87, s[32:35], s52 offen sc1
    v_mfma_f32_16x16x32_bf16 v[136:139], a[64:67], a[32:35], 0
    s_mov_b32 s59, 32768
    s_add_u32 m0, s41, 33024
    s_nop 0
    buffer_load_dwordx4 v4, s[8:11], s59 offen offset:0 lds
    v_max_f32 v88, v132, v133
    v_exp_f32 v128, v128
    v_exp_f32 v129, v129
    v_max_f32 v89, v164, v165
    v_cvt_pk_bf16_f32 v48, v128, v129
    v_max3_f32 v88, v134, v135, v88
    v_exp_f32 v130, v130
    v_mfma_f32_16x16x32_bf16 v[136:139], a[68:71], a[36:39], v[136:139]
    v_max3_f32 v89, v166, v167, v89
    v_exp_f32 v131, v131
    v_max3_f32 v88, v148, v149, v88
    v_cvt_pk_bf16_f32 v49, v130, v131
    v_exp_f32 v144, v144
    v_max3_f32 v89, v180, v181, v89
    v_mfma_f32_16x16x32_bf16 v[136:139], a[72:75], a[40:43], v[136:139]
    buffer_load_dwordx4 v4, s[8:11], s59 offen offset:1024 lds
    v_exp_f32_e64 v145, v145
    v_max3_f32 v88, v150, v151, v88
    v_cvt_pk_bf16_f32 v50, v144, v145
    v_max3_f32 v89, v182, v183, v89
    v_exp_f32 v146, v146
    v_max_f32 v88, v88, v89
    v_exp_f32 v147, v147
    v_mfma_f32_16x16x32_bf16 v[136:139], a[76:79], a[44:47], v[136:139]
    v_cvt_pk_bf16_f32 v51, v146, v147
    v_mov_b32 v89, v88
    v_exp_f32 v160, v160
    s_nop 0
    v_permlane32_swap_b32 v88, v89
    v_exp_f32 v161, v161
    v_mfma_f32_16x16x32_bf16 v[152:155], a[92:95], a[44:47], 0
    buffer_load_dwordx4 v4, s[8:11], s59 offen offset:2048 lds
    v_max_f32 v88, v88, v89
    v_cvt_pk_bf16_f32 v52, v160, v161
    v_mov_b32 v89, v88
    v_exp_f32 v162, v162
    s_nop 0
    v_permlane16_swap_b32 v88, v89
    v_exp_f32 v163, v163
    v_mfma_f32_16x16x32_bf16 v[152:155], a[88:91], a[40:43], v[152:155]
    v_cvt_pk_bf16_f32 v53, v162, v163
    v_max_f32 v88, v88, v89
    v_exp_f32 v176, v176
    v_floor_f32 v88, v88
    v_exp_f32 v177, v177
    v_sub_f32 v20, -v88, s51
    v_cvt_pk_bf16_f32 v54, v176, v177
    v_mfma_f32_16x16x32_bf16 v[152:155], a[84:87], a[36:39], v[152:155]
    buffer_load_dwordx4 v4, s[8:11], s59 offen offset:3072 lds
    v_add_f32 v132, v132, v20
    v_exp_f32 v178, v178
    v_exp_f32 v179, v179
    v_add_f32 v133, v133, v20
    v_cvt_pk_bf16_f32 v55, v178, v179
    v_add_f32 v134, v134, v20
    v_cvt_pk_bf16_f32 v32, v140, v141
    v_mfma_f32_16x16x32_bf16 v[152:155], a[80:83], a[32:35], v[152:155]
    v_add_f32 v135, v135, v20
    v_cvt_pk_bf16_f32 v34, v156, v157
    v_add_f32 v148, v148, v20
    v_cvt_pk_bf16_f32 v33, v142, v143
    v_cvt_pk_bf16_f32 v35, v158, v159
    v_add_f32 v149, v149, v20
    v_cvt_pk_bf16_f32 v36, v172, v173
    v_add_f32_e64 v150, v150, v20
    v_mfma_f32_16x16x32_bf16 v[168:171], a[96:99], a[32:35], 0
    s_mov_b32 s59, 49152
    s_add_u32 m0, s40, 49248
    s_nop 0
    buffer_load_dwordx4 v4, s[4:7], s59 offen offset:0 lds
    v_cvt_pk_bf16_f32 v38, v188, v189
    v_add_f32 v151, v151, v20
    v_cvt_pk_bf16_f32 v37, v174, v175
    v_add_f32 v164, v164, v20
    v_cvt_pk_bf16_f32 v39, v190, v191
    v_add_f32 v165, v165, v20
    v_cvt_pk_bf16_f32 v40, v204, v205
    v_cvt_pk_bf16_f32 v42, v220, v221
    v_add_f32 v166, v166, v20
    v_mfma_f32_16x16x32_bf16 v[168:171], a[100:103], a[36:39], v[168:171]
    v_cvt_pk_bf16_f32 v41, v206, v207
    v_add_f32 v167, v167, v20
    v_cvt_pk_bf16_f32 v43, v222, v223
    v_add_f32 v180, v180, v20
    v_cvt_pk_bf16_f32 v44, v236, v237
    v_add_f32 v181, v181, v20
    v_cvt_pk_bf16_f32 v46, v252, v253
    v_cvt_pk_bf16_f32 v45, v238, v239
    v_add_f32_e64 v182, v182, v20
    v_mfma_f32_16x16x32_bf16 v[168:171], a[104:107], a[40:43], v[168:171]
    buffer_load_dwordx4 v4, s[4:7], s59 offen offset:1024 lds
    v_cvt_pk_bf16_f32 v47, v254, v255
    v_add_f32 v183, v183, v20
    v_permlane16_swap_b32 v32, v34
    v_mov_b32 v21, v20
    v_permlane16_swap_b32 v33, v35
    v_mov_b32 v22, v20
    v_permlane16_swap_b32 v36, v38
    v_mfma_f32_16x16x32_bf16 v[168:171], a[108:111], a[44:47], v[168:171]
    v_permlane16_swap_b32 v37, v39
    v_mov_b32 v23, v20
    v_permlane16_swap_b32 v40, v42
    s_waitcnt vmcnt(10)
    v_lshlrev_b32 v64, 16, v72
    v_permlane16_swap_b32 v41, v43
    v_mfma_f32_16x16x32_bf16 v[184:187], a[124:127], a[44:47], 0
    v_and_b32 v65, 0xffff0000, v72
    v_permlane16_swap_b32 v44, v46
    v_lshlrev_b32 v66, 16, v73
    v_permlane16_swap_b32_e64 v45, v47
    v_and_b32 v67, 0xffff0000, v73
    v_accvgpr_write_b32 a48, v32
    v_accvgpr_write_b32 a49, v33
    v_mfma_f32_16x16x32_bf16 v[184:187], a[120:123], a[40:43], v[184:187]
    s_waitcnt vmcnt(9)
    v_lshlrev_b32 v68, 16, v74
    v_accvgpr_write_b32 a50, v34
    v_and_b32 v69, 0xffff0000, v74
    v_accvgpr_write_b32 a51, v35
    v_lshlrev_b32_e64 v70, 16, v75
    v_accvgpr_write_b32 a52, v36
    v_and_b32 v71, 0xffff0000, v75
    v_accvgpr_write_b32 a53, v37
    v_accvgpr_write_b32 a54, v38
    v_mfma_f32_16x16x32_bf16 v[184:187], a[116:119], a[36:39], v[184:187]
    s_waitcnt vmcnt(8)
    v_lshlrev_b32 v72, 16, v76
    v_accvgpr_write_b32 a55, v39
    v_and_b32 v73, 0xffff0000, v76
    v_accvgpr_write_b32 a56, v40
    v_lshlrev_b32_e64 v74, 16, v77
    v_accvgpr_write_b32 a57, v41
    v_and_b32 v75, 0xffff0000, v77
    v_accvgpr_write_b32 a58, v42
    v_accvgpr_write_b32 a59, v43
    v_mfma_f32_16x16x32_bf16 v[184:187], a[112:115], a[32:35], v[184:187]
    s_waitcnt vmcnt(7)
    v_lshlrev_b32 v76, 16, v78
    v_accvgpr_write_b32 a60, v44
    v_and_b32 v77, 0xffff0000, v78
    v_accvgpr_write_b32 a61, v45
    v_lshlrev_b32_e64 v78, 16, v79
    v_accvgpr_write_b32 a62, v46
    v_and_b32 v79, 0xffff0000, v79
    v_accvgpr_write_b32 a63, v47
    v_mfma_f32_16x16x32_bf16 v[140:143], a[64:67], a[48:51], 0
    buffer_load_dwordx4 v4, s[4:7], s59 offen offset:2048 lds
    v_mov_b32 v112, 0
    v_exp_f32 v132, v132
    v_mfma_f32_16x16x32_bf16 v[140:143], a[68:71], a[52:55], v[140:143]
    v_mov_b32 v113, 0
    v_mov_b32 v114, 0
    v_exp_f32 v133, v133
    v_mfma_f32_16x16x32_bf16 v[140:143], a[72:75], a[56:59], v[140:143]
    v_mov_b32 v115, 0
    v_mov_b32 v116, 0
    v_mfma_f32_16x16x32_bf16 v[140:143], a[76:79], a[60:63], v[140:143]
    v_cvt_pk_bf16_f32 v56, v132, v133
    v_mov_b32 v117, 0
    v_mov_b32 v118, 0
    v_mfma_f32_16x16x32_bf16 v[156:159], a[92:95], a[60:63], 0
    buffer_load_dwordx4 v4, s[4:7], s59 offen offset:3072 lds
    v_exp_f32 v134, v134
    v_mov_b32 v119, 0
    v_mfma_f32_16x16x32_bf16 v[156:159], a[88:91], a[56:59], v[156:159]
    v_mov_b32 v120, 0
    v_exp_f32 v135, v135
    v_mfma_f32_16x16x32_bf16 v[156:159], a[84:87], a[52:55], v[156:159]
    v_mov_b32 v121, 0
    v_mov_b32 v122, 0
    v_mfma_f32_16x16x32_bf16 v[156:159], a[80:83], a[48:51], v[156:159]
    v_cvt_pk_bf16_f32 v57, v134, v135
    v_mov_b32 v123, 0
    v_mov_b32_e64 v124, 0
    v_mfma_f32_16x16x32_bf16 v[172:175], a[96:99], a[48:51], 0
    s_mov_b32 s59, 49152
    s_add_u32 m0, s41, 49536
    s_nop 0
    buffer_load_dwordx4 v4, s[8:11], s59 offen offset:0 lds
    v_mov_b32 v125, 0
    v_exp_f32 v148, v148
    v_mfma_f32_16x16x32_bf16 v[172:175], a[100:103], a[52:55], v[172:175]
    v_mov_b32 v126, 0
    v_mov_b32 v127, 0
    v_exp_f32 v149, v149
    v_mfma_f32_16x16x32_bf16 v[172:175], a[104:107], a[56:59], v[172:175]
    v_max_f32 v88, v136, v137
    v_max_f32 v89, v168, v169
    v_mfma_f32_16x16x32_bf16 v[172:175], a[108:111], a[60:63], v[172:175]
    v_cvt_pk_bf16_f32 v58, v148, v149
    v_max3_f32 v88, v138, v139, v88
    v_max3_f32 v89, v170, v171, v89
    v_mfma_f32_16x16x32_bf16 v[188:191], a[124:127], a[60:63], 0
    buffer_load_dwordx4 v4, s[8:11], s59 offen offset:1024 lds
    v_exp_f32_e64 v150, v150
    v_max3_f32 v88, v152, v153, v88
    v_mfma_f32_16x16x32_bf16 v[188:191], a[120:123], a[56:59], v[188:191]
    v_max3_f32 v89, v184, v185, v89
    v_exp_f32_e64 v151, v151
    v_mfma_f32_16x16x32_bf16 v[188:191], a[116:119], a[52:55], v[188:191]
    v_max3_f32 v88, v154, v155, v88
    v_max3_f32 v89, v186, v187, v89
    v_mfma_f32_16x16x32_bf16 v[188:191], a[112:115], a[48:51], v[188:191]
    v_cvt_pk_bf16_f32 v59, v150, v151
    v_max_f32 v88, v88, v89
    v_mov_b32 v89, v88
    v_smfmac_f32_16x16x64_bf16 a[192:195], v[8:11], v[48:55], v5
    buffer_load_dwordx4 v4, s[8:11], s59 offen offset:2048 lds
    v_permlane32_swap_b32 v88, v89
    v_exp_f32 v164, v164
    v_mfma_f32_16x16x32_bf16 v[128:131], a[128:131], v[48:51], 0
    v_max_f32 v88, v88, v89
    v_mov_b32 v89, v88
    v_mfma_f32_16x16x32_bf16 v[128:131], a[160:163], v[52:55], v[128:131]
    v_exp_f32 v165, v165
    v_permlane16_swap_b32 v88, v89
    v_mfma_f32_16x16x32_bf16 v[144:147], a[164:167], v[52:55], 0
    v_max_f32_e64 v88, v88, v89
    v_mfma_f32_16x16x32_bf16 v[144:147], a[132:135], v[48:51], v[144:147]
    buffer_load_dwordx4 v4, s[8:11], s59 offen offset:3072 lds
    v_cvt_pk_bf16_f32 v60, v164, v165
    v_floor_f32 v88, v88
    v_sub_f32 v24, -v88, s51
    v_mfma_f32_16x16x32_bf16 v[160:163], a[136:139], v[48:51], 0
    v_exp_f32 v166, v166
    v_add_f32 v136, v136, v24
    v_mfma_f32_16x16x32_bf16 v[160:163], a[168:171], v[52:55], v[160:163]
    v_add_f32 v137, v137, v24
    v_exp_f32 v167, v167
    v_mfma_f32_16x16x32_bf16 v[176:179], a[172:175], v[52:55], 0
    v_add_f32 v138, v138, v24
    v_add_f32 v139, v139, v24
    v_cvt_pk_bf16_f32 v61, v166, v167
    v_mfma_f32_16x16x32_bf16 v[176:179], a[140:143], v[48:51], v[176:179]
    v_add_f32 v152, v152, v24
    v_add_f32 v153, v153, v24
    v_add_f32 v154, v154, v24
    v_mfma_f32_16x16x32_bf16 v[192:195], a[144:147], v[48:51], 0
    v_exp_f32 v180, v180
    v_add_f32 v155, v155, v24
    v_mfma_f32_16x16x32_bf16 v[192:195], a[176:179], v[52:55], v[192:195]
    v_add_f32 v168, v168, v24
    v_exp_f32 v181, v181
    v_mfma_f32_16x16x32_bf16 v[208:211], a[180:183], v[52:55], 0
    v_add_f32 v169, v169, v24
    v_add_f32 v170, v170, v24
    v_mfma_f32_16x16x32_bf16 v[208:211], a[148:151], v[48:51], v[208:211]
    v_cvt_pk_bf16_f32 v62, v180, v181
    v_add_f32 v171, v171, v24
    v_add_f32 v184, v184, v24
    v_mfma_f32_16x16x32_bf16 v[224:227], a[152:155], v[48:51], 0
    v_exp_f32 v182, v182
    v_add_f32 v185, v185, v24
    v_mfma_f32_16x16x32_bf16 v[224:227], a[184:187], v[52:55], v[224:227]
    v_add_f32 v186, v186, v24
    v_exp_f32 v183, v183
    v_mfma_f32_16x16x32_bf16 v[240:243], a[188:191], v[52:55], 0
    v_add_f32 v187, v187, v24
    v_mov_b32 v25, v24
    v_cvt_pk_bf16_f32 v63, v182, v183
    v_mfma_f32_16x16x32_bf16 v[240:243], a[156:159], v[48:51], v[240:243]
    v_mov_b32 v26, v24
    v_mov_b32 v27, v24
    v_smfmac_f32_16x16x64_bf16 a[196:199], v[8:11], v[56:63], v5
    ds_read_b64_tr_b16 v[96:97], v3 offset:16512
    v_max_f32 v88, v140, v141
    v_exp_f32 v136, v136
    v_max_f32 v89, v172, v173
    v_exp_f32 v137, v137
    v_mfma_f32_16x16x32_bf16 v[132:135], a[128:131], v[56:59], 0
    ds_read_b64_tr_b16 v[98:99], v3 offset:17536
    v_max3_f32 v88, v142, v143, v88
    v_max3_f32 v89, v174, v175, v89
    v_cvt_pk_bf16_f32 v48, v136, v137
    v_max3_f32 v88, v156, v157, v88
    v_mfma_f32_16x16x32_bf16 v[132:135], a[160:163], v[60:63], v[132:135]
    ds_read_b64_tr_b16 v[104:105], v3 offset:18560
    v_exp_f32_e64 v138, v138
    v_max3_f32 v89, v188, v189, v89
    v_max3_f32 v88, v158, v159, v88
    v_mfma_f32_16x16x32_bf16 v[148:151], a[164:167], v[60:63], 0
    ds_read_b64_tr_b16 v[106:107], v3 offset:19584
    v_exp_f32 v139, v139
    v_max3_f32 v89, v190, v191, v89
    v_cvt_pk_bf16_f32 v49, v138, v139
    v_max_f32 v88, v88, v89
    v_mfma_f32_16x16x32_bf16 v[148:151], a[132:135], v[56:59], v[148:151]
    ds_read_b64_tr_b16 v[108:109], v3 offset:18592
    v_mov_b32 v89, v88
    v_exp_f32 v152, v152
    s_nop 0
    v_permlane32_swap_b32 v88, v89
    v_mfma_f32_16x16x32_bf16 v[164:167], a[136:139], v[56:59], 0
    ds_read_b128 a[64:67], v2 offset:16416
    v_exp_f32 v153, v153
    v_max_f32 v88, v88, v89
    v_mov_b32_e64 v89, v88
    v_mfma_f32_16x16x32_bf16 v[164:167], a[168:171], v[60:63], v[164:167]
    ds_read_b128 a[68:71], v2 offset:16672
    v_cvt_pk_bf16_f32 v50, v152, v153
    v_permlane16_swap_b32 v88, v89
    v_exp_f32 v154, v154
    v_mfma_f32_16x16x32_bf16 v[180:183], a[172:175], v[60:63], 0
    ds_read_b128 a[72:75], v2 offset:16928
    v_max_f32 v88, v88, v89
    v_floor_f32 v88, v88
    v_exp_f32_e64 v155, v155
    v_mfma_f32_16x16x32_bf16 v[180:183], a[140:143], v[56:59], v[180:183]
    ds_read_b128 a[76:79], v2 offset:17184
    v_sub_f32 v28, -v88, s51
    v_cvt_pk_bf16_f32 v51, v154, v155
    v_add_f32 v140, v140, v28
    v_add_f32 v141, v141, v28
    v_exp_f32 v168, v168
    v_mfma_f32_16x16x32_bf16 v[196:199], a[144:147], v[56:59], 0
    ds_read_b128 a[92:95], v2 offset:18208
    v_add_f32 v142, v142, v28
    v_exp_f32 v169, v169
    v_mfma_f32_16x16x32_bf16 v[196:199], a[176:179], v[60:63], v[196:199]
    ds_read_b128 a[88:91], v2 offset:17952
    v_add_f32 v143, v143, v28
    v_add_f32 v156, v156, v28
    v_cvt_pk_bf16_f32 v52, v168, v169
    v_add_f32 v157, v157, v28
    v_exp_f32 v170, v170
    v_mfma_f32_16x16x32_bf16 v[212:215], a[180:183], v[60:63], 0
    s_lshl_b32 s56, s2, 2
    s_add_u32 s56, s56, s36
    s_lshl_b32 s57, s56, 5
    s_sub_u32 s57, s57, s49
    v_lshrrev_b32 v91, 1, v0
    v_add_lshl_u32 v91, v91, s57, 7
    buffer_load_dword v92, v91, s[60:63], 0 offen
    v_add_f32 v158, v158, v28
    v_add_f32 v159, v159, v28
    v_exp_f32 v171, v171
    v_mfma_f32_16x16x32_bf16 v[212:215], a[148:151], v[56:59], v[212:215]
    v_add_f32 v172, v172, v28
    v_cvt_pk_bf16_f32 v53, v170, v171
    v_add_f32 v173, v173, v28
    v_add_f32 v174, v174, v28
    v_mfma_f32_16x16x32_bf16 v[228:231], a[152:155], v[56:59], 0
    v_exp_f32 v184, v184
    v_add_f32 v175, v175, v28
    v_exp_f32 v185, v185
    v_mfma_f32_16x16x32_bf16 v[228:231], a[184:187], v[60:63], v[228:231]
    v_add_f32 v188, v188, v28
    v_add_f32 v189, v189, v28
    v_cvt_pk_bf16_f32 v54, v184, v185
    v_add_f32 v190, v190, v28
    v_mfma_f32_16x16x32_bf16 v[244:247], a[188:191], v[60:63], 0
    v_exp_f32 v186, v186
    v_add_f32 v191, v191, v28
    v_mov_b32 v29, v28
    v_exp_f32 v187, v187
    v_mfma_f32_16x16x32_bf16 v[244:247], a[156:159], v[56:59], v[244:247]
    v_mov_b32 v30, v28
    v_cvt_pk_bf16_f32 v55, v186, v187
    v_mov_b32 v31, v28
    s_nop 0
    v_smfmac_f32_16x16x64_bf16 a[200:203], v[8:11], v[48:55], v5
    ds_read_b128 a[84:87], v2 offset:17696
    v_lshrrev_b32 v7, 3, v0
    v_lshl_add_u32 v7, s36, 4, v7
    v_and_b32 v6, 7, v0
    v_mfma_f32_16x16x32_bf16 v[136:139], a[128:131], v[48:51], 0
    ds_read_b128 a[80:83], v2 offset:17440
    v_lshlrev_b32 v6, 4, v6
    v_lshl_add_u32 v7, v7, 10, v6
    v_mfma_f32_16x16x32_bf16 v[136:139], a[160:163], v[52:55], v[136:139]
    ds_read_b128 a[96:99], v2 offset:18464
    v_exp_f32 v140, v140
    v_mfma_f32_16x16x32_bf16 v[152:155], a[164:167], v[52:55], 0
    ds_read_b128 a[100:103], v2 offset:18720
    v_exp_f32 v141, v141
    v_mfma_f32_16x16x32_bf16 v[152:155], a[132:135], v[48:51], v[152:155]
    ds_read_b128 a[104:107], v2 offset:18976
    v_cvt_pk_bf16_f32 v56, v140, v141
    v_exp_f32 v142, v142
    v_mfma_f32_16x16x32_bf16 v[168:171], a[136:139], v[48:51], 0
    ds_read_b128 a[108:111], v2 offset:19232
    v_exp_f32 v143, v143
    v_mfma_f32_16x16x32_bf16 v[168:171], a[168:171], v[52:55], v[168:171]
    ds_read_b128 a[124:127], v2 offset:20256
    v_cvt_pk_bf16_f32 v57, v142, v143
    v_mfma_f32_16x16x32_bf16 v[184:187], a[172:175], v[52:55], 0
    ds_read_b128 a[120:123], v2 offset:20000
    v_exp_f32 v156, v156
    v_mfma_f32_16x16x32_bf16 v[184:187], a[140:143], v[48:51], v[184:187]
    ds_read_b128 a[116:119], v2 offset:19744
    v_exp_f32 v157, v157
    v_mfma_f32_16x16x32_bf16 v[200:203], a[144:147], v[48:51], 0
    ds_read_b128 a[112:115], v2 offset:19488
    v_cvt_pk_bf16_f32 v58, v156, v157
    v_exp_f32 v158, v158
    v_mfma_f32_16x16x32_bf16 v[200:203], a[176:179], v[52:55], v[200:203]
    ds_read_b64_tr_b16 v[110:111], v3 offset:19616
    v_exp_f32 v159, v159
    v_mfma_f32_16x16x32_bf16 v[216:219], a[180:183], v[52:55], 0
    v_cvt_pk_bf16_f32 v59, v158, v159
    v_mfma_f32_16x16x32_bf16 v[216:219], a[148:151], v[48:51], v[216:219]
    v_exp_f32 v172, v172
    v_mfma_f32_16x16x32_bf16 v[232:235], a[152:155], v[48:51], 0
    v_exp_f32 v173, v173
    v_mfma_f32_16x16x32_bf16 v[232:235], a[184:187], v[52:55], v[232:235]
    v_cvt_pk_bf16_f32 v60, v172, v173
    v_exp_f32 v174, v174
    v_mfma_f32_16x16x32_bf16 v[248:251], a[188:191], v[52:55], 0
    v_exp_f32 v175, v175
    v_mfma_f32_16x16x32_bf16 v[248:251], a[156:159], v[48:51], v[248:251]
L_hop4:
    s_cbranch_execz L_hop_back
    v_cvt_pk_bf16_f32 v61, v174, v175
L_attn:
    s_waitcnt lgkmcnt(1)
    v_mfma_f32_16x16x32_bf16 v[32:35], a[64:67], a[0:3], v[16:19]
    v_exp_f32_e64 v188, v188
    v_mfma_f32_16x16x32_bf16 v[32:35], a[68:71], a[4:7], v[32:35]
    global_load_dword v6, v94, s[90:91]
    v_mfma_f32_16x16x32_bf16 v[32:35], a[72:75], a[8:11], v[32:35]
    v_exp_f32_e64 v189, v189
    v_mfma_f32_16x16x32_bf16 v[32:35], a[76:79], a[12:15], v[32:35]
    ds_read_b64_tr_b16 a[208:209], v14 offset:0
    v_cvt_pk_bf16_f32 v62, v188, v189
    v_mfma_f32_16x16x32_bf16 v[36:39], a[92:95], a[12:15], v[16:19]
    v_exp_f32_e64 v190, v190
    v_mfma_f32_16x16x32_bf16 v[36:39], a[88:91], a[8:11], v[36:39]
    ds_read_b64_tr_b16 a[210:211], v14 offset:2048
    v_mfma_f32_16x16x32_bf16 v[36:39], a[84:87], a[4:7], v[36:39]
    v_exp_f32_e64 v191, v191
    v_mfma_f32_16x16x32_bf16 v[36:39], a[80:83], a[0:3], v[36:39]
    ds_read_b64_tr_b16 a[212:213], v15 offset:0
    v_cvt_pk_bf16_f32 v63, v190, v191
    v_mfma_f32_16x16x32_bf16 v[40:43], a[96:99], a[0:3], v[16:19]
    v_exp_f32_e64 v32, v32
    v_mfma_f32_16x16x32_bf16 v[40:43], a[100:103], a[4:7], v[40:43]
    ds_read_b64_tr_b16 a[214:215], v15 offset:2048
    v_mfma_f32_16x16x32_bf16 v[40:43], a[104:107], a[8:11], v[40:43]
    v_exp_f32_e64 v33, v33
    v_mfma_f32_16x16x32_bf16 v[40:43], a[108:111], a[12:15], v[40:43]
    ds_read_b64_tr_b16 v[100:101], v3 offset:16544
    v_cvt_pk_bf16_f32 v48, v32, v33
    v_mfma_f32_16x16x32_bf16 v[44:47], a[124:127], a[12:15], v[16:19]
    v_exp_f32_e64 v34, v34
    v_mfma_f32_16x16x32_bf16 v[44:47], a[120:123], a[8:11], v[44:47]
    ds_read_b64_tr_b16 v[102:103], v3 offset:17568
    v_mfma_f32_16x16x32_bf16 v[44:47], a[116:119], a[4:7], v[44:47]
    v_exp_f32_e64 v35, v35
    v_mfma_f32_16x16x32_bf16 v[44:47], a[112:115], a[0:3], v[44:47]
    ds_read_b64_tr_b16 a[216:217], v14 offset:512
    v_cvt_pk_bf16_f32 v49, v34, v35
    v_smfmac_f32_16x16x64_bf16 a[204:207], v[8:11], v[56:63], v5
    ds_read_b64_tr_b16 a[218:219], v14 offset:2560
    v_mfma_f32_16x16x32_bf16 v[140:143], a[128:131], v[56:59], 0
    v_exp_f32_e64 v36, v36
    v_mfma_f32_16x16x32_bf16 v[140:143], a[160:163], v[60:63], v[140:143]
    ds_read_b64_tr_b16 a[220:221], v15 offset:512
    v_mfma_f32_16x16x32_bf16 v[156:159], a[164:167], v[60:63], 0
    v_exp_f32_e64 v37, v37
    v_mfma_f32_16x16x32_bf16 v[156:159], a[132:135], v[56:59], v[156:159]
    ds_read_b64_tr_b16 a[222:223], v15 offset:2560
    v_cvt_pk_bf16_f32 v50, v36, v37
    v_mfma_f32_16x16x32_bf16 v[172:175], a[136:139], v[56:59], 0
    v_exp_f32_e64 v38, v38
    v_mfma_f32_16x16x32_bf16 v[172:175], a[168:171], v[60:63], v[172:175]
    ds_read_b64_tr_b16 a[136:137], v3 offset:16768
    v_mfma_f32_16x16x32_bf16 v[188:191], a[172:175], v[60:63], 0
    v_exp_f32_e64 v39, v39
    v_mfma_f32_16x16x32_bf16 v[188:191], a[140:143], v[56:59], v[188:191]
    ds_read_b64_tr_b16 a[138:139], v3 offset:17792
    v_cvt_pk_bf16_f32 v51, v38, v39
    v_mfma_f32_16x16x32_bf16 v[204:207], a[144:147], v[56:59], 0
    v_exp_f32_e64 v40, v40
    v_mfma_f32_16x16x32_bf16 v[204:207], a[176:179], v[60:63], v[204:207]
    ds_read_b64_tr_b16 a[168:169], v3 offset:18816
    v_mfma_f32_16x16x32_bf16 v[220:223], a[180:183], v[60:63], 0
    v_exp_f32_e64 v41, v41
    v_mfma_f32_16x16x32_bf16 v[220:223], a[148:151], v[56:59], v[220:223]
    ds_read_b64_tr_b16 a[170:171], v3 offset:19840
    v_cvt_pk_bf16_f32 v52, v40, v41
    v_mfma_f32_16x16x32_bf16 v[236:239], a[152:155], v[56:59], 0
    v_exp_f32_e64 v42, v42
    v_mfma_f32_16x16x32_bf16 v[236:239], a[184:187], v[60:63], v[236:239]
    ds_read_b64_tr_b16 a[172:173], v3 offset:18848
    v_mfma_f32_16x16x32_bf16 v[252:255], a[188:191], v[60:63], 0
    v_exp_f32_e64 v43, v43
    v_mfma_f32_16x16x32_bf16 v[252:255], a[156:159], v[56:59], v[252:255]
    ds_read_b64_tr_b16 a[174:175], v3 offset:19872
    v_cvt_pk_bf16_f32 v53, v42, v43
L_loop:
    v_mfma_f32_16x16x32_bf16 v[32:35], a[64:67], a[16:19], v[20:23]
    ds_read_b64_tr_b16 a[156:157], v3 offset:17312
    v_exp_f32_e64 v44, v44
    v_mfma_f32_16x16x32_bf16 v[32:35], a[68:71], a[20:23], v[32:35]
    ds_read_b64_tr_b16 a[140:141], v3 offset:16800
    v_mfma_f32_16x16x32_bf16 v[32:35], a[72:75], a[24:27], v[32:35]
    v_exp_f32_e64 v45, v45
    v_mfma_f32_16x16x32_bf16 v[32:35], a[76:79], a[28:31], v[32:35]
    ds_read_b64_tr_b16 a[142:143], v3 offset:17824
    v_cvt_pk_bf16_f32 v54, v44, v45
    v_mfma_f32_16x16x32_bf16 v[36:39], a[92:95], a[28:31], v[20:23]
    v_exp_f32_e64 v46, v46
    v_mfma_f32_16x16x32_bf16 v[36:39], a[88:91], a[24:27], v[36:39]
    ds_read_b64_tr_b16 a[144:145], v3 offset:17024
    v_mfma_f32_16x16x32_bf16 v[36:39], a[84:87], a[20:23], v[36:39]
    v_exp_f32_e64 v47, v47
    v_mfma_f32_16x16x32_bf16 v[36:39], a[80:83], a[16:19], v[36:39]
    ds_read_b64_tr_b16 a[146:147], v3 offset:18048
    v_cvt_pk_bf16_f32 v55, v46, v47
    v_mfma_f32_16x16x32_bf16 v[40:43], a[96:99], a[16:19], v[20:23]
    v_exp_f32_e64 v32, v32
    v_mfma_f32_16x16x32_bf16 v[40:43], a[100:103], a[20:23], v[40:43]
    ds_read_b64_tr_b16 a[176:177], v3 offset:19072
    v_mfma_f32_16x16x32_bf16 v[40:43], a[104:107], a[24:27], v[40:43]
    v_exp_f32_e64 v33, v33
    v_mfma_f32_16x16x32_bf16 v[40:43], a[108:111], a[28:31], v[40:43]
    ds_read_b64_tr_b16 a[178:179], v3 offset:20096
    v_cvt_pk_bf16_f32 v56, v32, v33
    v_mfma_f32_16x16x32_bf16 v[44:47], a[124:127], a[28:31], v[20:23]
    v_exp_f32_e64 v34, v34
    v_mfma_f32_16x16x32_bf16 v[44:47], a[120:123], a[24:27], v[44:47]
    ds_read_b64_tr_b16 a[180:181], v3 offset:19104
    v_mfma_f32_16x16x32_bf16 v[44:47], a[116:119], a[20:23], v[44:47]
    v_exp_f32_e64 v35, v35
    v_mfma_f32_16x16x32_bf16 v[44:47], a[112:115], a[16:19], v[44:47]
    ds_read_b64_tr_b16 a[182:183], v3 offset:20128
    v_cvt_pk_bf16_f32 v57, v34, v35
    v_smfmac_f32_16x16x64_bf16 a[192:195], v[8:11], v[48:55], v5
    s_waitcnt vmcnt(10) lgkmcnt(3)
    ds_read_b64_tr_b16 a[148:149], v3 offset:17056
    v_mfma_f32_16x16x32_bf16 v[64:67], a[208:211], a[224:227], v[64:67]
    s_waitcnt vmcnt(9)
    ds_read_b64_tr_b16 a[150:151], v3 offset:18080
    v_mfma_f32_16x16x32_bf16 v[112:115], a[208:211], a[228:231], v[112:115]
    s_waitcnt lgkmcnt(4)
    ds_read_b64_tr_b16 a[152:153], v3 offset:17280
    v_mfma_f32_16x16x32_bf16 v[116:119], a[212:215], a[228:231], v[116:119]
    ds_read_b64_tr_b16 a[154:155], v3 offset:18304
    v_mfma_f32_16x16x32_bf16 v[68:71], a[212:215], a[224:227], v[68:71]
    ds_read_b64_tr_b16 a[184:185], v3 offset:19328
    v_mfma_f32_16x16x32_bf16 v[128:131], v[96:99], v[48:51], v[128:131]
    v_exp_f32 v36, v36
    v_mfma_f32_16x16x32_bf16 v[128:131], v[104:107], v[52:55], v[128:131]
    ds_read_b64_tr_b16 a[186:187], v3 offset:20352
    v_mfma_f32_16x16x32_bf16 v[144:147], v[108:111], v[52:55], v[144:147]
    v_exp_f32_e64 v37, v37
    v_mfma_f32_16x16x32_bf16 v[144:147], v[100:103], v[48:51], v[144:147]
    ds_read_b64_tr_b16 a[188:189], v3 offset:19360
    v_cvt_pk_bf16_f32 v58, v36, v37
    v_mfma_f32_16x16x32_bf16 v[160:163], a[136:139], v[48:51], v[160:163]
    v_exp_f32_e64 v38, v38
    v_mfma_f32_16x16x32_bf16 v[160:163], a[168:171], v[52:55], v[160:163]
    ds_read_b64_tr_b16 a[190:191], v3 offset:20384
    v_mfma_f32_16x16x32_bf16 v[176:179], a[172:175], v[52:55], v[176:179]
    v_exp_f32_e64 v39, v39
    v_mfma_f32_16x16x32_bf16 v[176:179], a[140:143], v[48:51], v[176:179]
    ds_read_b64_tr_b16 a[158:159], v3 offset:18336
    v_cvt_pk_bf16_f32 v59, v38, v39
    v_mfma_f32_16x16x32_bf16 v[192:195], a[144:147], v[48:51], v[192:195]
    s_lshl_b32 s59, s3, 5
    v_exp_f32 v40, v40
    v_mfma_f32_16x16x32_bf16 v[192:195], a[176:179], v[52:55], v[192:195]
    s_waitcnt lgkmcnt(3)
    buffer_load_dword v1, off, s[32:35], s59 sc1
    v_mfma_f32_16x16x32_bf16 v[208:211], a[180:183], v[52:55], v[208:211]
    v_exp_f32 v41, v41
    v_mfma_f32_16x16x32_bf16 v[208:211], a[148:151], v[48:51], v[208:211]
    s_add_u32 s42, s42, 0x4000
    v_cvt_pk_bf16_f32 v60, v40, v41
    v_mfma_f32_16x16x32_bf16 v[224:227], a[152:155], v[48:51], v[224:227]
    s_add_u32 m0, s40, 0
    v_exp_f32 v42, v42
    v_mfma_f32_16x16x32_bf16 v[224:227], a[184:187], v[52:55], v[224:227]
    s_waitcnt lgkmcnt(1)
    buffer_load_dwordx4 v4, s[4:7], s42 offen offset:0 nt lds
    v_mfma_f32_16x16x32_bf16 v[240:243], a[188:191], v[52:55], v[240:243]
    s_waitcnt lgkmcnt(0)
    s_bitcmp1_b32 s93, s43
    v_exp_f32 v43, v43
    v_mfma_f32_16x16x32_bf16 v[240:243], a[156:159], v[48:51], v[240:243]
    v_cvt_pk_bf16_f32 v61, v42, v43
    s_cbranch_scc1 L_rc_a
L_rc_a_back:
    v_mfma_f32_16x16x32_bf16 v[32:35], a[64:67], a[32:35], v[24:27]
    v_exp_f32 v44, v44
    v_mfma_f32_16x16x32_bf16 v[32:35], a[68:71], a[36:39], v[32:35]
    buffer_load_dwordx4 v4, s[4:7], s42 offen offset:1024 nt lds
    v_mfma_f32_16x16x32_bf16 v[32:35], a[72:75], a[40:43], v[32:35]
    v_exp_f32_e64 v45, v45
    v_mfma_f32_16x16x32_bf16 v[32:35], a[76:79], a[44:47], v[32:35]
    v_cvt_pk_bf16_f32 v62, v44, v45
    v_mfma_f32_16x16x32_bf16 v[36:39], a[92:95], a[44:47], v[24:27]
    v_exp_f32_e64 v46, v46
    v_mfma_f32_16x16x32_bf16 v[36:39], a[88:91], a[40:43], v[36:39]
    buffer_load_dwordx4 v4, s[4:7], s42 offen offset:2048 nt lds
    v_mfma_f32_16x16x32_bf16 v[36:39], a[84:87], a[36:39], v[36:39]
    v_exp_f32_e64 v47, v47
    v_mfma_f32_16x16x32_bf16 v[36:39], a[80:83], a[32:35], v[36:39]
    v_cvt_pk_bf16_f32 v63, v46, v47
    v_mfma_f32_16x16x32_bf16 v[40:43], a[96:99], a[32:35], v[24:27]
    v_exp_f32_e64 v32, v32
    v_mfma_f32_16x16x32_bf16 v[40:43], a[100:103], a[36:39], v[40:43]
    buffer_load_dwordx4 v4, s[4:7], s42 offen offset:3072 nt lds
    v_mfma_f32_16x16x32_bf16 v[40:43], a[104:107], a[40:43], v[40:43]
    v_exp_f32_e64 v33, v33
    v_mfma_f32_16x16x32_bf16 v[40:43], a[108:111], a[44:47], v[40:43]
    v_cvt_pk_bf16_f32 v48, v32, v33
    v_mfma_f32_16x16x32_bf16 v[44:47], a[124:127], a[44:47], v[24:27]
    s_add_u32 m0, s41, 0
    v_exp_f32 v34, v34
    v_mfma_f32_16x16x32_bf16 v[44:47], a[120:123], a[40:43], v[44:47]
    buffer_load_dwordx4 v4, s[8:11], s42 offen offset:0 nt lds
    v_mfma_f32_16x16x32_bf16 v[44:47], a[116:119], a[36:39], v[44:47]
    v_exp_f32_e64 v35, v35
    v_mfma_f32_16x16x32_bf16 v[44:47], a[112:115], a[32:35], v[44:47]
    v_cvt_pk_bf16_f32 v49, v34, v35
    v_smfmac_f32_16x16x64_bf16 a[196:199], v[8:11], v[56:63], v5
    v_mfma_f32_16x16x32_bf16 v[132:135], v[96:99], v[56:59], v[132:135]
    v_exp_f32_e64 v36, v36
    v_mfma_f32_16x16x32_bf16 v[132:135], v[104:107], v[60:63], v[132:135]
    buffer_load_dwordx4 v4, s[8:11], s42 offen offset:1024 nt lds
    v_mfma_f32_16x16x32_bf16 v[148:151], v[108:111], v[60:63], v[148:151]
    v_exp_f32_e64 v37, v37
    v_mfma_f32_16x16x32_bf16 v[148:151], v[100:103], v[56:59], v[148:151]
    v_cvt_pk_bf16_f32 v50, v36, v37
    v_mfma_f32_16x16x32_bf16 v[164:167], a[136:139], v[56:59], v[164:167]
    v_exp_f32_e64 v38, v38
    v_mfma_f32_16x16x32_bf16 v[164:167], a[168:171], v[60:63], v[164:167]
    buffer_load_dwordx4 v4, s[8:11], s42 offen offset:2048 nt lds
    v_mfma_f32_16x16x32_bf16 v[180:183], a[172:175], v[60:63], v[180:183]
    v_exp_f32_e64 v39, v39
    v_mfma_f32_16x16x32_bf16 v[180:183], a[140:143], v[56:59], v[180:183]
    v_cvt_pk_bf16_f32 v51, v38, v39
    v_mfma_f32_16x16x32_bf16 v[196:199], a[144:147], v[56:59], v[196:199]
    v_exp_f32_e64 v40, v40
    v_mfma_f32_16x16x32_bf16 v[196:199], a[176:179], v[60:63], v[196:199]
    buffer_load_dwordx4 v4, s[8:11], s42 offen offset:3072 nt lds
    v_mfma_f32_16x16x32_bf16 v[212:215], a[180:183], v[60:63], v[212:215]
    v_exp_f32_e64 v41, v41
    v_mfma_f32_16x16x32_bf16 v[212:215], a[148:151], v[56:59], v[212:215]
    v_cvt_pk_bf16_f32 v52, v40, v41
    v_mfma_f32_16x16x32_bf16 v[228:231], a[152:155], v[56:59], v[228:231]
    v_exp_f32 v42, v42
    v_mfma_f32_16x16x32_bf16 v[228:231], a[184:187], v[60:63], v[228:231]
    s_waitcnt lgkmcnt(0)
    s_barrier
    v_mfma_f32_16x16x32_bf16 v[244:247], a[188:191], v[60:63], v[244:247]
    s_add_u32 s85, s85, 0x8000
    v_exp_f32_e64 v43, v43
    v_mfma_f32_16x16x32_bf16 v[244:247], a[156:159], v[56:59], v[244:247]
    s_add_u32 m0, s81, 0
    ds_read_b64_tr_b16 a[128:129], v3 offset:33024
    v_cvt_pk_bf16_f32 v53, v42, v43
    v_mfma_f32_16x16x32_bf16 v[72:75], a[216:219], a[224:227], v[72:75]
    buffer_load_dwordx4 v12, s[68:71], s85 offen lds
    v_mfma_f32_16x16x32_bf16 v[120:123], a[216:219], a[228:231], v[120:123]
    ds_read_b64_tr_b16 a[130:131], v3 offset:34048
    v_mfma_f32_16x16x32_bf16 v[124:127], a[220:223], a[228:231], v[124:127]
    ds_read_b64_tr_b16 a[160:161], v3 offset:35072
    v_mfma_f32_16x16x32_bf16 v[76:79], a[220:223], a[224:227], v[76:79]
    ds_read_b64_tr_b16 a[162:163], v3 offset:36096
    v_mfma_f32_16x16x32_bf16 v[32:35], a[64:67], a[48:51], v[28:31]
    v_exp_f32_e64 v44, v44
    v_mfma_f32_16x16x32_bf16 v[32:35], a[68:71], a[52:55], v[32:35]
    ds_read_b128 a[64:67], v2 offset:32832
    v_mfma_f32_16x16x32_bf16 v[32:35], a[72:75], a[56:59], v[32:35]
    v_exp_f32_e64 v45, v45
    v_mfma_f32_16x16x32_bf16 v[32:35], a[76:79], a[60:63], v[32:35]
    ds_read_b128 a[68:71], v2 offset:33088
    v_cvt_pk_bf16_f32 v54, v44, v45
    v_mfma_f32_16x16x32_bf16 v[36:39], a[92:95], a[60:63], v[28:31]
    v_exp_f32_e64 v46, v46
    v_mfma_f32_16x16x32_bf16 v[36:39], a[88:91], a[56:59], v[36:39]
    ds_read_b128 a[72:75], v2 offset:33344
    v_mfma_f32_16x16x32_bf16 v[36:39], a[84:87], a[52:55], v[36:39]
    v_exp_f32_e64 v47, v47
    v_mfma_f32_16x16x32_bf16 v[36:39], a[80:83], a[48:51], v[36:39]
    ds_read_b128 a[76:79], v2 offset:33600
    v_cvt_pk_bf16_f32 v55, v46, v47
    v_mfma_f32_16x16x32_bf16 v[40:43], a[96:99], a[48:51], v[28:31]
    v_exp_f32_e64 v32, v32
    v_mfma_f32_16x16x32_bf16 v[40:43], a[100:103], a[52:55], v[40:43]
    ds_read_b128 a[92:95], v2 offset:34624
    v_mfma_f32_16x16x32_bf16 v[40:43], a[104:107], a[56:59], v[40:43]
    v_exp_f32_e64 v33, v33
    v_mfma_f32_16x16x32_bf16 v[40:43], a[108:111], a[60:63], v[40:43]
    ds_read_b128 a[88:91], v2 offset:34368
    v_cvt_pk_bf16_f32 v56, v32, v33
    v_mfma_f32_16x16x32_bf16 v[44:47], a[124:127], a[60:63], v[28:31]
    v_exp_f32_e64 v34, v34
    v_mfma_f32_16x16x32_bf16 v[44:47], a[120:123], a[56:59], v[44:47]
    ds_read_b128 a[84:87], v2 offset:34112
    v_mfma_f32_16x16x32_bf16 v[44:47], a[116:119], a[52:55], v[44:47]
    v_exp_f32_e64 v35, v35
    v_mfma_f32_16x16x32_bf16 v[44:47], a[112:115], a[48:51], v[44:47]
    ds_read_b128 a[80:83], v2 offset:33856
    v_cvt_pk_bf16_f32 v57, v34, v35
    v_smfmac_f32_16x16x64_bf16 a[200:203], v[8:11], v[48:55], v5
    ds_read_b128 a[96:99], v2 offset:34880
    v_mfma_f32_16x16x32_bf16 v[136:139], v[96:99], v[48:51], v[136:139]
    v_exp_f32_e64 v36, v36
    v_mfma_f32_16x16x32_bf16 v[136:139], v[104:107], v[52:55], v[136:139]
    ds_read_b128 a[100:103], v2 offset:35136
    v_mfma_f32_16x16x32_bf16 v[152:155], v[108:111], v[52:55], v[152:155]
    v_exp_f32_e64 v37, v37
    v_mfma_f32_16x16x32_bf16 v[152:155], v[100:103], v[48:51], v[152:155]
    ds_read_b128 a[104:107], v2 offset:35392
    v_cvt_pk_bf16_f32 v58, v36, v37
    v_mfma_f32_16x16x32_bf16 v[168:171], a[136:139], v[48:51], v[168:171]
    v_exp_f32_e64 v38, v38
    v_mfma_f32_16x16x32_bf16 v[168:171], a[168:171], v[52:55], v[168:171]
    ds_read_b128 a[108:111], v2 offset:35648
    v_mfma_f32_16x16x32_bf16 v[184:187], a[172:175], v[52:55], v[184:187]
    v_exp_f32_e64 v39, v39
    v_mfma_f32_16x16x32_bf16 v[184:187], a[140:143], v[48:51], v[184:187]
    ds_read_b128 a[124:127], v2 offset:36672
    v_cvt_pk_bf16_f32 v59, v38, v39
    v_mfma_f32_16x16x32_bf16 v[200:203], a[144:147], v[48:51], v[200:203]
    v_exp_f32_e64 v40, v40
    v_mfma_f32_16x16x32_bf16 v[200:203], a[176:179], v[52:55], v[200:203]
    ds_read_b128 a[120:123], v2 offset:36416
    v_mfma_f32_16x16x32_bf16 v[216:219], a[180:183], v[52:55], v[216:219]
    v_exp_f32_e64 v41, v41
    v_mfma_f32_16x16x32_bf16 v[216:219], a[148:151], v[48:51], v[216:219]
    ds_read_b128 a[116:119], v2 offset:36160
    v_cvt_pk_bf16_f32 v60, v40, v41
    v_mfma_f32_16x16x32_bf16 v[232:235], a[152:155], v[48:51], v[232:235]
    v_exp_f32 v42, v42
    v_mfma_f32_16x16x32_bf16 v[232:235], a[184:187], v[52:55], v[232:235]
    s_waitcnt vmcnt(9)
    v_cmp_le_u32 vcc, 32, v1
    s_nop 0
    s_cmp_eq_u64 vcc, -1
    s_cbranch_scc0 L_spin_cnt
L_ok_cnt:
    v_mfma_f32_16x16x32_bf16 v[248:251], a[188:191], v[52:55], v[248:251]
    s_bitcmp1_b32 s93, s43
    v_exp_f32 v43, v43
    v_mfma_f32_16x16x32_bf16 v[248:251], a[156:159], v[48:51], v[248:251]
    v_cvt_pk_bf16_f32 v61, v42, v43
    s_cbranch_scc1 L_rc_b
L_rc_b_back:
    s_waitcnt lgkmcnt(2)
    v_mfma_f32_16x16x32_bf16 v[32:35], a[64:67], a[0:3], v[16:19]
    s_add_u32 s86, s86, 0x1000
    v_exp_f32_e64 v44, v44
    v_mfma_f32_16x16x32_bf16 v[32:35], a[68:71], a[4:7], v[32:35]
    buffer_load_dwordx4 a[224:227], v13, s[12:15], s86 offen sc1
    v_mfma_f32_16x16x32_bf16 v[32:35], a[72:75], a[8:11], v[32:35]
    v_exp_f32_e64 v45, v45
    v_mfma_f32_16x16x32_bf16 v[32:35], a[76:79], a[12:15], v[32:35]
    ds_read_b128 a[112:115], v2 offset:35904
    v_cvt_pk_bf16_f32 v62, v44, v45
    v_mfma_f32_16x16x32_bf16 v[36:39], a[92:95], a[12:15], v[16:19]
    s_add_u32 s95, s86, s94
    v_exp_f32 v46, v46
    v_mfma_f32_16x16x32_bf16 v[36:39], a[88:91], a[8:11], v[36:39]
    buffer_load_dwordx4 a[228:231], v13, s[12:15], s95 offen sc1
    v_mfma_f32_16x16x32_bf16 v[36:39], a[84:87], a[4:7], v[36:39]
    v_exp_f32_e64 v47, v47
    v_mfma_f32_16x16x32_bf16 v[36:39], a[80:83], a[0:3], v[36:39]
    ds_read_b64_tr_b16 a[164:165], v3 offset:35104
    v_cvt_pk_bf16_f32 v63, v46, v47
    v_mfma_f32_16x16x32_bf16 v[40:43], a[96:99], a[0:3], v[16:19]
    v_exp_f32_e64 v32, v32
    v_mfma_f32_16x16x32_bf16 v[40:43], a[100:103], a[4:7], v[40:43]
    ds_read_b64_tr_b16 a[166:167], v3 offset:36128
    v_mfma_f32_16x16x32_bf16 v[40:43], a[104:107], a[8:11], v[40:43]
    v_exp_f32_e64 v33, v33
    v_mfma_f32_16x16x32_bf16 v[40:43], a[108:111], a[12:15], v[40:43]
    ds_read_b64_tr_b16 a[132:133], v3 offset:33056
    v_cvt_pk_bf16_f32 v48, v32, v33
    v_mfma_f32_16x16x32_bf16 v[44:47], a[124:127], a[12:15], v[16:19]
    s_waitcnt lgkmcnt(3)
    v_exp_f32 v34, v34
    v_mfma_f32_16x16x32_bf16 v[44:47], a[120:123], a[8:11], v[44:47]
    ds_read_b64_tr_b16 a[134:135], v3 offset:34080
    v_mfma_f32_16x16x32_bf16 v[44:47], a[116:119], a[4:7], v[44:47]
    v_exp_f32_e64 v35, v35
    v_mfma_f32_16x16x32_bf16 v[44:47], a[112:115], a[0:3], v[44:47]
    v_cvt_pk_bf16_f32 v49, v34, v35
    v_smfmac_f32_16x16x64_bf16 a[204:207], v[8:11], v[56:63], v5
    v_mfma_f32_16x16x32_bf16 v[140:143], v[96:99], v[56:59], v[140:143]
    v_exp_f32 v36, v36
    v_mfma_f32_16x16x32_bf16 v[140:143], v[104:107], v[60:63], v[140:143]
    v_mfma_f32_16x16x32_bf16 v[156:159], v[108:111], v[60:63], v[156:159]
    v_exp_f32 v37, v37
    v_mfma_f32_16x16x32_bf16 v[156:159], v[100:103], v[56:59], v[156:159]
    v_cvt_pk_bf16_f32 v50, v36, v37
    v_mfma_f32_16x16x32_bf16 v[172:175], a[136:139], v[56:59], v[172:175]
    v_exp_f32_e64 v38, v38
    v_mfma_f32_16x16x32_bf16 v[172:175], a[168:171], v[60:63], v[172:175]
    ds_read_b64_tr_b16 a[136:137], v3 offset:33280
    v_mfma_f32_16x16x32_bf16 v[188:191], a[172:175], v[60:63], v[188:191]
    v_exp_f32_e64 v39, v39
    v_mfma_f32_16x16x32_bf16 v[188:191], a[140:143], v[56:59], v[188:191]
    ds_read_b64_tr_b16 a[138:139], v3 offset:34304
    v_cvt_pk_bf16_f32 v51, v38, v39
    v_mfma_f32_16x16x32_bf16 v[204:207], a[144:147], v[56:59], v[204:207]
    v_exp_f32_e64 v40, v40
    v_mfma_f32_16x16x32_bf16 v[204:207], a[176:179], v[60:63], v[204:207]
    ds_read_b64_tr_b16 a[168:169], v3 offset:35328
    v_mfma_f32_16x16x32_bf16 v[220:223], a[180:183], v[60:63], v[220:223]
    v_exp_f32_e64 v41, v41
    v_mfma_f32_16x16x32_bf16 v[220:223], a[148:151], v[56:59], v[220:223]
    ds_read_b64_tr_b16 a[170:171], v3 offset:36352
    v_cvt_pk_bf16_f32 v52, v40, v41
    v_mfma_f32_16x16x32_bf16 v[236:239], a[152:155], v[56:59], v[236:239]
    v_exp_f32_e64 v42, v42
    v_mfma_f32_16x16x32_bf16 v[236:239], a[184:187], v[60:63], v[236:239]
    ds_read_b64_tr_b16 a[172:173], v3 offset:35360
    v_mfma_f32_16x16x32_bf16 v[252:255], a[188:191], v[60:63], v[252:255]
    ds_read_b64_tr_b16 a[184:185], v3 offset:35840
    v_exp_f32_e64 v43, v43
    v_mfma_f32_16x16x32_bf16 v[252:255], a[156:159], v[56:59], v[252:255]
    ds_read_b64_tr_b16 a[174:175], v3 offset:36384
    v_cvt_pk_bf16_f32 v53, v42, v43
    v_mfma_f32_16x16x32_bf16 v[32:35], a[64:67], a[16:19], v[20:23]
    ds_read_b64_tr_b16 a[188:189], v3 offset:35872
    v_exp_f32_e64 v44, v44
    v_mfma_f32_16x16x32_bf16 v[32:35], a[68:71], a[20:23], v[32:35]
    ds_read_b64_tr_b16 a[140:141], v3 offset:33312
    v_mfma_f32_16x16x32_bf16 v[32:35], a[72:75], a[24:27], v[32:35]
    ds_read_b64_tr_b16 a[190:191], v3 offset:36896
    v_exp_f32_e64 v45, v45
    v_mfma_f32_16x16x32_bf16 v[32:35], a[76:79], a[28:31], v[32:35]
    ds_read_b64_tr_b16 a[142:143], v3 offset:34336
    v_cvt_pk_bf16_f32 v54, v44, v45
    v_mfma_f32_16x16x32_bf16 v[36:39], a[92:95], a[28:31], v[20:23]
    ds_read_b64_tr_b16 a[156:157], v3 offset:33824
    v_exp_f32_e64 v46, v46
    v_mfma_f32_16x16x32_bf16 v[36:39], a[88:91], a[24:27], v[36:39]
    ds_read_b64_tr_b16 a[144:145], v3 offset:33536
    v_mfma_f32_16x16x32_bf16 v[36:39], a[84:87], a[20:23], v[36:39]
    v_exp_f32_e64 v47, v47
    v_mfma_f32_16x16x32_bf16 v[36:39], a[80:83], a[16:19], v[36:39]
    ds_read_b64_tr_b16 a[146:147], v3 offset:34560
    v_cvt_pk_bf16_f32 v55, v46, v47
    v_mfma_f32_16x16x32_bf16 v[40:43], a[96:99], a[16:19], v[20:23]
    v_exp_f32_e64 v32, v32
    v_mfma_f32_16x16x32_bf16 v[40:43], a[100:103], a[20:23], v[40:43]
    ds_read_b64_tr_b16 a[176:177], v3 offset:35584
    v_mfma_f32_16x16x32_bf16 v[40:43], a[104:107], a[24:27], v[40:43]
    v_exp_f32_e64 v33, v33
    v_mfma_f32_16x16x32_bf16 v[40:43], a[108:111], a[28:31], v[40:43]
    ds_read_b64_tr_b16 a[178:179], v3 offset:36608
    v_cvt_pk_bf16_f32 v56, v32, v33
    v_mfma_f32_16x16x32_bf16 v[44:47], a[124:127], a[28:31], v[20:23]
    v_exp_f32_e64 v34, v34
    v_mfma_f32_16x16x32_bf16 v[44:47], a[120:123], a[24:27], v[44:47]
    ds_read_b64_tr_b16 a[180:181], v3 offset:35616
    v_mfma_f32_16x16x32_bf16 v[44:47], a[116:119], a[20:23], v[44:47]
    v_exp_f32_e64 v35, v35
    v_mfma_f32_16x16x32_bf16 v[44:47], a[112:115], a[16:19], v[44:47]
    ds_read_b64_tr_b16 a[182:183], v3 offset:36640
    v_cvt_pk_bf16_f32 v57, v34, v35
    v_smfmac_f32_16x16x64_bf16 a[192:195], v[8:11], v[48:55], v5
    ds_read_b64_tr_b16 a[148:149], v3 offset:33568
    v_mfma_f32_16x16x32_bf16 v[128:131], a[128:131], v[48:51], v[128:131]
    v_exp_f32 v36, v36
    v_mfma_f32_16x16x32_bf16 v[128:131], a[160:163], v[52:55], v[128:131]
    s_waitcnt lgkmcnt(3)
    ds_read_b64_tr_b16 a[150:151], v3 offset:34592
    v_mfma_f32_16x16x32_bf16 v[144:147], a[164:167], v[52:55], v[144:147]
    v_exp_f32_e64 v37, v37
    v_mfma_f32_16x16x32_bf16 v[144:147], a[132:135], v[48:51], v[144:147]
    ds_read_b64_tr_b16 a[152:153], v3 offset:33792
    v_cvt_pk_bf16_f32 v58, v36, v37
    v_mfma_f32_16x16x32_bf16 v[160:163], a[136:139], v[48:51], v[160:163]
    v_exp_f32_e64 v38, v38
    v_mfma_f32_16x16x32_bf16 v[160:163], a[168:171], v[52:55], v[160:163]
    ds_read_b64_tr_b16 a[154:155], v3 offset:34816
    v_mfma_f32_16x16x32_bf16 v[176:179], a[172:175], v[52:55], v[176:179]
    v_exp_f32_e64 v39, v39
    v_mfma_f32_16x16x32_bf16 v[176:179], a[140:143], v[48:51], v[176:179]
    ds_read_b64_tr_b16 a[186:187], v3 offset:36864
    v_cvt_pk_bf16_f32 v59, v38, v39
    v_mfma_f32_16x16x32_bf16 v[192:195], a[144:147], v[48:51], v[192:195]
    v_exp_f32 v40, v40
    v_mfma_f32_16x16x32_bf16 v[192:195], a[176:179], v[52:55], v[192:195]
    s_waitcnt lgkmcnt(3)
    ds_read_b64_tr_b16 a[158:159], v3 offset:34848
    v_mfma_f32_16x16x32_bf16 v[208:211], a[180:183], v[52:55], v[208:211]
    v_exp_f32 v41, v41
    v_mfma_f32_16x16x32_bf16 v[208:211], a[148:151], v[48:51], v[208:211]
    s_waitcnt lgkmcnt(2)
    s_add_u32 s42, s42, 0x4000
    v_cvt_pk_bf16_f32 v60, v40, v41
    v_mfma_f32_16x16x32_bf16 v[224:227], a[152:155], v[48:51], v[224:227]
    s_waitcnt lgkmcnt(1)
    s_add_u32 m0, s40, 16416
    v_exp_f32 v42, v42
    v_mfma_f32_16x16x32_bf16 v[224:227], a[184:187], v[52:55], v[224:227]
    buffer_load_dwordx4 v4, s[4:7], s42 offen offset:0 nt lds
    v_mfma_f32_16x16x32_bf16 v[240:243], a[188:191], v[52:55], v[240:243]
    s_waitcnt lgkmcnt(0)
    v_exp_f32 v43, v43
    v_mfma_f32_16x16x32_bf16 v[240:243], a[156:159], v[48:51], v[240:243]
    v_cvt_pk_bf16_f32 v61, v42, v43
    v_mfma_f32_16x16x32_bf16 v[32:35], a[64:67], a[32:35], v[24:27]
    v_exp_f32_e64 v44, v44
    v_mfma_f32_16x16x32_bf16 v[32:35], a[68:71], a[36:39], v[32:35]
    buffer_load_dwordx4 v4, s[4:7], s42 offen offset:1024 nt lds
    v_mfma_f32_16x16x32_bf16 v[32:35], a[72:75], a[40:43], v[32:35]
    v_exp_f32_e64 v45, v45
    v_mfma_f32_16x16x32_bf16 v[32:35], a[76:79], a[44:47], v[32:35]
    v_cvt_pk_bf16_f32 v62, v44, v45
    v_mfma_f32_16x16x32_bf16 v[36:39], a[92:95], a[44:47], v[24:27]
    v_exp_f32_e64 v46, v46
    v_mfma_f32_16x16x32_bf16 v[36:39], a[88:91], a[40:43], v[36:39]
    buffer_load_dwordx4 v4, s[4:7], s42 offen offset:2048 nt lds
    v_mfma_f32_16x16x32_bf16 v[36:39], a[84:87], a[36:39], v[36:39]
    v_exp_f32_e64 v47, v47
    v_mfma_f32_16x16x32_bf16 v[36:39], a[80:83], a[32:35], v[36:39]
    v_cvt_pk_bf16_f32 v63, v46, v47
    v_mfma_f32_16x16x32_bf16 v[40:43], a[96:99], a[32:35], v[24:27]
    v_exp_f32_e64 v32, v32
    v_mfma_f32_16x16x32_bf16 v[40:43], a[100:103], a[36:39], v[40:43]
    buffer_load_dwordx4 v4, s[4:7], s42 offen offset:3072 nt lds
    v_mfma_f32_16x16x32_bf16 v[40:43], a[104:107], a[40:43], v[40:43]
    v_exp_f32_e64 v33, v33
    v_mfma_f32_16x16x32_bf16 v[40:43], a[108:111], a[44:47], v[40:43]
    v_cvt_pk_bf16_f32 v48, v32, v33
    v_mfma_f32_16x16x32_bf16 v[44:47], a[124:127], a[44:47], v[24:27]
    s_add_u32 m0, s41, 16512
    v_exp_f32_e64 v34, v34
    v_mfma_f32_16x16x32_bf16 v[44:47], a[120:123], a[40:43], v[44:47]
    buffer_load_dwordx4 v4, s[8:11], s42 offen offset:0 nt lds
    v_mfma_f32_16x16x32_bf16 v[44:47], a[116:119], a[36:39], v[44:47]
    v_exp_f32_e64 v35, v35
    v_mfma_f32_16x16x32_bf16 v[44:47], a[112:115], a[32:35], v[44:47]
    v_cvt_pk_bf16_f32 v49, v34, v35
    v_smfmac_f32_16x16x64_bf16 a[196:199], v[8:11], v[56:63], v5
    v_mfma_f32_16x16x32_bf16 v[132:135], a[128:131], v[56:59], v[132:135]
    v_exp_f32_e64 v36, v36
    v_mfma_f32_16x16x32_bf16 v[132:135], a[160:163], v[60:63], v[132:135]
    buffer_load_dwordx4 v4, s[8:11], s42 offen offset:1024 nt lds
    v_mfma_f32_16x16x32_bf16 v[148:151], a[164:167], v[60:63], v[148:151]
    v_exp_f32_e64 v37, v37
    v_mfma_f32_16x16x32_bf16 v[148:151], a[132:135], v[56:59], v[148:151]
    v_cvt_pk_bf16_f32 v50, v36, v37
    v_mfma_f32_16x16x32_bf16 v[164:167], a[136:139], v[56:59], v[164:167]
    v_exp_f32_e64 v38, v38
    v_mfma_f32_16x16x32_bf16 v[164:167], a[168:171], v[60:63], v[164:167]
    buffer_load_dwordx4 v4, s[8:11], s42 offen offset:2048 nt lds
    v_mfma_f32_16x16x32_bf16 v[180:183], a[172:175], v[60:63], v[180:183]
    v_exp_f32_e64 v39, v39
    v_mfma_f32_16x16x32_bf16 v[180:183], a[140:143], v[56:59], v[180:183]
    v_cvt_pk_bf16_f32 v51, v38, v39
    v_mfma_f32_16x16x32_bf16 v[196:199], a[144:147], v[56:59], v[196:199]
    v_exp_f32_e64 v40, v40
    v_mfma_f32_16x16x32_bf16 v[196:199], a[176:179], v[60:63], v[196:199]
    buffer_load_dwordx4 v4, s[8:11], s42 offen offset:3072 nt lds
    v_mfma_f32_16x16x32_bf16 v[212:215], a[180:183], v[60:63], v[212:215]
L_hop5:
    s_cbranch_execz L_hop_back
    v_exp_f32 v41, v41
    v_mfma_f32_16x16x32_bf16 v[212:215], a[148:151], v[56:59], v[212:215]
    v_cvt_pk_bf16_f32 v52, v40, v41
    v_mfma_f32_16x16x32_bf16 v[228:231], a[152:155], v[56:59], v[228:231]
    v_exp_f32 v42, v42
    v_mfma_f32_16x16x32_bf16 v[228:231], a[184:187], v[60:63], v[228:231]
    s_waitcnt vmcnt(10) lgkmcnt(0)
    s_barrier
    v_mfma_f32_16x16x32_bf16 v[244:247], a[188:191], v[60:63], v[244:247]
    v_exp_f32 v43, v43
    v_mfma_f32_16x16x32_bf16 v[244:247], a[156:159], v[56:59], v[244:247]
    s_add_u32 s85, s85, 0x8000
    ds_read_b64_tr_b16 v[96:97], v3 offset:49536
    v_cvt_pk_bf16_f32 v53, v42, v43
    v_mfma_f32_16x16x32_bf16 v[32:35], a[64:67], a[48:51], v[28:31]
    s_add_u32 m0, s81, 8192
    v_exp_f32_e64 v44, v44
    v_mfma_f32_16x16x32_bf16 v[32:35], a[68:71], a[52:55], v[32:35]
    buffer_load_dwordx4 v12, s[68:71], s85 offen lds
    v_mfma_f32_16x16x32_bf16 v[32:35], a[72:75], a[56:59], v[32:35]
    v_exp_f32_e64 v45, v45
    v_mfma_f32_16x16x32_bf16 v[32:35], a[76:79], a[60:63], v[32:35]
    ds_read_b128 a[64:67], v2 offset:49248
    v_cvt_pk_bf16_f32 v54, v44, v45
    v_mfma_f32_16x16x32_bf16 v[36:39], a[92:95], a[60:63], v[28:31]
    v_exp_f32_e64 v46, v46
    v_mfma_f32_16x16x32_bf16 v[36:39], a[88:91], a[56:59], v[36:39]
    ds_read_b128 a[68:71], v2 offset:49504
    v_mfma_f32_16x16x32_bf16 v[36:39], a[84:87], a[52:55], v[36:39]
    v_exp_f32_e64 v47, v47
    v_mfma_f32_16x16x32_bf16 v[36:39], a[80:83], a[48:51], v[36:39]
    ds_read_b128 a[72:75], v2 offset:49760
    v_cvt_pk_bf16_f32 v55, v46, v47
    v_mfma_f32_16x16x32_bf16 v[40:43], a[96:99], a[48:51], v[28:31]
    v_exp_f32_e64 v32, v32
    v_mfma_f32_16x16x32_bf16 v[40:43], a[100:103], a[52:55], v[40:43]
    ds_read_b128 a[76:79], v2 offset:50016
    v_mfma_f32_16x16x32_bf16 v[40:43], a[104:107], a[56:59], v[40:43]
    v_exp_f32_e64 v33, v33
    v_mfma_f32_16x16x32_bf16 v[40:43], a[108:111], a[60:63], v[40:43]
    ds_read_b128 a[92:95], v2 offset:51040
    v_cvt_pk_bf16_f32 v56, v32, v33
    v_mfma_f32_16x16x32_bf16 v[44:47], a[124:127], a[60:63], v[28:31]
    v_exp_f32_e64 v34, v34
    v_mfma_f32_16x16x32_bf16 v[44:47], a[120:123], a[56:59], v[44:47]
    ds_read_b128 a[88:91], v2 offset:50784
    v_mfma_f32_16x16x32_bf16 v[44:47], a[116:119], a[52:55], v[44:47]
    v_exp_f32_e64 v35, v35
    v_mfma_f32_16x16x32_bf16 v[44:47], a[112:115], a[48:51], v[44:47]
    ds_read_b128 a[84:87], v2 offset:50528
    v_cvt_pk_bf16_f32 v57, v34, v35
    v_smfmac_f32_16x16x64_bf16 a[200:203], v[8:11], v[48:55], v5
    ds_read_b128 a[80:83], v2 offset:50272
    v_mfma_f32_16x16x32_bf16 v[136:139], a[128:131], v[48:51], v[136:139]
    v_exp_f32_e64 v36, v36
    v_mfma_f32_16x16x32_bf16 v[136:139], a[160:163], v[52:55], v[136:139]
    ds_read_b128 a[96:99], v2 offset:51296
    v_mfma_f32_16x16x32_bf16 v[152:155], a[164:167], v[52:55], v[152:155]
    v_exp_f32_e64 v37, v37
    v_mfma_f32_16x16x32_bf16 v[152:155], a[132:135], v[48:51], v[152:155]
    ds_read_b128 a[100:103], v2 offset:51552
    v_cvt_pk_bf16_f32 v58, v36, v37
    v_mfma_f32_16x16x32_bf16 v[168:171], a[136:139], v[48:51], v[168:171]
    v_exp_f32_e64 v38, v38
    v_mfma_f32_16x16x32_bf16 v[168:171], a[168:171], v[52:55], v[168:171]
    ds_read_b128 a[104:107], v2 offset:51808
    v_mfma_f32_16x16x32_bf16 v[184:187], a[172:175], v[52:55], v[184:187]
    v_exp_f32_e64 v39, v39
    v_mfma_f32_16x16x32_bf16 v[184:187], a[140:143], v[48:51], v[184:187]
    ds_read_b128 a[108:111], v2 offset:52064
    v_cvt_pk_bf16_f32 v59, v38, v39
    v_mfma_f32_16x16x32_bf16 v[200:203], a[144:147], v[48:51], v[200:203]
    v_exp_f32_e64 v40, v40
    v_mfma_f32_16x16x32_bf16 v[200:203], a[176:179], v[52:55], v[200:203]
    ds_read_b128 a[124:127], v2 offset:53088
    v_mfma_f32_16x16x32_bf16 v[216:219], a[180:183], v[52:55], v[216:219]
    v_exp_f32_e64 v41, v41
    v_mfma_f32_16x16x32_bf16 v[216:219], a[148:151], v[48:51], v[216:219]
    ds_read_b128 a[120:123], v2 offset:52832
    v_cvt_pk_bf16_f32 v60, v40, v41
    v_mfma_f32_16x16x32_bf16 v[232:235], a[152:155], v[48:51], v[232:235]
    v_exp_f32_e64 v42, v42
    v_mfma_f32_16x16x32_bf16 v[232:235], a[184:187], v[52:55], v[232:235]
    ds_read_b128 a[116:119], v2 offset:52576
    v_mfma_f32_16x16x32_bf16 v[248:251], a[188:191], v[52:55], v[248:251]
    v_exp_f32 v43, v43
    v_mfma_f32_16x16x32_bf16 v[248:251], a[156:159], v[48:51], v[248:251]
    s_waitcnt lgkmcnt(3)
    ds_read_b128 a[112:115], v2 offset:52320
    v_cvt_pk_bf16_f32 v61, v42, v43
    v_mfma_f32_16x16x32_bf16 v[32:35], a[64:67], a[0:3], v[16:19]
    s_add_u32 s86, s86, 0x1000
    v_exp_f32_e64 v44, v44
    v_mfma_f32_16x16x32_bf16 v[32:35], a[68:71], a[4:7], v[32:35]
    buffer_load_dwordx4 a[232:235], v13, s[12:15], s86 offen sc1
    v_mfma_f32_16x16x32_bf16 v[32:35], a[72:75], a[8:11], v[32:35]
    v_exp_f32_e64 v45, v45
    v_mfma_f32_16x16x32_bf16 v[32:35], a[76:79], a[12:15], v[32:35]
    ds_read_b64_tr_b16 a[208:209], v14 offset:0
    v_cvt_pk_bf16_f32 v62, v44, v45
    v_mfma_f32_16x16x32_bf16 v[36:39], a[92:95], a[12:15], v[16:19]
    s_add_u32 s95, s86, s94
    v_exp_f32 v46, v46
    v_mfma_f32_16x16x32_bf16 v[36:39], a[88:91], a[8:11], v[36:39]
    buffer_load_dwordx4 a[236:239], v13, s[12:15], s95 offen sc1
    v_mfma_f32_16x16x32_bf16 v[36:39], a[84:87], a[4:7], v[36:39]
    v_exp_f32_e64 v47, v47
    v_mfma_f32_16x16x32_bf16 v[36:39], a[80:83], a[0:3], v[36:39]
    ds_read_b64_tr_b16 a[210:211], v14 offset:2048
    v_cvt_pk_bf16_f32 v63, v46, v47
    v_mfma_f32_16x16x32_bf16 v[40:43], a[96:99], a[0:3], v[16:19]
    v_exp_f32_e64 v32, v32
    v_mfma_f32_16x16x32_bf16 v[40:43], a[100:103], a[4:7], v[40:43]
    ds_read_b64_tr_b16 a[212:213], v15 offset:0
    v_mfma_f32_16x16x32_bf16 v[40:43], a[104:107], a[8:11], v[40:43]
    v_exp_f32 v33, v33
    v_mfma_f32_16x16x32_bf16 v[40:43], a[108:111], a[12:15], v[40:43]
    s_waitcnt lgkmcnt(2)
    ds_read_b64_tr_b16 a[214:215], v15 offset:2048
    v_cvt_pk_bf16_f32 v48, v32, v33
    v_mfma_f32_16x16x32_bf16 v[44:47], a[124:127], a[12:15], v[16:19]
    v_exp_f32_e64 v34, v34
    v_mfma_f32_16x16x32_bf16 v[44:47], a[120:123], a[8:11], v[44:47]
    ds_read_b64_tr_b16 v[98:99], v3 offset:50560
    v_mfma_f32_16x16x32_bf16 v[44:47], a[116:119], a[4:7], v[44:47]
    v_exp_f32_e64 v35, v35
    v_mfma_f32_16x16x32_bf16 v[44:47], a[112:115], a[0:3], v[44:47]
    ds_read_b64_tr_b16 v[104:105], v3 offset:51584
    v_cvt_pk_bf16_f32 v49, v34, v35
    v_smfmac_f32_16x16x64_bf16 a[204:207], v[8:11], v[56:63], v5
    ds_read_b64_tr_b16 v[106:107], v3 offset:52608
    v_mfma_f32_16x16x32_bf16 v[140:143], a[128:131], v[56:59], v[140:143]
    v_exp_f32_e64 v36, v36
    v_mfma_f32_16x16x32_bf16 v[140:143], a[160:163], v[60:63], v[140:143]
    ds_read_b64_tr_b16 v[108:109], v3 offset:51616
    v_mfma_f32_16x16x32_bf16 v[156:159], a[164:167], v[60:63], v[156:159]
    v_exp_f32_e64 v37, v37
    v_mfma_f32_16x16x32_bf16 v[156:159], a[132:135], v[56:59], v[156:159]
    ds_read_b64_tr_b16 v[110:111], v3 offset:52640
    v_cvt_pk_bf16_f32 v50, v36, v37
    v_mfma_f32_16x16x32_bf16 v[172:175], a[136:139], v[56:59], v[172:175]
    v_exp_f32_e64 v38, v38
    v_mfma_f32_16x16x32_bf16 v[172:175], a[168:171], v[60:63], v[172:175]
    ds_read_b64_tr_b16 v[100:101], v3 offset:49568
    v_mfma_f32_16x16x32_bf16 v[188:191], a[172:175], v[60:63], v[188:191]
    v_exp_f32_e64 v39, v39
    v_mfma_f32_16x16x32_bf16 v[188:191], a[140:143], v[56:59], v[188:191]
    ds_read_b64_tr_b16 v[102:103], v3 offset:50592
    v_cvt_pk_bf16_f32 v51, v38, v39
    v_mfma_f32_16x16x32_bf16 v[204:207], a[144:147], v[56:59], v[204:207]
    v_exp_f32_e64 v40, v40
    v_mfma_f32_16x16x32_bf16 v[204:207], a[176:179], v[60:63], v[204:207]
    ds_read_b64_tr_b16 a[136:137], v3 offset:49792
    v_mfma_f32_16x16x32_bf16 v[220:223], a[180:183], v[60:63], v[220:223]
    v_exp_f32_e64 v41, v41
    v_mfma_f32_16x16x32_bf16 v[220:223], a[148:151], v[56:59], v[220:223]
    ds_read_b64_tr_b16 a[138:139], v3 offset:50816
    v_cvt_pk_bf16_f32 v52, v40, v41
    v_mfma_f32_16x16x32_bf16 v[236:239], a[152:155], v[56:59], v[236:239]
    v_exp_f32_e64 v42, v42
    v_mfma_f32_16x16x32_bf16 v[236:239], a[184:187], v[60:63], v[236:239]
    ds_read_b64_tr_b16 a[168:169], v3 offset:51840
    v_mfma_f32_16x16x32_bf16 v[252:255], a[188:191], v[60:63], v[252:255]
    ds_read_b64_tr_b16 a[188:189], v3 offset:52384
    v_exp_f32_e64 v43, v43
    v_mfma_f32_16x16x32_bf16 v[252:255], a[156:159], v[56:59], v[252:255]
    ds_read_b64_tr_b16 a[170:171], v3 offset:52864
    v_cvt_pk_bf16_f32 v53, v42, v43
    v_mfma_f32_16x16x32_bf16 v[32:35], a[64:67], a[16:19], v[20:23]
    ds_read_b64_tr_b16 a[156:157], v3 offset:50336
    v_exp_f32_e64 v44, v44
    v_mfma_f32_16x16x32_bf16 v[32:35], a[68:71], a[20:23], v[32:35]
    ds_read_b64_tr_b16 a[172:173], v3 offset:51872
    v_mfma_f32_16x16x32_bf16 v[32:35], a[72:75], a[24:27], v[32:35]
    v_exp_f32_e64 v45, v45
    v_mfma_f32_16x16x32_bf16 v[32:35], a[76:79], a[28:31], v[32:35]
    ds_read_b64_tr_b16 a[174:175], v3 offset:52896
    v_cvt_pk_bf16_f32 v54, v44, v45
    v_mfma_f32_16x16x32_bf16 v[36:39], a[92:95], a[28:31], v[20:23]
    v_exp_f32_e64 v46, v46
    v_mfma_f32_16x16x32_bf16 v[36:39], a[88:91], a[24:27], v[36:39]
    ds_read_b64_tr_b16 a[140:141], v3 offset:49824
    v_mfma_f32_16x16x32_bf16 v[36:39], a[84:87], a[20:23], v[36:39]
    v_exp_f32_e64 v47, v47
    v_mfma_f32_16x16x32_bf16 v[36:39], a[80:83], a[16:19], v[36:39]
    ds_read_b64_tr_b16 a[142:143], v3 offset:50848
    v_cvt_pk_bf16_f32 v55, v46, v47
    v_mfma_f32_16x16x32_bf16 v[40:43], a[96:99], a[16:19], v[20:23]
    v_exp_f32_e64 v32, v32
    v_mfma_f32_16x16x32_bf16 v[40:43], a[100:103], a[20:23], v[40:43]
    ds_read_b64_tr_b16 a[144:145], v3 offset:50048
    v_mfma_f32_16x16x32_bf16 v[40:43], a[104:107], a[24:27], v[40:43]
    v_exp_f32_e64 v33, v33
    v_mfma_f32_16x16x32_bf16 v[40:43], a[108:111], a[28:31], v[40:43]
    ds_read_b64_tr_b16 a[146:147], v3 offset:51072
    v_cvt_pk_bf16_f32 v56, v32, v33
    v_mfma_f32_16x16x32_bf16 v[44:47], a[124:127], a[28:31], v[20:23]
    v_exp_f32_e64 v34, v34
    v_mfma_f32_16x16x32_bf16 v[44:47], a[120:123], a[24:27], v[44:47]
    ds_read_b64_tr_b16 a[176:177], v3 offset:52096
    v_mfma_f32_16x16x32_bf16 v[44:47], a[116:119], a[20:23], v[44:47]
    v_exp_f32_e64 v35, v35
    v_mfma_f32_16x16x32_bf16 v[44:47], a[112:115], a[16:19], v[44:47]
    ds_read_b64_tr_b16 a[178:179], v3 offset:53120
    v_cvt_pk_bf16_f32 v57, v34, v35
    v_smfmac_f32_16x16x64_bf16 a[192:195], v[8:11], v[48:55], v5
    s_waitcnt vmcnt(12) lgkmcnt(3)
    ds_read_b64_tr_b16 a[180:181], v3 offset:52128
    v_mfma_f32_16x16x32_bf16 v[64:67], a[208:211], a[224:227], v[64:67]
    s_waitcnt vmcnt(11)
    ds_read_b64_tr_b16 a[182:183], v3 offset:53152
    v_mfma_f32_16x16x32_bf16 v[112:115], a[208:211], a[228:231], v[112:115]
    ds_read_b64_tr_b16 a[148:149], v3 offset:50080
    v_mfma_f32_16x16x32_bf16 v[116:119], a[212:215], a[228:231], v[116:119]
    ds_read_b64_tr_b16 a[150:151], v3 offset:51104
    v_mfma_f32_16x16x32_bf16 v[68:71], a[212:215], a[224:227], v[68:71]
    ds_read_b64_tr_b16 a[152:153], v3 offset:50304
    v_mfma_f32_16x16x32_bf16 v[128:131], v[96:99], v[48:51], v[128:131]
    v_exp_f32_e64 v36, v36
    v_mfma_f32_16x16x32_bf16 v[128:131], v[104:107], v[52:55], v[128:131]
    ds_read_b64_tr_b16 a[154:155], v3 offset:51328
    v_mfma_f32_16x16x32_bf16 v[144:147], v[108:111], v[52:55], v[144:147]
    v_exp_f32_e64 v37, v37
    v_mfma_f32_16x16x32_bf16 v[144:147], v[100:103], v[48:51], v[144:147]
    ds_read_b64_tr_b16 a[184:185], v3 offset:52352
    v_cvt_pk_bf16_f32 v58, v36, v37
    v_mfma_f32_16x16x32_bf16 v[160:163], a[136:139], v[48:51], v[160:163]
    v_exp_f32_e64 v38, v38
    v_mfma_f32_16x16x32_bf16 v[160:163], a[168:171], v[52:55], v[160:163]
    ds_read_b64_tr_b16 a[186:187], v3 offset:53376
    v_mfma_f32_16x16x32_bf16 v[176:179], a[172:175], v[52:55], v[176:179]
    v_exp_f32 v39, v39
    v_mfma_f32_16x16x32_bf16 v[176:179], a[140:143], v[48:51], v[176:179]
    s_waitcnt lgkmcnt(3)
    ds_read_b64_tr_b16 a[190:191], v3 offset:53408
    v_cvt_pk_bf16_f32 v59, v38, v39
    v_mfma_f32_16x16x32_bf16 v[192:195], a[144:147], v[48:51], v[192:195]
    v_exp_f32_e64 v40, v40
    v_mfma_f32_16x16x32_bf16 v[192:195], a[176:179], v[52:55], v[192:195]
    ds_read_b64_tr_b16 a[158:159], v3 offset:51360
    v_mfma_f32_16x16x32_bf16 v[208:211], a[180:183], v[52:55], v[208:211]
    v_exp_f32 v41, v41
    v_mfma_f32_16x16x32_bf16 v[208:211], a[148:151], v[48:51], v[208:211]
    s_waitcnt lgkmcnt(3)
    s_add_u32 s42, s42, 0x4000
    ds_read_b64_tr_b16 a[216:217], v14 offset:512
    v_cvt_pk_bf16_f32 v60, v40, v41
    v_mfma_f32_16x16x32_bf16 v[224:227], a[152:155], v[48:51], v[224:227]
    s_waitcnt lgkmcnt(3)
    s_add_u32 m0, s40, 32832
    v_exp_f32 v42, v42
    v_mfma_f32_16x16x32_bf16 v[224:227], a[184:187], v[52:55], v[224:227]
    s_waitcnt lgkmcnt(2)
    buffer_load_dwordx4 v4, s[4:7], s42 offen offset:0 nt lds
    v_mfma_f32_16x16x32_bf16 v[240:243], a[188:191], v[52:55], v[240:243]
    s_waitcnt lgkmcnt(1)
    v_exp_f32_e64 v43, v43
    v_mfma_f32_16x16x32_bf16 v[240:243], a[156:159], v[48:51], v[240:243]
    ds_read_b64_tr_b16 a[218:219], v14 offset:2560
    v_cvt_pk_bf16_f32 v61, v42, v43
    v_mfma_f32_16x16x32_bf16 v[32:35], a[64:67], a[32:35], v[24:27]
    v_exp_f32_e64 v44, v44
    v_mfma_f32_16x16x32_bf16 v[32:35], a[68:71], a[36:39], v[32:35]
    buffer_load_dwordx4 v4, s[4:7], s42 offen offset:1024 nt lds
    v_mfma_f32_16x16x32_bf16 v[32:35], a[72:75], a[40:43], v[32:35]
    v_exp_f32_e64 v45, v45
    v_mfma_f32_16x16x32_bf16 v[32:35], a[76:79], a[44:47], v[32:35]
    ds_read_b64_tr_b16 a[220:221], v15 offset:512
    v_cvt_pk_bf16_f32 v62, v44, v45
    v_mfma_f32_16x16x32_bf16 v[36:39], a[92:95], a[44:47], v[24:27]
    v_exp_f32_e64 v46, v46
    v_mfma_f32_16x16x32_bf16 v[36:39], a[88:91], a[40:43], v[36:39]
    buffer_load_dwordx4 v4, s[4:7], s42 offen offset:2048 nt lds
    v_mfma_f32_16x16x32_bf16 v[36:39], a[84:87], a[36:39], v[36:39]
    v_exp_f32_e64 v47, v47
    v_mfma_f32_16x16x32_bf16 v[36:39], a[80:83], a[32:35], v[36:39]
    ds_read_b64_tr_b16 a[222:223], v15 offset:2560
    v_cvt_pk_bf16_f32 v63, v46, v47
    v_mfma_f32_16x16x32_bf16 v[40:43], a[96:99], a[32:35], v[24:27]
    v_exp_f32_e64 v32, v32
    v_mfma_f32_16x16x32_bf16 v[40:43], a[100:103], a[36:39], v[40:43]
    buffer_load_dwordx4 v4, s[4:7], s42 offen offset:3072 nt lds
    v_mfma_f32_16x16x32_bf16 v[40:43], a[104:107], a[40:43], v[40:43]
    v_exp_f32_e64 v33, v33
    v_mfma_f32_16x16x32_bf16 v[40:43], a[108:111], a[44:47], v[40:43]
    v_cvt_pk_bf16_f32 v48, v32, v33
    v_mfma_f32_16x16x32_bf16 v[44:47], a[124:127], a[44:47], v[24:27]
    s_add_u32 m0, s41, 33024
    v_exp_f32_e64 v34, v34
    v_mfma_f32_16x16x32_bf16 v[44:47], a[120:123], a[40:43], v[44:47]
    buffer_load_dwordx4 v4, s[8:11], s42 offen offset:0 nt lds
    v_mfma_f32_16x16x32_bf16 v[44:47], a[116:119], a[36:39], v[44:47]
    v_exp_f32_e64 v35, v35
    v_mfma_f32_16x16x32_bf16 v[44:47], a[112:115], a[32:35], v[44:47]
    v_cvt_pk_bf16_f32 v49, v34, v35
    v_smfmac_f32_16x16x64_bf16 a[196:199], v[8:11], v[56:63], v5
    v_mfma_f32_16x16x32_bf16 v[132:135], v[96:99], v[56:59], v[132:135]
    v_exp_f32_e64 v36, v36
    v_mfma_f32_16x16x32_bf16 v[132:135], v[104:107], v[60:63], v[132:135]
    buffer_load_dwordx4 v4, s[8:11], s42 offen offset:1024 nt lds
    v_mfma_f32_16x16x32_bf16 v[148:151], v[108:111], v[60:63], v[148:151]
    v_exp_f32_e64 v37, v37
    v_mfma_f32_16x16x32_bf16 v[148:151], v[100:103], v[56:59], v[148:151]
    v_cvt_pk_bf16_f32 v50, v36, v37
    v_mfma_f32_16x16x32_bf16 v[164:167], a[136:139], v[56:59], v[164:167]
    v_exp_f32_e64 v38, v38
    v_mfma_f32_16x16x32_bf16 v[164:167], a[168:171], v[60:63], v[164:167]
    buffer_load_dwordx4 v4, s[8:11], s42 offen offset:2048 nt lds
    v_mfma_f32_16x16x32_bf16 v[180:183], a[172:175], v[60:63], v[180:183]
    v_exp_f32_e64 v39, v39
    v_mfma_f32_16x16x32_bf16 v[180:183], a[140:143], v[56:59], v[180:183]
    v_cvt_pk_bf16_f32 v51, v38, v39
    v_mfma_f32_16x16x32_bf16 v[196:199], a[144:147], v[56:59], v[196:199]
    v_exp_f32_e64 v40, v40
    v_mfma_f32_16x16x32_bf16 v[196:199], a[176:179], v[60:63], v[196:199]
    buffer_load_dwordx4 v4, s[8:11], s42 offen offset:3072 nt lds
    v_mfma_f32_16x16x32_bf16 v[212:215], a[180:183], v[60:63], v[212:215]
    v_exp_f32_e64 v41, v41
    v_mfma_f32_16x16x32_bf16 v[212:215], a[148:151], v[56:59], v[212:215]
    v_cvt_pk_bf16_f32 v52, v40, v41
    v_mfma_f32_16x16x32_bf16 v[228:231], a[152:155], v[56:59], v[228:231]
    v_exp_f32 v42, v42
    v_mfma_f32_16x16x32_bf16 v[228:231], a[184:187], v[60:63], v[228:231]
    s_waitcnt vmcnt(10) lgkmcnt(0)
    s_barrier
    v_mfma_f32_16x16x32_bf16 v[244:247], a[188:191], v[60:63], v[244:247]
    s_add_u32 s85, s85, 0x8000
    v_exp_f32_e64 v43, v43
    v_mfma_f32_16x16x32_bf16 v[244:247], a[156:159], v[56:59], v[244:247]
    s_add_u32 m0, s81, 0
    ds_read_b64_tr_b16 a[128:129], v3 offset:0
    v_cvt_pk_bf16_f32 v53, v42, v43
    v_mfma_f32_16x16x32_bf16 v[72:75], a[216:219], a[224:227], v[72:75]
    buffer_load_dwordx4 v12, s[68:71], s85 offen lds
    v_mfma_f32_16x16x32_bf16 v[120:123], a[216:219], a[228:231], v[120:123]
    ds_read_b64_tr_b16 a[130:131], v3 offset:1024
    v_mfma_f32_16x16x32_bf16 v[124:127], a[220:223], a[228:231], v[124:127]
    ds_read_b64_tr_b16 a[160:161], v3 offset:2048
    v_mfma_f32_16x16x32_bf16 v[76:79], a[220:223], a[224:227], v[76:79]
    ds_read_b64_tr_b16 a[162:163], v3 offset:3072
    v_mfma_f32_16x16x32_bf16 v[32:35], a[64:67], a[48:51], v[28:31]
    v_exp_f32_e64 v44, v44
    v_mfma_f32_16x16x32_bf16 v[32:35], a[68:71], a[52:55], v[32:35]
    ds_read_b128 a[64:67], v2 offset:0
    v_mfma_f32_16x16x32_bf16 v[32:35], a[72:75], a[56:59], v[32:35]
    v_exp_f32_e64 v45, v45
    v_mfma_f32_16x16x32_bf16 v[32:35], a[76:79], a[60:63], v[32:35]
    ds_read_b128 a[68:71], v2 offset:256
    v_cvt_pk_bf16_f32 v54, v44, v45
    v_mfma_f32_16x16x32_bf16 v[36:39], a[92:95], a[60:63], v[28:31]
    v_exp_f32_e64 v46, v46
    v_mfma_f32_16x16x32_bf16 v[36:39], a[88:91], a[56:59], v[36:39]
    ds_read_b128 a[72:75], v2 offset:512
    v_mfma_f32_16x16x32_bf16 v[36:39], a[84:87], a[52:55], v[36:39]
    v_exp_f32_e64 v47, v47
    v_mfma_f32_16x16x32_bf16 v[36:39], a[80:83], a[48:51], v[36:39]
    ds_read_b128 a[76:79], v2 offset:768
    v_cvt_pk_bf16_f32 v55, v46, v47
    v_mfma_f32_16x16x32_bf16 v[40:43], a[96:99], a[48:51], v[28:31]
    v_exp_f32_e64 v32, v32
    v_mfma_f32_16x16x32_bf16 v[40:43], a[100:103], a[52:55], v[40:43]
    ds_read_b128 a[92:95], v2 offset:1792
    v_mfma_f32_16x16x32_bf16 v[40:43], a[104:107], a[56:59], v[40:43]
    v_exp_f32_e64 v33, v33
    v_mfma_f32_16x16x32_bf16 v[40:43], a[108:111], a[60:63], v[40:43]
    ds_read_b128 a[88:91], v2 offset:1536
    v_cvt_pk_bf16_f32 v56, v32, v33
    v_mfma_f32_16x16x32_bf16 v[44:47], a[124:127], a[60:63], v[28:31]
    v_exp_f32_e64 v34, v34
    v_mfma_f32_16x16x32_bf16 v[44:47], a[120:123], a[56:59], v[44:47]
    ds_read_b128 a[84:87], v2 offset:1280
    v_mfma_f32_16x16x32_bf16 v[44:47], a[116:119], a[52:55], v[44:47]
    v_exp_f32_e64 v35, v35
    v_mfma_f32_16x16x32_bf16 v[44:47], a[112:115], a[48:51], v[44:47]
    ds_read_b128 a[80:83], v2 offset:1024
    v_cvt_pk_bf16_f32 v57, v34, v35
    v_smfmac_f32_16x16x64_bf16 a[200:203], v[8:11], v[48:55], v5
    ds_read_b128 a[96:99], v2 offset:2048
    v_mfma_f32_16x16x32_bf16 v[136:139], v[96:99], v[48:51], v[136:139]
    v_exp_f32_e64 v36, v36
    v_mfma_f32_16x16x32_bf16 v[136:139], v[104:107], v[52:55], v[136:139]
    ds_read_b128 a[100:103], v2 offset:2304
    v_mfma_f32_16x16x32_bf16 v[152:155], v[108:111], v[52:55], v[152:155]
    v_exp_f32_e64 v37, v37
    v_mfma_f32_16x16x32_bf16 v[152:155], v[100:103], v[48:51], v[152:155]
    ds_read_b128 a[104:107], v2 offset:2560
    v_cvt_pk_bf16_f32 v58, v36, v37
    v_mfma_f32_16x16x32_bf16 v[168:171], a[136:139], v[48:51], v[168:171]
    v_exp_f32_e64 v38, v38
    v_mfma_f32_16x16x32_bf16 v[168:171], a[168:171], v[52:55], v[168:171]
    ds_read_b128 a[108:111], v2 offset:2816
    v_mfma_f32_16x16x32_bf16 v[184:187], a[172:175], v[52:55], v[184:187]
    v_exp_f32_e64 v39, v39
    v_mfma_f32_16x16x32_bf16 v[184:187], a[140:143], v[48:51], v[184:187]
    ds_read_b128 a[124:127], v2 offset:3840
    v_cvt_pk_bf16_f32 v59, v38, v39
    v_mfma_f32_16x16x32_bf16 v[200:203], a[144:147], v[48:51], v[200:203]
    v_exp_f32_e64 v40, v40
    v_mfma_f32_16x16x32_bf16 v[200:203], a[176:179], v[52:55], v[200:203]
    ds_read_b128 a[120:123], v2 offset:3584
    v_mfma_f32_16x16x32_bf16 v[216:219], a[180:183], v[52:55], v[216:219]
    v_exp_f32_e64 v41, v41
    v_mfma_f32_16x16x32_bf16 v[216:219], a[148:151], v[48:51], v[216:219]
    ds_read_b128 a[116:119], v2 offset:3328
    v_cvt_pk_bf16_f32 v60, v40, v41
    v_mfma_f32_16x16x32_bf16 v[232:235], a[152:155], v[48:51], v[232:235]
    v_exp_f32_e64 v42, v42
    v_mfma_f32_16x16x32_bf16 v[232:235], a[184:187], v[52:55], v[232:235]
    ds_read_b128 a[112:115], v2 offset:3072
    v_mfma_f32_16x16x32_bf16 v[248:251], a[188:191], v[52:55], v[248:251]
    v_exp_f32 v43, v43
    v_mfma_f32_16x16x32_bf16 v[248:251], a[156:159], v[48:51], v[248:251]
    s_waitcnt lgkmcnt(3)
    ds_read_b64_tr_b16 a[164:165], v3 offset:2080
    v_cvt_pk_bf16_f32 v61, v42, v43
    v_mfma_f32_16x16x32_bf16 v[32:35], a[64:67], a[0:3], v[16:19]
    s_add_u32 s86, s86, 0x1000
    v_exp_f32_e64 v44, v44
    v_mfma_f32_16x16x32_bf16 v[32:35], a[68:71], a[4:7], v[32:35]
    buffer_load_dwordx4 a[224:227], v13, s[12:15], s86 offen sc1
    v_mfma_f32_16x16x32_bf16 v[32:35], a[72:75], a[8:11], v[32:35]
    v_exp_f32_e64 v45, v45
    v_mfma_f32_16x16x32_bf16 v[32:35], a[76:79], a[12:15], v[32:35]
    ds_read_b64_tr_b16 a[208:209], v14 offset:8192
    v_cvt_pk_bf16_f32 v62, v44, v45
    v_mfma_f32_16x16x32_bf16 v[36:39], a[92:95], a[12:15], v[16:19]
    s_add_u32 s95, s86, s94
    v_exp_f32 v46, v46
    v_mfma_f32_16x16x32_bf16 v[36:39], a[88:91], a[8:11], v[36:39]
    buffer_load_dwordx4 a[228:231], v13, s[12:15], s95 offen sc1
    v_mfma_f32_16x16x32_bf16 v[36:39], a[84:87], a[4:7], v[36:39]
    v_exp_f32_e64 v47, v47
    v_mfma_f32_16x16x32_bf16 v[36:39], a[80:83], a[0:3], v[36:39]
    ds_read_b64_tr_b16 a[210:211], v14 offset:10240
    v_cvt_pk_bf16_f32 v63, v46, v47
    v_mfma_f32_16x16x32_bf16 v[40:43], a[96:99], a[0:3], v[16:19]
    v_exp_f32_e64 v32, v32
    v_mfma_f32_16x16x32_bf16 v[40:43], a[100:103], a[4:7], v[40:43]
    ds_read_b64_tr_b16 a[212:213], v15 offset:8192
    v_mfma_f32_16x16x32_bf16 v[40:43], a[104:107], a[8:11], v[40:43]
    v_exp_f32_e64 v33, v33
    v_mfma_f32_16x16x32_bf16 v[40:43], a[108:111], a[12:15], v[40:43]
    ds_read_b64_tr_b16 a[214:215], v15 offset:10240
    v_cvt_pk_bf16_f32 v48, v32, v33
    v_mfma_f32_16x16x32_bf16 v[44:47], a[124:127], a[12:15], v[16:19]
    s_waitcnt lgkmcnt(3)
    v_exp_f32 v34, v34
    v_mfma_f32_16x16x32_bf16 v[44:47], a[120:123], a[8:11], v[44:47]
    ds_read_b64_tr_b16 a[166:167], v3 offset:3104
    v_mfma_f32_16x16x32_bf16 v[44:47], a[116:119], a[4:7], v[44:47]
    v_exp_f32_e64 v35, v35
    v_mfma_f32_16x16x32_bf16 v[44:47], a[112:115], a[0:3], v[44:47]
    ds_read_b64_tr_b16 a[132:133], v3 offset:32
    v_cvt_pk_bf16_f32 v49, v34, v35
    v_smfmac_f32_16x16x64_bf16 a[204:207], v[8:11], v[56:63], v5
    ds_read_b64_tr_b16 a[134:135], v3 offset:1056
    v_mfma_f32_16x16x32_bf16 v[140:143], v[96:99], v[56:59], v[140:143]
    v_exp_f32_e64 v36, v36
    v_mfma_f32_16x16x32_bf16 v[140:143], v[104:107], v[60:63], v[140:143]
    ds_read_b64_tr_b16 a[216:217], v14 offset:8704
    v_mfma_f32_16x16x32_bf16 v[156:159], v[108:111], v[60:63], v[156:159]
    v_exp_f32_e64 v37, v37
    v_mfma_f32_16x16x32_bf16 v[156:159], v[100:103], v[56:59], v[156:159]
    ds_read_b64_tr_b16 a[218:219], v14 offset:10752
    v_cvt_pk_bf16_f32 v50, v36, v37
    v_mfma_f32_16x16x32_bf16 v[172:175], a[136:139], v[56:59], v[172:175]
    v_exp_f32_e64 v38, v38
    v_mfma_f32_16x16x32_bf16 v[172:175], a[168:171], v[60:63], v[172:175]
    ds_read_b64_tr_b16 a[136:137], v3 offset:256
    v_mfma_f32_16x16x32_bf16 v[188:191], a[172:175], v[60:63], v[188:191]
    v_exp_f32_e64 v39, v39
    v_mfma_f32_16x16x32_bf16 v[188:191], a[140:143], v[56:59], v[188:191]
    ds_read_b64_tr_b16 a[138:139], v3 offset:1280
    v_cvt_pk_bf16_f32 v51, v38, v39
    v_mfma_f32_16x16x32_bf16 v[204:207], a[144:147], v[56:59], v[204:207]
    v_exp_f32_e64 v40, v40
    v_mfma_f32_16x16x32_bf16 v[204:207], a[176:179], v[60:63], v[204:207]
    ds_read_b64_tr_b16 a[168:169], v3 offset:2304
    v_mfma_f32_16x16x32_bf16 v[220:223], a[180:183], v[60:63], v[220:223]
    v_exp_f32_e64 v41, v41
    v_mfma_f32_16x16x32_bf16 v[220:223], a[148:151], v[56:59], v[220:223]
    ds_read_b64_tr_b16 a[170:171], v3 offset:3328
    v_cvt_pk_bf16_f32 v52, v40, v41
    v_mfma_f32_16x16x32_bf16 v[236:239], a[152:155], v[56:59], v[236:239]
    v_exp_f32_e64 v42, v42
    v_mfma_f32_16x16x32_bf16 v[236:239], a[184:187], v[60:63], v[236:239]
    ds_read_b64_tr_b16 a[172:173], v3 offset:2336
    v_mfma_f32_16x16x32_bf16 v[252:255], a[188:191], v[60:63], v[252:255]
    v_exp_f32_e64 v43, v43
    v_mfma_f32_16x16x32_bf16 v[252:255], a[156:159], v[56:59], v[252:255]
    ds_read_b64_tr_b16 a[174:175], v3 offset:3360
    v_cvt_pk_bf16_f32 v53, v42, v43
    v_mfma_f32_16x16x32_bf16 v[32:35], a[64:67], a[16:19], v[20:23]
    v_exp_f32_e64 v44, v44
    v_mfma_f32_16x16x32_bf16 v[32:35], a[68:71], a[20:23], v[32:35]
    ds_read_b64_tr_b16 a[140:141], v3 offset:288
    v_mfma_f32_16x16x32_bf16 v[32:35], a[72:75], a[24:27], v[32:35]
    v_exp_f32_e64 v45, v45
    v_mfma_f32_16x16x32_bf16 v[32:35], a[76:79], a[28:31], v[32:35]
    ds_read_b64_tr_b16 a[142:143], v3 offset:1312
    v_cvt_pk_bf16_f32 v54, v44, v45
    v_mfma_f32_16x16x32_bf16 v[36:39], a[92:95], a[28:31], v[20:23]
    v_exp_f32_e64 v46, v46
    v_mfma_f32_16x16x32_bf16 v[36:39], a[88:91], a[24:27], v[36:39]
    ds_read_b64_tr_b16 a[144:145], v3 offset:512
    v_mfma_f32_16x16x32_bf16 v[36:39], a[84:87], a[20:23], v[36:39]
    v_exp_f32_e64 v47, v47
    v_mfma_f32_16x16x32_bf16 v[36:39], a[80:83], a[16:19], v[36:39]
    ds_read_b64_tr_b16 a[146:147], v3 offset:1536
    v_cvt_pk_bf16_f32 v55, v46, v47
    v_mfma_f32_16x16x32_bf16 v[40:43], a[96:99], a[16:19], v[20:23]
    v_exp_f32_e64 v32, v32
    v_mfma_f32_16x16x32_bf16 v[40:43], a[100:103], a[20:23], v[40:43]
    ds_read_b64_tr_b16 a[176:177], v3 offset:2560
    v_mfma_f32_16x16x32_bf16 v[40:43], a[104:107], a[24:27], v[40:43]
    v_exp_f32_e64 v33, v33
    v_mfma_f32_16x16x32_bf16 v[40:43], a[108:111], a[28:31], v[40:43]
    ds_read_b64_tr_b16 a[178:179], v3 offset:3584
    v_cvt_pk_bf16_f32 v56, v32, v33
    v_mfma_f32_16x16x32_bf16 v[44:47], a[124:127], a[28:31], v[20:23]
    v_exp_f32_e64 v34, v34
    v_mfma_f32_16x16x32_bf16 v[44:47], a[120:123], a[24:27], v[44:47]
    ds_read_b64_tr_b16 a[180:181], v3 offset:2592
    v_mfma_f32_16x16x32_bf16 v[44:47], a[116:119], a[20:23], v[44:47]
    v_exp_f32 v35, v35
    v_mfma_f32_16x16x32_bf16 v[44:47], a[112:115], a[16:19], v[44:47]
L_hop6:
    s_cbranch_execz L_hop_back
    ds_read_b64_tr_b16 a[182:183], v3 offset:3616
    v_cvt_pk_bf16_f32 v57, v34, v35
    v_smfmac_f32_16x16x64_bf16 a[192:195], v[8:11], v[48:55], v5
    s_waitcnt vmcnt(12) lgkmcnt(3)
    ds_read_b64_tr_b16 a[148:149], v3 offset:544
    v_mfma_f32_16x16x32_bf16 v[64:67], a[208:211], a[232:235], v[64:67]
    s_waitcnt vmcnt(11)
    ds_read_b64_tr_b16 a[150:151], v3 offset:1568
    v_mfma_f32_16x16x32_bf16 v[112:115], a[208:211], a[236:239], v[112:115]
    ds_read_b64_tr_b16 a[152:153], v3 offset:768
    v_mfma_f32_16x16x32_bf16 v[116:119], a[212:215], a[236:239], v[116:119]
    ds_read_b64_tr_b16 a[154:155], v3 offset:1792
    v_mfma_f32_16x16x32_bf16 v[68:71], a[212:215], a[232:235], v[68:71]
    ds_read_b64_tr_b16 a[184:185], v3 offset:2816
    v_mfma_f32_16x16x32_bf16 v[128:131], a[128:131], v[48:51], v[128:131]
    v_exp_f32_e64 v36, v36
    v_mfma_f32_16x16x32_bf16 v[128:131], a[160:163], v[52:55], v[128:131]
    ds_read_b64_tr_b16 a[186:187], v3 offset:3840
    v_mfma_f32_16x16x32_bf16 v[144:147], a[164:167], v[52:55], v[144:147]
    v_exp_f32_e64 v37, v37
    v_mfma_f32_16x16x32_bf16 v[144:147], a[132:135], v[48:51], v[144:147]
    ds_read_b64_tr_b16 a[188:189], v3 offset:2848
    v_cvt_pk_bf16_f32 v58, v36, v37
    v_mfma_f32_16x16x32_bf16 v[160:163], a[136:139], v[48:51], v[160:163]
    v_exp_f32_e64 v38, v38
    v_mfma_f32_16x16x32_bf16 v[160:163], a[168:171], v[52:55], v[160:163]
    ds_read_b64_tr_b16 a[190:191], v3 offset:3872
    v_mfma_f32_16x16x32_bf16 v[176:179], a[172:175], v[52:55], v[176:179]
    v_exp_f32_e64 v39, v39
    v_mfma_f32_16x16x32_bf16 v[176:179], a[140:143], v[48:51], v[176:179]
    ds_read_b64_tr_b16 a[156:157], v3 offset:800
    v_cvt_pk_bf16_f32 v59, v38, v39
    v_mfma_f32_16x16x32_bf16 v[192:195], a[144:147], v[48:51], v[192:195]
    s_waitcnt lgkmcnt(3)
    v_exp_f32 v40, v40
    v_mfma_f32_16x16x32_bf16 v[192:195], a[176:179], v[52:55], v[192:195]
    ds_read_b64_tr_b16 a[158:159], v3 offset:1824
    v_mfma_f32_16x16x32_bf16 v[208:211], a[180:183], v[52:55], v[208:211]
    v_exp_f32_e64 v41, v41
    v_mfma_f32_16x16x32_bf16 v[208:211], a[148:151], v[48:51], v[208:211]
    s_add_u32 s42, s42, 0x4000
    ds_read_b64_tr_b16 a[220:221], v15 offset:8704
    v_cvt_pk_bf16_f32 v60, v40, v41
    v_mfma_f32_16x16x32_bf16 v[224:227], a[152:155], v[48:51], v[224:227]
    s_add_u32 m0, s40, 49248
    v_exp_f32 v42, v42
    v_mfma_f32_16x16x32_bf16 v[224:227], a[184:187], v[52:55], v[224:227]
    s_waitcnt lgkmcnt(3)
    buffer_load_dwordx4 v4, s[4:7], s42 offen offset:0 nt lds
    v_mfma_f32_16x16x32_bf16 v[240:243], a[188:191], v[52:55], v[240:243]
    s_waitcnt lgkmcnt(1)
    v_exp_f32 v43, v43
    v_mfma_f32_16x16x32_bf16 v[240:243], a[156:159], v[48:51], v[240:243]
    ds_read_b64_tr_b16 a[222:223], v15 offset:10752
    v_cvt_pk_bf16_f32 v61, v42, v43
    v_mfma_f32_16x16x32_bf16 v[32:35], a[64:67], a[32:35], v[24:27]
    v_exp_f32_e64 v44, v44
    v_mfma_f32_16x16x32_bf16 v[32:35], a[68:71], a[36:39], v[32:35]
    buffer_load_dwordx4 v4, s[4:7], s42 offen offset:1024 nt lds
    v_mfma_f32_16x16x32_bf16 v[32:35], a[72:75], a[40:43], v[32:35]
    v_exp_f32_e64 v45, v45
    v_mfma_f32_16x16x32_bf16 v[32:35], a[76:79], a[44:47], v[32:35]
    v_cvt_pk_bf16_f32 v62, v44, v45
    v_mfma_f32_16x16x32_bf16 v[36:39], a[92:95], a[44:47], v[24:27]
    v_exp_f32_e64 v46, v46
    v_mfma_f32_16x16x32_bf16 v[36:39], a[88:91], a[40:43], v[36:39]
    buffer_load_dwordx4 v4, s[4:7], s42 offen offset:2048 nt lds
    v_mfma_f32_16x16x32_bf16 v[36:39], a[84:87], a[36:39], v[36:39]
    v_exp_f32_e64 v47, v47
    v_mfma_f32_16x16x32_bf16 v[36:39], a[80:83], a[32:35], v[36:39]
    v_cvt_pk_bf16_f32 v63, v46, v47
    v_mfma_f32_16x16x32_bf16 v[40:43], a[96:99], a[32:35], v[24:27]
    v_exp_f32_e64 v32, v32
    v_mfma_f32_16x16x32_bf16 v[40:43], a[100:103], a[36:39], v[40:43]
    buffer_load_dwordx4 v4, s[4:7], s42 offen offset:3072 nt lds
    v_mfma_f32_16x16x32_bf16 v[40:43], a[104:107], a[40:43], v[40:43]
    v_exp_f32_e64 v33, v33
    v_mfma_f32_16x16x32_bf16 v[40:43], a[108:111], a[44:47], v[40:43]
    v_cvt_pk_bf16_f32 v48, v32, v33
    v_mfma_f32_16x16x32_bf16 v[44:47], a[124:127], a[44:47], v[24:27]
    s_add_u32 m0, s41, 49536
    v_exp_f32 v34, v34
    v_mfma_f32_16x16x32_bf16 v[44:47], a[120:123], a[40:43], v[44:47]
    s_sub_u32 s43, s43, 1
    buffer_load_dwordx4 v4, s[8:11], s42 offen offset:0 nt lds
    v_mfma_f32_16x16x32_bf16 v[44:47], a[116:119], a[36:39], v[44:47]
    s_cmp_lg_u32 s43, 0
    v_exp_f32 v35, v35
    v_mfma_f32_16x16x32_bf16 v[44:47], a[112:115], a[32:35], v[44:47]
    v_cvt_pk_bf16_f32 v49, v34, v35
    v_smfmac_f32_16x16x64_bf16 a[196:199], v[8:11], v[56:63], v5
    v_mfma_f32_16x16x32_bf16 v[132:135], a[128:131], v[56:59], v[132:135]
    v_exp_f32_e64 v36, v36
    v_mfma_f32_16x16x32_bf16 v[132:135], a[160:163], v[60:63], v[132:135]
    buffer_load_dwordx4 v4, s[8:11], s42 offen offset:1024 nt lds
    v_mfma_f32_16x16x32_bf16 v[148:151], a[164:167], v[60:63], v[148:151]
    v_exp_f32_e64 v37, v37
    v_mfma_f32_16x16x32_bf16 v[148:151], a[132:135], v[56:59], v[148:151]
    v_cvt_pk_bf16_f32 v50, v36, v37
    v_mfma_f32_16x16x32_bf16 v[164:167], a[136:139], v[56:59], v[164:167]
    v_exp_f32_e64 v38, v38
    v_mfma_f32_16x16x32_bf16 v[164:167], a[168:171], v[60:63], v[164:167]
    buffer_load_dwordx4 v4, s[8:11], s42 offen offset:2048 nt lds
    v_mfma_f32_16x16x32_bf16 v[180:183], a[172:175], v[60:63], v[180:183]
    v_exp_f32_e64 v39, v39
    v_mfma_f32_16x16x32_bf16 v[180:183], a[140:143], v[56:59], v[180:183]
    v_cvt_pk_bf16_f32 v51, v38, v39
    v_mfma_f32_16x16x32_bf16 v[196:199], a[144:147], v[56:59], v[196:199]
    v_exp_f32_e64 v40, v40
    v_mfma_f32_16x16x32_bf16 v[196:199], a[176:179], v[60:63], v[196:199]
    buffer_load_dwordx4 v4, s[8:11], s42 offen offset:3072 nt lds
    v_mfma_f32_16x16x32_bf16 v[212:215], a[180:183], v[60:63], v[212:215]
    v_exp_f32_e64 v41, v41
    v_mfma_f32_16x16x32_bf16 v[212:215], a[148:151], v[56:59], v[212:215]
    v_cvt_pk_bf16_f32 v52, v40, v41
    v_mfma_f32_16x16x32_bf16 v[228:231], a[152:155], v[56:59], v[228:231]
    v_exp_f32 v42, v42
    v_mfma_f32_16x16x32_bf16 v[228:231], a[184:187], v[60:63], v[228:231]
    s_waitcnt vmcnt(10) lgkmcnt(0)
    s_barrier
    v_mfma_f32_16x16x32_bf16 v[244:247], a[188:191], v[60:63], v[244:247]
    v_exp_f32 v43, v43
    v_mfma_f32_16x16x32_bf16 v[244:247], a[156:159], v[56:59], v[244:247]
    ds_read_b64_tr_b16 v[96:97], v3 offset:16512
    v_cvt_pk_bf16_f32 v53, v42, v43
    v_mfma_f32_16x16x32_bf16 v[72:75], a[216:219], a[232:235], v[72:75]
    ds_read_b64_tr_b16 v[98:99], v3 offset:17536
    v_mfma_f32_16x16x32_bf16 v[120:123], a[216:219], a[236:239], v[120:123]
    ds_read_b64_tr_b16 v[104:105], v3 offset:18560
    v_mfma_f32_16x16x32_bf16 v[124:127], a[220:223], a[236:239], v[124:127]
    ds_read_b64_tr_b16 v[106:107], v3 offset:19584
    v_mfma_f32_16x16x32_bf16 v[76:79], a[220:223], a[232:235], v[76:79]
    ds_read_b64_tr_b16 v[108:109], v3 offset:18592
    v_mfma_f32_16x16x32_bf16 v[32:35], a[64:67], a[48:51], v[28:31]
    v_exp_f32_e64 v44, v44
    v_mfma_f32_16x16x32_bf16 v[32:35], a[68:71], a[52:55], v[32:35]
    ds_read_b128 a[64:67], v2 offset:16416
    v_mfma_f32_16x16x32_bf16 v[32:35], a[72:75], a[56:59], v[32:35]
    v_exp_f32_e64 v45, v45
    v_mfma_f32_16x16x32_bf16 v[32:35], a[76:79], a[60:63], v[32:35]
    ds_read_b128 a[68:71], v2 offset:16672
    v_cvt_pk_bf16_f32 v54, v44, v45
    v_mfma_f32_16x16x32_bf16 v[36:39], a[92:95], a[60:63], v[28:31]
    v_exp_f32_e64 v46, v46
    v_mfma_f32_16x16x32_bf16 v[36:39], a[88:91], a[56:59], v[36:39]
    ds_read_b128 a[72:75], v2 offset:16928
    v_mfma_f32_16x16x32_bf16 v[36:39], a[84:87], a[52:55], v[36:39]
    v_exp_f32_e64 v47, v47
    v_mfma_f32_16x16x32_bf16 v[36:39], a[80:83], a[48:51], v[36:39]
    ds_read_b128 a[76:79], v2 offset:17184
    v_cvt_pk_bf16_f32 v55, v46, v47
    v_mfma_f32_16x16x32_bf16 v[40:43], a[96:99], a[48:51], v[28:31]
    v_exp_f32_e64 v32, v32
    v_mfma_f32_16x16x32_bf16 v[40:43], a[100:103], a[52:55], v[40:43]
    ds_read_b128 a[92:95], v2 offset:18208
    v_mfma_f32_16x16x32_bf16 v[40:43], a[104:107], a[56:59], v[40:43]
    v_exp_f32_e64 v33, v33
    v_mfma_f32_16x16x32_bf16 v[40:43], a[108:111], a[60:63], v[40:43]
    ds_read_b128 a[88:91], v2 offset:17952
    v_cvt_pk_bf16_f32 v56, v32, v33
    v_mfma_f32_16x16x32_bf16 v[44:47], a[124:127], a[60:63], v[28:31]
    v_exp_f32_e64 v34, v34
    v_mfma_f32_16x16x32_bf16 v[44:47], a[120:123], a[56:59], v[44:47]
    ds_read_b128 a[84:87], v2 offset:17696
    v_mfma_f32_16x16x32_bf16 v[44:47], a[116:119], a[52:55], v[44:47]
    v_exp_f32_e64 v35, v35
    v_mfma_f32_16x16x32_bf16 v[44:47], a[112:115], a[48:51], v[44:47]
    ds_read_b128 a[80:83], v2 offset:17440
    v_cvt_pk_bf16_f32 v57, v34, v35
    v_smfmac_f32_16x16x64_bf16 a[200:203], v[8:11], v[48:55], v5
    ds_read_b128 a[96:99], v2 offset:18464
    v_mfma_f32_16x16x32_bf16 v[136:139], a[128:131], v[48:51], v[136:139]
    v_exp_f32_e64 v36, v36
    v_mfma_f32_16x16x32_bf16 v[136:139], a[160:163], v[52:55], v[136:139]
    ds_read_b128 a[100:103], v2 offset:18720
    v_mfma_f32_16x16x32_bf16 v[152:155], a[164:167], v[52:55], v[152:155]
    v_exp_f32_e64 v37, v37
    v_mfma_f32_16x16x32_bf16 v[152:155], a[132:135], v[48:51], v[152:155]
    ds_read_b128 a[104:107], v2 offset:18976
    v_cvt_pk_bf16_f32 v58, v36, v37
    v_mfma_f32_16x16x32_bf16 v[168:171], a[136:139], v[48:51], v[168:171]
    v_exp_f32_e64 v38, v38
    v_mfma_f32_16x16x32_bf16 v[168:171], a[168:171], v[52:55], v[168:171]
    ds_read_b128 a[108:111], v2 offset:19232
    v_mfma_f32_16x16x32_bf16 v[184:187], a[172:175], v[52:55], v[184:187]
    v_exp_f32_e64 v39, v39
    v_mfma_f32_16x16x32_bf16 v[184:187], a[140:143], v[48:51], v[184:187]
    ds_read_b128 a[124:127], v2 offset:20256
    v_cvt_pk_bf16_f32 v59, v38, v39
    v_mfma_f32_16x16x32_bf16 v[200:203], a[144:147], v[48:51], v[200:203]
    v_exp_f32_e64 v40, v40
    v_mfma_f32_16x16x32_bf16 v[200:203], a[176:179], v[52:55], v[200:203]
    ds_read_b128 a[120:123], v2 offset:20000
    v_mfma_f32_16x16x32_bf16 v[216:219], a[180:183], v[52:55], v[216:219]
    v_exp_f32_e64 v41, v41
    v_mfma_f32_16x16x32_bf16 v[216:219], a[148:151], v[48:51], v[216:219]
    ds_read_b128 a[116:119], v2 offset:19744
    v_cvt_pk_bf16_f32 v60, v40, v41
    v_mfma_f32_16x16x32_bf16 v[232:235], a[152:155], v[48:51], v[232:235]
    v_exp_f32_e64 v42, v42
    v_mfma_f32_16x16x32_bf16 v[232:235], a[184:187], v[52:55], v[232:235]
    ds_read_b128 a[112:115], v2 offset:19488
    v_mfma_f32_16x16x32_bf16 v[248:251], a[188:191], v[52:55], v[248:251]
    v_exp_f32 v43, v43
    v_mfma_f32_16x16x32_bf16 v[248:251], a[156:159], v[48:51], v[248:251]
    s_waitcnt lgkmcnt(3)
    ds_read_b64_tr_b16 v[110:111], v3 offset:19616
    v_cvt_pk_bf16_f32 v61, v42, v43
    v_mfma_f32_16x16x32_bf16 v[32:35], a[64:67], a[0:3], v[16:19]
    v_exp_f32_e64 v44, v44
    v_mfma_f32_16x16x32_bf16 v[32:35], a[68:71], a[4:7], v[32:35]
    global_load_dword v6, v94, s[90:91]
    v_mfma_f32_16x16x32_bf16 v[32:35], a[72:75], a[8:11], v[32:35]
    v_exp_f32_e64 v45, v45
    v_mfma_f32_16x16x32_bf16 v[32:35], a[76:79], a[12:15], v[32:35]
    ds_read_b64_tr_b16 a[208:209], v14 offset:0
    v_cvt_pk_bf16_f32 v62, v44, v45
    v_mfma_f32_16x16x32_bf16 v[36:39], a[92:95], a[12:15], v[16:19]
    v_exp_f32_e64 v46, v46
    v_mfma_f32_16x16x32_bf16 v[36:39], a[88:91], a[8:11], v[36:39]
    ds_read_b64_tr_b16 a[210:211], v14 offset:2048
    v_mfma_f32_16x16x32_bf16 v[36:39], a[84:87], a[4:7], v[36:39]
    v_exp_f32_e64 v47, v47
    v_mfma_f32_16x16x32_bf16 v[36:39], a[80:83], a[0:3], v[36:39]
    ds_read_b64_tr_b16 a[212:213], v15 offset:0
    v_cvt_pk_bf16_f32 v63, v46, v47
    v_mfma_f32_16x16x32_bf16 v[40:43], a[96:99], a[0:3], v[16:19]
    v_exp_f32_e64 v32, v32
    v_mfma_f32_16x16x32_bf16 v[40:43], a[100:103], a[4:7], v[40:43]
    ds_read_b64_tr_b16 a[214:215], v15 offset:2048
    v_mfma_f32_16x16x32_bf16 v[40:43], a[104:107], a[8:11], v[40:43]
    v_exp_f32_e64 v33, v33
    v_mfma_f32_16x16x32_bf16 v[40:43], a[108:111], a[12:15], v[40:43]
    ds_read_b64_tr_b16 v[100:101], v3 offset:16544
    v_cvt_pk_bf16_f32 v48, v32, v33
    v_mfma_f32_16x16x32_bf16 v[44:47], a[124:127], a[12:15], v[16:19]
    s_waitcnt lgkmcnt(3)
    v_exp_f32 v34, v34
    v_mfma_f32_16x16x32_bf16 v[44:47], a[120:123], a[8:11], v[44:47]
    ds_read_b64_tr_b16 v[102:103], v3 offset:17568
    v_mfma_f32_16x16x32_bf16 v[44:47], a[116:119], a[4:7], v[44:47]
    v_exp_f32_e64 v35, v35
    v_mfma_f32_16x16x32_bf16 v[44:47], a[112:115], a[0:3], v[44:47]
    ds_read_b64_tr_b16 a[216:217], v14 offset:512
    v_cvt_pk_bf16_f32 v49, v34, v35
    v_smfmac_f32_16x16x64_bf16 a[204:207], v[8:11], v[56:63], v5
    ds_read_b64_tr_b16 a[218:219], v14 offset:2560
    v_mfma_f32_16x16x32_bf16 v[140:143], a[128:131], v[56:59], v[140:143]
    v_exp_f32_e64 v36, v36
    v_mfma_f32_16x16x32_bf16 v[140:143], a[160:163], v[60:63], v[140:143]
    ds_read_b64_tr_b16 a[220:221], v15 offset:512
    v_mfma_f32_16x16x32_bf16 v[156:159], a[164:167], v[60:63], v[156:159]
    v_exp_f32_e64 v37, v37
    v_mfma_f32_16x16x32_bf16 v[156:159], a[132:135], v[56:59], v[156:159]
    ds_read_b64_tr_b16 a[222:223], v15 offset:2560
    v_cvt_pk_bf16_f32 v50, v36, v37
    v_mfma_f32_16x16x32_bf16 v[172:175], a[136:139], v[56:59], v[172:175]
    v_exp_f32_e64 v38, v38
    v_mfma_f32_16x16x32_bf16 v[172:175], a[168:171], v[60:63], v[172:175]
    ds_read_b64_tr_b16 a[136:137], v3 offset:16768
    v_mfma_f32_16x16x32_bf16 v[188:191], a[172:175], v[60:63], v[188:191]
    v_exp_f32_e64 v39, v39
    v_mfma_f32_16x16x32_bf16 v[188:191], a[140:143], v[56:59], v[188:191]
    ds_read_b64_tr_b16 a[138:139], v3 offset:17792
    v_cvt_pk_bf16_f32 v51, v38, v39
    v_mfma_f32_16x16x32_bf16 v[204:207], a[144:147], v[56:59], v[204:207]
    v_exp_f32_e64 v40, v40
    v_mfma_f32_16x16x32_bf16 v[204:207], a[176:179], v[60:63], v[204:207]
    ds_read_b64_tr_b16 a[168:169], v3 offset:18816
    v_mfma_f32_16x16x32_bf16 v[220:223], a[180:183], v[60:63], v[220:223]
    v_exp_f32_e64 v41, v41
    v_mfma_f32_16x16x32_bf16 v[220:223], a[148:151], v[56:59], v[220:223]
    ds_read_b64_tr_b16 a[170:171], v3 offset:19840
    v_cvt_pk_bf16_f32 v52, v40, v41
    v_mfma_f32_16x16x32_bf16 v[236:239], a[152:155], v[56:59], v[236:239]
    v_exp_f32_e64 v42, v42
    v_mfma_f32_16x16x32_bf16 v[236:239], a[184:187], v[60:63], v[236:239]
    ds_read_b64_tr_b16 a[172:173], v3 offset:18848
    v_mfma_f32_16x16x32_bf16 v[252:255], a[188:191], v[60:63], v[252:255]
    v_exp_f32_e64 v43, v43
    v_mfma_f32_16x16x32_bf16 v[252:255], a[156:159], v[56:59], v[252:255]
    ds_read_b64_tr_b16 a[174:175], v3 offset:19872
    v_cvt_pk_bf16_f32 v53, v42, v43
    s_cbranch_scc1 L_loop
L_loop_end:
    v_mfma_f32_16x16x32_bf16 v[32:35], a[64:67], a[16:19], v[20:23]
    ds_read_b64_tr_b16 a[156:157], v3 offset:17312
    v_exp_f32 v44, v44
    v_mfma_f32_16x16x32_bf16 v[32:35], a[68:71], a[20:23], v[32:35]
    ds_read_b64_tr_b16 a[140:141], v3 offset:16800
    v_mfma_f32_16x16x32_bf16 v[32:35], a[72:75], a[24:27], v[32:35]
    v_exp_f32_e64 v45, v45
    v_mfma_f32_16x16x32_bf16 v[32:35], a[76:79], a[28:31], v[32:35]
    ds_read_b64_tr_b16 a[142:143], v3 offset:17824
    v_cvt_pk_bf16_f32 v54, v44, v45
    v_mfma_f32_16x16x32_bf16 v[36:39], a[92:95], a[28:31], v[20:23]
    v_exp_f32_e64 v46, v46
    v_mfma_f32_16x16x32_bf16 v[36:39], a[88:91], a[24:27], v[36:39]
    ds_read_b64_tr_b16 a[144:145], v3 offset:17024
    v_mfma_f32_16x16x32_bf16 v[36:39], a[84:87], a[20:23], v[36:39]
    v_exp_f32_e64 v47, v47
    v_mfma_f32_16x16x32_bf16 v[36:39], a[80:83], a[16:19], v[36:39]
    ds_read_b64_tr_b16 a[146:147], v3 offset:18048
    v_cvt_pk_bf16_f32 v55, v46, v47
    v_mfma_f32_16x16x32_bf16 v[40:43], a[96:99], a[16:19], v[20:23]
    v_exp_f32_e64 v32, v32
    v_mfma_f32_16x16x32_bf16 v[40:43], a[100:103], a[20:23], v[40:43]
    ds_read_b64_tr_b16 a[176:177], v3 offset:19072
    v_mfma_f32_16x16x32_bf16 v[40:43], a[104:107], a[24:27], v[40:43]
    v_exp_f32_e64 v33, v33
    v_mfma_f32_16x16x32_bf16 v[40:43], a[108:111], a[28:31], v[40:43]
    ds_read_b64_tr_b16 a[178:179], v3 offset:20096
    v_cvt_pk_bf16_f32 v56, v32, v33
    v_mfma_f32_16x16x32_bf16 v[44:47], a[124:127], a[28:31], v[20:23]
    v_exp_f32_e64 v34, v34
    v_mfma_f32_16x16x32_bf16 v[44:47], a[120:123], a[24:27], v[44:47]
    ds_read_b64_tr_b16 a[180:181], v3 offset:19104
    v_mfma_f32_16x16x32_bf16 v[44:47], a[116:119], a[20:23], v[44:47]
    v_exp_f32_e64 v35, v35
    v_mfma_f32_16x16x32_bf16 v[44:47], a[112:115], a[16:19], v[44:47]
    ds_read_b64_tr_b16 a[182:183], v3 offset:20128
    v_cvt_pk_bf16_f32 v57, v34, v35
    v_smfmac_f32_16x16x64_bf16 a[192:195], v[8:11], v[48:55], v5
    s_waitcnt vmcnt(10)
    ds_read_b64_tr_b16 a[148:149], v3 offset:17056
    v_mfma_f32_16x16x32_bf16 v[64:67], a[208:211], a[224:227], v[64:67]
    s_waitcnt vmcnt(9)
    ds_read_b64_tr_b16 a[150:151], v3 offset:18080
    v_mfma_f32_16x16x32_bf16 v[112:115], a[208:211], a[228:231], v[112:115]
    s_waitcnt lgkmcnt(4)
    ds_read_b64_tr_b16 a[152:153], v3 offset:17280
    v_mfma_f32_16x16x32_bf16 v[116:119], a[212:215], a[228:231], v[116:119]
    ds_read_b64_tr_b16 a[154:155], v3 offset:18304
    v_mfma_f32_16x16x32_bf16 v[68:71], a[212:215], a[224:227], v[68:71]
    ds_read_b64_tr_b16 a[184:185], v3 offset:19328
    v_mfma_f32_16x16x32_bf16 v[128:131], v[96:99], v[48:51], v[128:131]
    v_exp_f32 v36, v36
    v_mfma_f32_16x16x32_bf16 v[128:131], v[104:107], v[52:55], v[128:131]
    ds_read_b64_tr_b16 a[186:187], v3 offset:20352
    v_mfma_f32_16x16x32_bf16 v[144:147], v[108:111], v[52:55], v[144:147]
    v_exp_f32_e64 v37, v37
    v_mfma_f32_16x16x32_bf16 v[144:147], v[100:103], v[48:51], v[144:147]
    ds_read_b64_tr_b16 a[188:189], v3 offset:19360
    v_cvt_pk_bf16_f32 v58, v36, v37
    v_mfma_f32_16x16x32_bf16 v[160:163], a[136:139], v[48:51], v[160:163]
    v_exp_f32_e64 v38, v38
    v_mfma_f32_16x16x32_bf16 v[160:163], a[168:171], v[52:55], v[160:163]
    ds_read_b64_tr_b16 a[190:191], v3 offset:20384
    v_mfma_f32_16x16x32_bf16 v[176:179], a[172:175], v[52:55], v[176:179]
    s_lshl_b32 s85, s36, 13
    v_exp_f32 v39, v39
    v_mfma_f32_16x16x32_bf16 v[176:179], a[140:143], v[48:51], v[176:179]
    s_add_u32 s85, s85, 1376256
    ds_read_b64_tr_b16 a[158:159], v3 offset:18336
    v_cvt_pk_bf16_f32 v59, v38, v39
    v_mfma_f32_16x16x32_bf16 v[192:195], a[144:147], v[48:51], v[192:195]
    s_add_u32 m0, s81, 8192
    v_exp_f32 v40, v40
    v_mfma_f32_16x16x32_bf16 v[192:195], a[176:179], v[52:55], v[192:195]
    s_waitcnt lgkmcnt(3)
    buffer_load_dwordx4 v12, s[68:71], s85 offen lds
    v_mfma_f32_16x16x32_bf16 v[208:211], a[180:183], v[52:55], v[208:211]
    v_exp_f32_e64 v41, v41
    v_mfma_f32_16x16x32_bf16 v[208:211], a[148:151], v[48:51], v[208:211]
    v_cvt_pk_bf16_f32 v60, v40, v41
    v_mfma_f32_16x16x32_bf16 v[224:227], a[152:155], v[48:51], v[224:227]
    s_add_u32 s86, s84, 172032
    v_exp_f32 v42, v42
    v_mfma_f32_16x16x32_bf16 v[224:227], a[184:187], v[52:55], v[224:227]
    s_waitcnt lgkmcnt(1)
    buffer_load_dwordx4 a[232:235], v13, s[12:15], s86 offen sc1
    v_mfma_f32_16x16x32_bf16 v[240:243], a[188:191], v[52:55], v[240:243]
    s_waitcnt lgkmcnt(0)
    v_exp_f32 v43, v43
    v_mfma_f32_16x16x32_bf16 v[240:243], a[156:159], v[48:51], v[240:243]
    s_xor_b32 s54, s80, 0
    v_cvt_pk_bf16_f32 v61, v42, v43
    v_mfma_f32_16x16x32_bf16 v[32:35], a[64:67], a[32:35], v[24:27]
    s_add_u32 m0, s40, 0
    v_exp_f32_e64 v44, v44
    v_mfma_f32_16x16x32_bf16 v[32:35], a[68:71], a[36:39], v[32:35]
    buffer_load_dwordx4 v12, s[60:63], s54 offen offset:0 lds
    v_mfma_f32_16x16x32_bf16 v[32:35], a[72:75], a[40:43], v[32:35]
    v_exp_f32_e64 v45, v45
    v_mfma_f32_16x16x32_bf16 v[32:35], a[76:79], a[44:47], v[32:35]
    v_cvt_pk_bf16_f32 v62, v44, v45
    v_mfma_f32_16x16x32_bf16 v[36:39], a[92:95], a[44:47], v[24:27]
    s_add_u32 s54, s54, 7168
    v_exp_f32_e64 v46, v46
    v_mfma_f32_16x16x32_bf16 v[36:39], a[88:91], a[40:43], v[36:39]
    buffer_load_dwordx4 v12, s[60:63], s54 offen offset:1024 lds
    v_mfma_f32_16x16x32_bf16 v[36:39], a[84:87], a[36:39], v[36:39]
    v_exp_f32_e64 v47, v47
    v_mfma_f32_16x16x32_bf16 v[36:39], a[80:83], a[32:35], v[36:39]
    v_cvt_pk_bf16_f32 v63, v46, v47
    v_mfma_f32_16x16x32_bf16 v[40:43], a[96:99], a[32:35], v[24:27]
    s_add_u32 s54, s54, 7168
    v_exp_f32_e64 v32, v32
    v_mfma_f32_16x16x32_bf16 v[40:43], a[100:103], a[36:39], v[40:43]
    buffer_load_dwordx4 v12, s[60:63], s54 offen offset:2048 lds
    v_mfma_f32_16x16x32_bf16 v[40:43], a[104:107], a[40:43], v[40:43]
    v_exp_f32_e64 v33, v33
    v_mfma_f32_16x16x32_bf16 v[40:43], a[108:111], a[44:47], v[40:43]
    v_cvt_pk_bf16_f32 v48, v32, v33
    v_mfma_f32_16x16x32_bf16 v[44:47], a[124:127], a[44:47], v[24:27]
    s_add_u32 s54, s54, 7168
    v_exp_f32_e64 v34, v34
    v_mfma_f32_16x16x32_bf16 v[44:47], a[120:123], a[40:43], v[44:47]
    buffer_load_dwordx4 v12, s[60:63], s54 offen offset:3072 lds
    v_mfma_f32_16x16x32_bf16 v[44:47], a[116:119], a[36:39], v[44:47]
    v_exp_f32_e64 v35, v35
    v_mfma_f32_16x16x32_bf16 v[44:47], a[112:115], a[32:35], v[44:47]
    v_cvt_pk_bf16_f32 v49, v34, v35
    v_smfmac_f32_16x16x64_bf16 a[196:199], v[8:11], v[56:63], v5
    s_xor_b32 s54, s80, 32768
    v_mfma_f32_16x16x32_bf16 v[132:135], v[96:99], v[56:59], v[132:135]
    s_add_u32 m0, s41, 0
    v_exp_f32 v36, v36
    v_mfma_f32_16x16x32_bf16 v[132:135], v[104:107], v[60:63], v[132:135]
    buffer_load_dwordx4 v12, s[60:63], s54 offen offset:0 lds
    v_mfma_f32_16x16x32_bf16 v[148:151], v[108:111], v[60:63], v[148:151]
    v_exp_f32_e64 v37, v37
    v_mfma_f32_16x16x32_bf16 v[148:151], v[100:103], v[56:59], v[148:151]
    v_cvt_pk_bf16_f32 v50, v36, v37
    v_mfma_f32_16x16x32_bf16 v[164:167], a[136:139], v[56:59], v[164:167]
    s_add_u32 s54, s54, 7168
    v_exp_f32_e64 v38, v38
    v_mfma_f32_16x16x32_bf16 v[164:167], a[168:171], v[60:63], v[164:167]
    buffer_load_dwordx4 v12, s[60:63], s54 offen offset:1024 lds
    v_mfma_f32_16x16x32_bf16 v[180:183], a[172:175], v[60:63], v[180:183]
    v_exp_f32_e64 v39, v39
    v_mfma_f32_16x16x32_bf16 v[180:183], a[140:143], v[56:59], v[180:183]
    v_cvt_pk_bf16_f32 v51, v38, v39
    v_mfma_f32_16x16x32_bf16 v[196:199], a[144:147], v[56:59], v[196:199]
    s_add_u32 s54, s54, 7168
    v_exp_f32_e64 v40, v40
    v_mfma_f32_16x16x32_bf16 v[196:199], a[176:179], v[60:63], v[196:199]
    buffer_load_dwordx4 v12, s[60:63], s54 offen offset:2048 lds
    v_mfma_f32_16x16x32_bf16 v[212:215], a[180:183], v[60:63], v[212:215]
    v_exp_f32_e64 v41, v41
    v_mfma_f32_16x16x32_bf16 v[212:215], a[148:151], v[56:59], v[212:215]
    s_add_u32 s54, s54, 7168
    v_cvt_pk_bf16_f32 v52, v40, v41
    v_mfma_f32_16x16x32_bf16 v[228:231], a[152:155], v[56:59], v[228:231]
    buffer_load_dwordx4 v12, s[60:63], s54 offen offset:3072 lds
    v_exp_f32_e64 v42, v42
    v_mfma_f32_16x16x32_bf16 v[228:231], a[184:187], v[60:63], v[228:231]
    s_waitcnt vmcnt(9) lgkmcnt(0)
    s_barrier
    v_mfma_f32_16x16x32_bf16 v[244:247], a[188:191], v[60:63], v[244:247]
    s_xor_b32 s54, s80, 65536
    ds_read_b64_tr_b16 a[132:133], v3 offset:33056
    v_exp_f32_e64 v43, v43
    v_mfma_f32_16x16x32_bf16 v[244:247], a[156:159], v[56:59], v[244:247]
    s_add_u32 m0, s40, 16416
    ds_read_b64_tr_b16 a[128:129], v3 offset:33024
    v_cvt_pk_bf16_f32 v53, v42, v43
    v_mfma_f32_16x16x32_bf16 v[72:75], a[216:219], a[224:227], v[72:75]
    buffer_load_dwordx4 v12, s[60:63], s54 offen offset:0 lds
    v_mfma_f32_16x16x32_bf16 v[120:123], a[216:219], a[228:231], v[120:123]
    ds_read_b64_tr_b16 a[130:131], v3 offset:34048
    v_mfma_f32_16x16x32_bf16 v[124:127], a[220:223], a[228:231], v[124:127]
    ds_read_b64_tr_b16 a[160:161], v3 offset:35072
    v_mfma_f32_16x16x32_bf16 v[76:79], a[220:223], a[224:227], v[76:79]
    ds_read_b64_tr_b16 a[162:163], v3 offset:36096
    v_mfma_f32_16x16x32_bf16 v[32:35], a[64:67], a[48:51], v[28:31]
    s_add_u32 s54, s54, 7168
    v_exp_f32_e64 v44, v44
    v_mfma_f32_16x16x32_bf16 v[32:35], a[68:71], a[52:55], v[32:35]
    buffer_load_dwordx4 v12, s[60:63], s54 offen offset:1024 lds
    v_mfma_f32_16x16x32_bf16 v[32:35], a[72:75], a[56:59], v[32:35]
    v_exp_f32_e64 v45, v45
    v_mfma_f32_16x16x32_bf16 v[32:35], a[76:79], a[60:63], v[32:35]
    ds_read_b128 a[64:67], v2 offset:32832
    v_cvt_pk_bf16_f32 v54, v44, v45
    v_mfma_f32_16x16x32_bf16 v[36:39], a[92:95], a[60:63], v[28:31]
    s_add_u32 s54, s54, 7168
    ds_read_b128 a[76:79], v2 offset:33600
    v_exp_f32_e64 v46, v46
    v_mfma_f32_16x16x32_bf16 v[36:39], a[88:91], a[56:59], v[36:39]
    buffer_load_dwordx4 v12, s[60:63], s54 offen offset:2048 lds
    v_mfma_f32_16x16x32_bf16 v[36:39], a[84:87], a[52:55], v[36:39]
    ds_read_b128 a[92:95], v2 offset:34624
    v_exp_f32_e64 v47, v47
    v_mfma_f32_16x16x32_bf16 v[36:39], a[80:83], a[48:51], v[36:39]
    ds_read_b128 a[68:71], v2 offset:33088
    v_cvt_pk_bf16_f32 v55, v46, v47
    v_mfma_f32_16x16x32_bf16 v[40:43], a[96:99], a[48:51], v[28:31]
    s_add_u32 s54, s54, 7168
    ds_read_b128 a[84:87], v2 offset:34112
    v_exp_f32_e64 v32, v32
    v_mfma_f32_16x16x32_bf16 v[40:43], a[100:103], a[52:55], v[40:43]
    buffer_load_dwordx4 v12, s[60:63], s54 offen offset:3072 lds
    v_mfma_f32_16x16x32_bf16 v[40:43], a[104:107], a[56:59], v[40:43]
    ds_read_b128 a[80:83], v2 offset:33856
    v_exp_f32_e64 v33, v33
    v_mfma_f32_16x16x32_bf16 v[40:43], a[108:111], a[60:63], v[40:43]
    s_xor_b32 s54, s80, 98304
    ds_read_b128 a[96:99], v2 offset:34880
    v_cvt_pk_bf16_f32 v56, v32, v33
    v_cvt_pk_bf16_f32 v112, v112, v113
    v_mfma_f32_16x16x32_bf16 v[44:47], a[124:127], a[60:63], v[28:31]
    s_add_u32 m0, s41, 16512
    ds_read_b128 a[104:107], v2 offset:35392
    v_exp_f32_e64 v34, v34
    v_cvt_pk_bf16_f32 v113, v114, v115
    v_mfma_f32_16x16x32_bf16 v[44:47], a[120:123], a[56:59], v[44:47]
    buffer_load_dwordx4 v12, s[60:63], s54 offen offset:0 lds
    v_mfma_f32_16x16x32_bf16 v[44:47], a[116:119], a[52:55], v[44:47]
    ds_read_b128 a[108:111], v2 offset:35648
    v_exp_f32_e64 v35, v35
    v_mfma_f32_16x16x32_bf16 v[44:47], a[112:115], a[48:51], v[44:47]
    ds_read_b128 a[124:127], v2 offset:36672
    v_cvt_pk_bf16_f32 v57, v34, v35
    v_cvt_pk_bf16_f32 v114, v116, v117
    v_smfmac_f32_16x16x64_bf16 a[200:203], v[8:11], v[48:55], v5
    ds_read_b128 a[116:119], v2 offset:36160
    v_cvt_pk_bf16_f32 v115, v118, v119
    v_cvt_pk_bf16_f32 v116, v120, v121
    v_mfma_f32_16x16x32_bf16 v[136:139], v[96:99], v[48:51], v[136:139]
    s_add_u32 s54, s54, 7168
    ds_read_b128 a[112:115], v2 offset:35904
    v_exp_f32_e64 v36, v36
    v_mfma_f32_16x16x32_bf16 v[136:139], v[104:107], v[52:55], v[136:139]
    buffer_load_dwordx4 v12, s[60:63], s54 offen offset:1024 lds
    v_mfma_f32_16x16x32_bf16 v[152:155], v[108:111], v[52:55], v[152:155]
    v_exp_f32_e64 v37, v37
    v_mfma_f32_16x16x32_bf16 v[152:155], v[100:103], v[48:51], v[152:155]
    v_cvt_pk_bf16_f32 v58, v36, v37
    v_cvt_pk_bf16_f32 v117, v122, v123
    v_mfma_f32_16x16x32_bf16 v[168:171], a[136:139], v[48:51], v[168:171]
    s_add_u32 s54, s54, 7168
    v_exp_f32 v38, v38
    v_cvt_pk_bf16_f32 v118, v124, v125
    v_mfma_f32_16x16x32_bf16 v[168:171], a[168:171], v[52:55], v[168:171]
L_hoo0:
    s_cbranch_execz L_hoo_back
    buffer_load_dwordx4 v12, s[60:63], s54 offen offset:2048 lds
    v_mfma_f32_16x16x32_bf16 v[184:187], a[172:175], v[52:55], v[184:187]
    v_exp_f32_e64 v39, v39
    v_mfma_f32_16x16x32_bf16 v[184:187], a[140:143], v[48:51], v[184:187]
    v_cvt_pk_bf16_f32 v59, v38, v39
    v_cvt_pk_bf16_f32 v119, v126, v127
    v_mfma_f32_16x16x32_bf16 v[200:203], a[144:147], v[48:51], v[200:203]
    s_add_u32 s54, s54, 7168
    v_exp_f32_e64 v40, v40
    v_mfma_f32_16x16x32_bf16 v[200:203], a[176:179], v[52:55], v[200:203]
    buffer_load_dwordx4 v12, s[60:63], s54 offen offset:3072 lds
    v_mfma_f32_16x16x32_bf16 v[216:219], a[180:183], v[52:55], v[216:219]
    v_exp_f32 v41, v41
    v_mfma_f32_16x16x32_bf16 v[216:219], a[148:151], v[48:51], v[216:219]
    s_lshl_b32 s56, s36, 11
    ds_read_b128 a[72:75], v2 offset:33344
    v_cvt_pk_bf16_f32 v60, v40, v41
    v_mfma_f32_16x16x32_bf16 v[232:235], a[152:155], v[48:51], v[232:235]
    s_add_u32 m0, s56, 148224
    v_exp_f32_e64 v42, v42
    v_mfma_f32_16x16x32_bf16 v[232:235], a[184:187], v[52:55], v[232:235]
    buffer_load_dwordx4 v7, s[64:67], 0 offen lds
    v_mfma_f32_16x16x32_bf16 v[248:251], a[188:191], v[52:55], v[248:251]
    v_exp_f32 v43, v43
    v_mfma_f32_16x16x32_bf16 v[248:251], a[156:159], v[48:51], v[248:251]
    s_waitcnt lgkmcnt(1)
    ds_read_b128 a[88:91], v2 offset:34368
    v_cvt_pk_bf16_f32 v61, v42, v43
    v_mfma_f32_16x16x32_bf16 v[32:35], a[64:67], a[0:3], v[16:19]
    s_mov_b32 s56, 7168
    v_exp_f32 v44, v44
    v_mfma_f32_16x16x32_bf16 v[32:35], a[68:71], a[4:7], v[32:35]
    s_waitcnt vmcnt(13) lgkmcnt(1)
    buffer_load_dwordx4 v7, s[64:67], s56 offen offset:1024 lds
    v_mfma_f32_16x16x32_bf16 v[32:35], a[72:75], a[8:11], v[32:35]
    v_exp_f32_e64 v45, v45
    v_mfma_f32_16x16x32_bf16 v[32:35], a[76:79], a[12:15], v[32:35]
    ds_read_b128 a[100:103], v2 offset:35136
    v_cvt_pk_bf16_f32 v62, v44, v45
    v_mfma_f32_16x16x32_bf16 v[36:39], a[92:95], a[12:15], v[16:19]
    s_waitcnt lgkmcnt(1)
    v_exp_f32_e64 v46, v46
    s_lshl_b32 s57, s2, 2
    s_add_u32 s57, s57, s36
    s_lshl_b32 s57, s57, 12
    s_add_u32 s57, s57, 26214400
    v_mfma_f32_16x16x32_bf16 v[36:39], a[88:91], a[8:11], v[36:39]
    buffer_store_dwordx4 v[112:115], v13, s[12:15], s57 offen offset:2048 sc1
    v_mfma_f32_16x16x32_bf16 v[36:39], a[84:87], a[4:7], v[36:39]
    v_exp_f32_e64 v47, v47
    v_mfma_f32_16x16x32_bf16 v[36:39], a[80:83], a[0:3], v[36:39]
    ds_read_b128 a[120:123], v2 offset:36416
    v_cvt_pk_bf16_f32 v63, v46, v47
    v_mfma_f32_16x16x32_bf16 v[40:43], a[96:99], a[0:3], v[16:19]
    s_waitcnt lgkmcnt(1)
    v_exp_f32 v32, v32
    v_mfma_f32_16x16x32_bf16 v[40:43], a[100:103], a[4:7], v[40:43]
    buffer_store_dwordx4 v[116:119], v13, s[12:15], s57 offen offset:3072 sc1
    v_mfma_f32_16x16x32_bf16 v[40:43], a[104:107], a[8:11], v[40:43]
    v_exp_f32_e64 v33, v33
    v_mfma_f32_16x16x32_bf16 v[40:43], a[108:111], a[12:15], v[40:43]
    ds_read_b64_tr_b16 a[240:241], v80 offset:0
    v_cvt_pk_bf16_f32 v48, v32, v33
    v_mfma_f32_16x16x32_bf16 v[44:47], a[124:127], a[12:15], v[16:19]
    s_waitcnt lgkmcnt(1)
    v_exp_f32 v34, v34
    v_mfma_f32_16x16x32_bf16 v[44:47], a[120:123], a[8:11], v[44:47]
    ds_read_b64_tr_b16 a[242:243], v80 offset:2048
    v_mfma_f32_16x16x32_bf16 v[44:47], a[116:119], a[4:7], v[44:47]
    v_exp_f32_e64 v35, v35
    v_mfma_f32_16x16x32_bf16 v[44:47], a[112:115], a[0:3], v[44:47]
    ds_read_b64_tr_b16 a[244:245], v81 offset:0
    v_cvt_pk_bf16_f32 v49, v34, v35
    v_smfmac_f32_16x16x64_bf16 a[204:207], v[8:11], v[56:63], v5
    ds_read_b64_tr_b16 a[246:247], v81 offset:2048
    v_mfma_f32_16x16x32_bf16 v[140:143], v[96:99], v[56:59], v[140:143]
    v_exp_f32_e64 v36, v36
    v_mfma_f32_16x16x32_bf16 v[140:143], v[104:107], v[60:63], v[140:143]
    ds_read_b64_tr_b16 a[248:249], v80 offset:512
    v_mfma_f32_16x16x32_bf16 v[156:159], v[108:111], v[60:63], v[156:159]
    v_exp_f32_e64 v37, v37
    v_mfma_f32_16x16x32_bf16 v[156:159], v[100:103], v[56:59], v[156:159]
    ds_read_b64_tr_b16 a[250:251], v80 offset:2560
    v_cvt_pk_bf16_f32 v50, v36, v37
    v_mfma_f32_16x16x32_bf16 v[172:175], a[136:139], v[56:59], v[172:175]
    ds_read_b64_tr_b16 a[136:137], v3 offset:33280
    v_exp_f32_e64 v38, v38
    v_mfma_f32_16x16x32_bf16 v[172:175], a[168:171], v[60:63], v[172:175]
    ds_read_b64_tr_b16 a[252:253], v81 offset:512
    v_mfma_f32_16x16x32_bf16 v[188:191], a[172:175], v[60:63], v[188:191]
    ds_read_b64_tr_b16 a[168:169], v3 offset:35328
    v_exp_f32_e64 v39, v39
    v_mfma_f32_16x16x32_bf16 v[188:191], a[140:143], v[56:59], v[188:191]
    ds_read_b64_tr_b16 a[254:255], v81 offset:2560
    v_cvt_pk_bf16_f32 v51, v38, v39
    v_mfma_f32_16x16x32_bf16 v[204:207], a[144:147], v[56:59], v[204:207]
    ds_read_b64_tr_b16 a[172:173], v3 offset:35360
    v_exp_f32_e64 v40, v40
    v_mfma_f32_16x16x32_bf16 v[204:207], a[176:179], v[60:63], v[204:207]
    ds_read_b64_tr_b16 a[208:209], v14 offset:8192
    v_mfma_f32_16x16x32_bf16 v[220:223], a[180:183], v[60:63], v[220:223]
    ds_read_b64_tr_b16 a[174:175], v3 offset:36384
    v_exp_f32_e64 v41, v41
    v_mfma_f32_16x16x32_bf16 v[220:223], a[148:151], v[56:59], v[220:223]
    ds_read_b64_tr_b16 a[210:211], v14 offset:10240
    v_cvt_pk_bf16_f32 v52, v40, v41
    v_mfma_f32_16x16x32_bf16 v[236:239], a[152:155], v[56:59], v[236:239]
    ds_read_b64_tr_b16 a[140:141], v3 offset:33312
    v_exp_f32_e64 v42, v42
    v_mfma_f32_16x16x32_bf16 v[236:239], a[184:187], v[60:63], v[236:239]
    ds_read_b64_tr_b16 a[212:213], v15 offset:8192
    v_mfma_f32_16x16x32_bf16 v[252:255], a[188:191], v[60:63], v[252:255]
    ds_read_b64_tr_b16 a[144:145], v3 offset:33536
    v_exp_f32_e64 v43, v43
    v_mfma_f32_16x16x32_bf16 v[252:255], a[156:159], v[56:59], v[252:255]
    ds_read_b64_tr_b16 a[214:215], v15 offset:10240
    v_cvt_pk_bf16_f32 v53, v42, v43
    v_mfma_f32_16x16x32_bf16 v[32:35], a[64:67], a[16:19], v[20:23]
    ds_read_b64_tr_b16 a[146:147], v3 offset:34560
    v_exp_f32 v44, v44
    v_mfma_f32_16x16x32_bf16 v[32:35], a[68:71], a[20:23], v[32:35]
    s_waitcnt lgkmcnt(6)
    ds_read_b64_tr_b16 a[216:217], v14 offset:8704
    v_mfma_f32_16x16x32_bf16 v[32:35], a[72:75], a[24:27], v[32:35]
    ds_read_b64_tr_b16 a[176:177], v3 offset:35584
    v_exp_f32_e64 v45, v45
    v_mfma_f32_16x16x32_bf16 v[32:35], a[76:79], a[28:31], v[32:35]
    s_xor_b32 s54, s80, 131072
    ds_read_b64_tr_b16 a[218:219], v14 offset:10752
    v_cvt_pk_bf16_f32 v54, v44, v45
    v_mfma_f32_16x16x32_bf16 v[36:39], a[92:95], a[28:31], v[20:23]
    s_add_u32 m0, s40, 0
    ds_read_b64_tr_b16 a[180:181], v3 offset:35616
    v_exp_f32 v46, v46
    v_mfma_f32_16x16x32_bf16 v[36:39], a[88:91], a[24:27], v[36:39]
    buffer_load_dwordx4 v12, s[60:63], s54 offen offset:0 lds
    v_mfma_f32_16x16x32_bf16 v[36:39], a[84:87], a[20:23], v[36:39]
    ds_read_b64_tr_b16 a[182:183], v3 offset:36640
    v_exp_f32_e64 v47, v47
    v_mfma_f32_16x16x32_bf16 v[36:39], a[80:83], a[16:19], v[36:39]
    ds_read_b64_tr_b16 a[220:221], v15 offset:8704
    v_cvt_pk_bf16_f32 v55, v46, v47
    v_mfma_f32_16x16x32_bf16 v[40:43], a[96:99], a[16:19], v[20:23]
    s_add_u32 s54, s54, 7168
    ds_read_b64_tr_b16 a[148:149], v3 offset:33568
    v_exp_f32_e64 v32, v32
    v_mfma_f32_16x16x32_bf16 v[40:43], a[100:103], a[20:23], v[40:43]
    buffer_load_dwordx4 v12, s[60:63], s54 offen offset:1024 lds
    v_mfma_f32_16x16x32_bf16 v[40:43], a[104:107], a[24:27], v[40:43]
    ds_read_b64_tr_b16 a[152:153], v3 offset:33792
    v_exp_f32_e64 v33, v33
    v_mfma_f32_16x16x32_bf16 v[40:43], a[108:111], a[28:31], v[40:43]
    ds_read_b64_tr_b16 a[222:223], v15 offset:10752
    v_cvt_pk_bf16_f32 v56, v32, v33
    v_mfma_f32_16x16x32_bf16 v[44:47], a[124:127], a[28:31], v[20:23]
    s_add_u32 s54, s54, 7168
    ds_read_b64_tr_b16 a[154:155], v3 offset:34816
    v_exp_f32_e64 v34, v34
    v_mfma_f32_16x16x32_bf16 v[44:47], a[120:123], a[24:27], v[44:47]
    buffer_load_dwordx4 v12, s[60:63], s54 offen offset:2048 lds
    v_mfma_f32_16x16x32_bf16 v[44:47], a[116:119], a[20:23], v[44:47]
    ds_read_b64_tr_b16 a[184:185], v3 offset:35840
    v_exp_f32_e64 v35, v35
    v_mfma_f32_16x16x32_bf16 v[44:47], a[112:115], a[16:19], v[44:47]
    ds_read_b64_tr_b16 a[164:165], v3 offset:35104
    v_cvt_pk_bf16_f32 v57, v34, v35
    v_smfmac_f32_16x16x64_bf16 a[192:195], v[8:11], v[48:55], v5
    s_waitcnt lgkmcnt(5)
    s_add_u32 s54, s54, 7168
    ds_read_b64_tr_b16 a[166:167], v3 offset:36128
    v_mfma_f32_16x16x32_bf16 v[64:67], a[208:211], a[232:235], v[64:67]
    buffer_load_dwordx4 v12, s[60:63], s54 offen offset:3072 lds
    v_mfma_f32_16x16x32_bf16 v[68:71], a[212:215], a[232:235], v[68:71]
    ds_read_b64_tr_b16 a[134:135], v3 offset:34080
    v_mfma_f32_16x16x32_bf16 v[72:75], a[216:219], a[232:235], v[72:75]
    s_waitcnt lgkmcnt(4)
    ds_read_b64_tr_b16 a[138:139], v3 offset:34304
    v_mfma_f32_16x16x32_bf16 v[76:79], a[220:223], a[232:235], v[76:79]
    ds_read_b64_tr_b16 a[170:171], v3 offset:36352
    v_mfma_f32_16x16x32_bf16 v[128:131], a[128:131], v[48:51], v[128:131]
    ds_read_b64_tr_b16 a[188:189], v3 offset:35872
    v_exp_f32 v36, v36
    v_mfma_f32_16x16x32_bf16 v[128:131], a[160:163], v[52:55], v[128:131]
    s_waitcnt lgkmcnt(4)
    ds_read_b64_tr_b16 a[142:143], v3 offset:34336
    v_mfma_f32_16x16x32_bf16 v[144:147], a[164:167], v[52:55], v[144:147]
    s_waitcnt lgkmcnt(4)
    ds_read_b64_tr_b16 a[190:191], v3 offset:36896
    v_exp_f32_e64 v37, v37
    v_mfma_f32_16x16x32_bf16 v[144:147], a[132:135], v[48:51], v[144:147]
    s_waitcnt lgkmcnt(4)
    ds_read_b64_tr_b16 a[178:179], v3 offset:36608
    v_cvt_pk_bf16_f32 v58, v36, v37
    v_mfma_f32_16x16x32_bf16 v[160:163], a[136:139], v[48:51], v[160:163]
    s_waitcnt vmcnt(16) lgkmcnt(4)
    ds_read_b64_tr_b16 a[156:157], v3 offset:33824
    v_exp_f32 v38, v38
    v_mfma_f32_16x16x32_bf16 v[160:163], a[168:171], v[52:55], v[160:163]
    ds_read_b64_tr_b16 a[150:151], v3 offset:34592
    v_mfma_f32_16x16x32_bf16 v[176:179], a[172:175], v[52:55], v[176:179]
    s_waitcnt lgkmcnt(4)
    ds_read_b64_tr_b16 v[112:113], v82 offset:0
    v_exp_f32 v39, v39
    v_mfma_f32_16x16x32_bf16 v[176:179], a[140:143], v[48:51], v[176:179]
    ds_read_b64_tr_b16 a[186:187], v3 offset:36864
    v_cvt_pk_bf16_f32 v59, v38, v39
    v_mfma_f32_16x16x32_bf16 v[192:195], a[144:147], v[48:51], v[192:195]
    s_waitcnt lgkmcnt(4)
    ds_read_b64_tr_b16 v[114:115], v82 offset:2048
    v_exp_f32 v40, v40
    v_mfma_f32_16x16x32_bf16 v[192:195], a[176:179], v[52:55], v[192:195]
    ds_read_b64_tr_b16 a[158:159], v3 offset:34848
    v_mfma_f32_16x16x32_bf16 v[208:211], a[180:183], v[52:55], v[208:211]
    s_waitcnt lgkmcnt(4)
    ds_read_b64_tr_b16 v[116:117], v83 offset:0
    v_exp_f32 v41, v41
    v_mfma_f32_16x16x32_bf16 v[208:211], a[148:151], v[48:51], v[208:211]
    ds_read_b64_tr_b16 v[118:119], v83 offset:2048
    v_cvt_pk_bf16_f32 v60, v40, v41
    v_mfma_f32_16x16x32_bf16 v[224:227], a[152:155], v[48:51], v[224:227]
    s_waitcnt vmcnt(12) lgkmcnt(4)
    ds_read_b64_tr_b16 v[120:121], v82 offset:512
    v_exp_f32 v42, v42
    v_mfma_f32_16x16x32_bf16 v[224:227], a[184:187], v[52:55], v[224:227]
    ds_read_b64_tr_b16 v[122:123], v82 offset:2560
    v_mfma_f32_16x16x32_bf16 v[240:243], a[188:191], v[52:55], v[240:243]
    s_waitcnt lgkmcnt(4)
    ds_read_b64_tr_b16 a[208:209], v80 offset:16416
    v_exp_f32 v43, v43
    v_mfma_f32_16x16x32_bf16 v[240:243], a[156:159], v[48:51], v[240:243]
    ds_read_b64_tr_b16 v[124:125], v83 offset:512
    v_cvt_pk_bf16_f32 v61, v42, v43
    v_mfma_f32_16x16x32_bf16 v[32:35], a[64:67], a[32:35], v[24:27]
    ds_read_b64_tr_b16 a[210:211], v80 offset:18464
    v_exp_f32_e64 v44, v44
    v_mfma_f32_16x16x32_bf16 v[32:35], a[68:71], a[36:39], v[32:35]
    ds_read_b64_tr_b16 v[126:127], v83 offset:2560
    v_mfma_f32_16x16x32_bf16 v[32:35], a[72:75], a[40:43], v[32:35]
    ds_read_b64_tr_b16 a[212:213], v81 offset:16416
    v_exp_f32_e64 v45, v45
    v_mfma_f32_16x16x32_bf16 v[32:35], a[76:79], a[44:47], v[32:35]
    ds_read_b64_tr_b16 a[214:215], v81 offset:18464
    v_cvt_pk_bf16_f32 v62, v44, v45
    v_mfma_f32_16x16x32_bf16 v[36:39], a[92:95], a[44:47], v[24:27]
    ds_read_b64_tr_b16 a[216:217], v80 offset:16928
    v_exp_f32 v46, v46
    v_mfma_f32_16x16x32_bf16 v[36:39], a[88:91], a[40:43], v[36:39]
    s_waitcnt lgkmcnt(3)
    ds_read_b64_tr_b16 a[218:219], v80 offset:18976
    v_mfma_f32_16x16x32_bf16 v[36:39], a[84:87], a[36:39], v[36:39]
    v_exp_f32_e64 v47, v47
    v_mfma_f32_16x16x32_bf16 v[36:39], a[80:83], a[32:35], v[36:39]
    s_xor_b32 s54, s80, 163840
    ds_read_b64_tr_b16 a[220:221], v81 offset:16928
    v_cvt_pk_bf16_f32 v63, v46, v47
    v_mfma_f32_16x16x32_bf16 v[40:43], a[96:99], a[32:35], v[24:27]
    s_add_u32 m0, s41, 0
    v_exp_f32 v32, v32
    v_mfma_f32_16x16x32_bf16 v[40:43], a[100:103], a[36:39], v[40:43]
    buffer_load_dwordx4 v12, s[60:63], s54 offen offset:0 lds
    v_mfma_f32_16x16x32_bf16 v[40:43], a[104:107], a[40:43], v[40:43]
    v_exp_f32_e64 v33, v33
    v_mfma_f32_16x16x32_bf16 v[40:43], a[108:111], a[44:47], v[40:43]
    ds_read_b64_tr_b16 a[222:223], v81 offset:18976
    v_cvt_pk_bf16_f32 v48, v32, v33
    v_mfma_f32_16x16x32_bf16 v[44:47], a[124:127], a[44:47], v[24:27]
    s_add_u32 s54, s54, 7168
    v_exp_f32_e64 v34, v34
    v_mfma_f32_16x16x32_bf16 v[44:47], a[120:123], a[40:43], v[44:47]
    buffer_load_dwordx4 v12, s[60:63], s54 offen offset:1024 lds
    v_mfma_f32_16x16x32_bf16 v[44:47], a[116:119], a[36:39], v[44:47]
    v_exp_f32_e64 v35, v35
    v_mfma_f32_16x16x32_bf16 v[44:47], a[112:115], a[32:35], v[44:47]
    v_cvt_pk_bf16_f32 v49, v34, v35
    v_smfmac_f32_16x16x64_bf16 a[196:199], v[8:11], v[56:63], v5
    v_mfma_f32_16x16x32_bf16 v[132:135], a[128:131], v[56:59], v[132:135]
    s_add_u32 s54, s54, 7168
    v_exp_f32_e64 v36, v36
    v_mfma_f32_16x16x32_bf16 v[132:135], a[160:163], v[60:63], v[132:135]
    buffer_load_dwordx4 v12, s[60:63], s54 offen offset:2048 lds
    v_mfma_f32_16x16x32_bf16 v[148:151], a[164:167], v[60:63], v[148:151]
    v_exp_f32_e64 v37, v37
    v_mfma_f32_16x16x32_bf16 v[148:151], a[132:135], v[56:59], v[148:151]
    v_cvt_pk_bf16_f32 v50, v36, v37
    v_mfma_f32_16x16x32_bf16 v[164:167], a[136:139], v[56:59], v[164:167]
    s_add_u32 s54, s54, 7168
    v_exp_f32 v38, v38
    v_mfma_f32_16x16x32_bf16 v[164:167], a[168:171], v[60:63], v[164:167]
    s_waitcnt lgkmcnt(0)
    buffer_load_dwordx4 v12, s[60:63], s54 offen offset:3072 lds
    v_mfma_f32_16x16x32_bf16 v[180:183], a[172:175], v[60:63], v[180:183]
    v_exp_f32_e64 v39, v39
    v_mfma_f32_16x16x32_bf16 v[180:183], a[140:143], v[56:59], v[180:183]
    s_xor_b32 s54, s80, 196608
    v_cvt_pk_bf16_f32 v51, v38, v39
    v_mfma_f32_16x16x32_bf16 v[196:199], a[144:147], v[56:59], v[196:199]
    s_add_u32 m0, s40, 16416
    v_exp_f32_e64 v40, v40
    v_mfma_f32_16x16x32_bf16 v[196:199], a[176:179], v[60:63], v[196:199]
    buffer_load_dwordx4 v12, s[60:63], s54 offen offset:0 lds
    v_mfma_f32_16x16x32_bf16 v[212:215], a[180:183], v[60:63], v[212:215]
    s_add_u32 s54, s54, 7168
    buffer_load_dwordx4 v12, s[60:63], s54 offen offset:1024 lds
    v_exp_f32_e64 v41, v41
    v_mfma_f32_16x16x32_bf16 v[212:215], a[148:151], v[56:59], v[212:215]
    s_add_u32 s54, s54, 7168
    buffer_load_dwordx4 v12, s[60:63], s54 offen offset:2048 lds
    v_cvt_pk_bf16_f32 v52, v40, v41
    v_mfma_f32_16x16x32_bf16 v[228:231], a[152:155], v[56:59], v[228:231]
    s_add_u32 s54, s54, 7168
    buffer_load_dwordx4 v12, s[60:63], s54 offen offset:3072 lds
    v_exp_f32 v42, v42
    v_mfma_f32_16x16x32_bf16 v[228:231], a[184:187], v[60:63], v[228:231]
    s_waitcnt lgkmcnt(0)
    s_barrier
    v_mfma_f32_16x16x32_bf16 v[244:247], a[188:191], v[60:63], v[244:247]
    v_exp_f32 v43, v43
    v_mfma_f32_16x16x32_bf16 v[244:247], a[156:159], v[56:59], v[244:247]
    s_xor_b32 s54, s80, 229376
    ds_read_b64_tr_b16 v[96:97], v3 offset:49536
    v_cvt_pk_bf16_f32 v53, v42, v43
    v_mfma_f32_16x16x32_bf16 v[32:35], a[64:67], a[48:51], v[28:31]
    s_add_u32 m0, s40, 32832
    v_exp_f32_e64 v44, v44
    v_mfma_f32_16x16x32_bf16 v[32:35], a[68:71], a[52:55], v[32:35]
    buffer_load_dwordx4 v12, s[60:63], s54 offen offset:0 lds
    v_mfma_f32_16x16x32_bf16 v[32:35], a[72:75], a[56:59], v[32:35]
    v_exp_f32_e64 v45, v45
    v_mfma_f32_16x16x32_bf16 v[32:35], a[76:79], a[60:63], v[32:35]
    ds_read_b128 a[64:67], v2 offset:49248
    v_cvt_pk_bf16_f32 v54, v44, v45
    v_mfma_f32_16x16x32_bf16 v[36:39], a[92:95], a[60:63], v[28:31]
    s_add_u32 s54, s54, 7168
    v_exp_f32_e64 v46, v46
    v_mfma_f32_16x16x32_bf16 v[36:39], a[88:91], a[56:59], v[36:39]
    buffer_load_dwordx4 v12, s[60:63], s54 offen offset:1024 lds
    v_mfma_f32_16x16x32_bf16 v[36:39], a[84:87], a[52:55], v[36:39]
    v_exp_f32_e64 v47, v47
    v_mfma_f32_16x16x32_bf16 v[36:39], a[80:83], a[48:51], v[36:39]
    ds_read_b128 a[68:71], v2 offset:49504
    v_cvt_pk_bf16_f32 v55, v46, v47
    v_mfma_f32_16x16x32_bf16 v[40:43], a[96:99], a[48:51], v[28:31]
    s_add_u32 s54, s54, 7168
    v_exp_f32_e64 v32, v32
    v_mfma_f32_16x16x32_bf16 v[40:43], a[100:103], a[52:55], v[40:43]
    buffer_load_dwordx4 v12, s[60:63], s54 offen offset:2048 lds
    v_mfma_f32_16x16x32_bf16 v[40:43], a[104:107], a[56:59], v[40:43]
    ds_read_b128 a[104:107], v2 offset:51808
    v_exp_f32_e64 v33, v33
    v_mfma_f32_16x16x32_bf16 v[40:43], a[108:111], a[60:63], v[40:43]
    ds_read_b128 a[72:75], v2 offset:49760
    v_cvt_pk_bf16_f32 v56, v32, v33
    v_mfma_f32_16x16x32_bf16 v[44:47], a[124:127], a[60:63], v[28:31]
    s_add_u32 s54, s54, 7168
    ds_read_b128 a[108:111], v2 offset:52064
    v_exp_f32_e64 v34, v34
    v_mfma_f32_16x16x32_bf16 v[44:47], a[120:123], a[56:59], v[44:47]
    buffer_load_dwordx4 v12, s[60:63], s54 offen offset:3072 lds
    v_mfma_f32_16x16x32_bf16 v[44:47], a[116:119], a[52:55], v[44:47]
    ds_read_b128 a[124:127], v2 offset:53088
    v_exp_f32_e64 v35, v35
    v_mfma_f32_16x16x32_bf16 v[44:47], a[112:115], a[48:51], v[44:47]
    ds_read_b128 a[76:79], v2 offset:50016
    v_cvt_pk_bf16_f32 v57, v34, v35
    v_smfmac_f32_16x16x64_bf16 a[200:203], v[8:11], v[48:55], v5
    s_xor_b32 s54, s80, 262144
    ds_read_b128 a[92:95], v2 offset:51040
    v_mfma_f32_16x16x32_bf16 v[136:139], a[128:131], v[48:51], v[136:139]
    s_add_u32 m0, s41, 33024
    ds_read_b128 a[116:119], v2 offset:52576
    v_exp_f32_e64 v36, v36
    v_mfma_f32_16x16x32_bf16 v[136:139], a[160:163], v[52:55], v[136:139]
    buffer_load_dwordx4 v12, s[60:63], s54 offen offset:0 lds
    v_mfma_f32_16x16x32_bf16 v[152:155], a[164:167], v[52:55], v[152:155]
    ds_read_b128 a[112:115], v2 offset:52320
    v_exp_f32_e64 v37, v37
    v_mfma_f32_16x16x32_bf16 v[152:155], a[132:135], v[48:51], v[152:155]
    ds_read_b128 a[88:91], v2 offset:50784
    v_cvt_pk_bf16_f32 v58, v36, v37
    v_mfma_f32_16x16x32_bf16 v[168:171], a[136:139], v[48:51], v[168:171]
    s_add_u32 s54, s54, 7168
    v_exp_f32_e64 v38, v38
    v_mfma_f32_16x16x32_bf16 v[168:171], a[168:171], v[52:55], v[168:171]
    buffer_load_dwordx4 v12, s[60:63], s54 offen offset:1024 lds
    v_mfma_f32_16x16x32_bf16 v[184:187], a[172:175], v[52:55], v[184:187]
    v_exp_f32_e64 v39, v39
    v_mfma_f32_16x16x32_bf16 v[184:187], a[140:143], v[48:51], v[184:187]
    ds_read_b128 a[84:87], v2 offset:50528
    v_cvt_pk_bf16_f32 v59, v38, v39
    v_mfma_f32_16x16x32_bf16 v[200:203], a[144:147], v[48:51], v[200:203]
    s_add_u32 s54, s54, 7168
    v_exp_f32_e64 v40, v40
    v_mfma_f32_16x16x32_bf16 v[200:203], a[176:179], v[52:55], v[200:203]
    buffer_load_dwordx4 v12, s[60:63], s54 offen offset:2048 lds
    v_mfma_f32_16x16x32_bf16 v[216:219], a[180:183], v[52:55], v[216:219]
    v_exp_f32_e64 v41, v41
    v_mfma_f32_16x16x32_bf16 v[216:219], a[148:151], v[48:51], v[216:219]
    ds_read_b128 a[80:83], v2 offset:50272
    v_cvt_pk_bf16_f32 v60, v40, v41
    v_mfma_f32_16x16x32_bf16 v[232:235], a[152:155], v[48:51], v[232:235]
    s_add_u32 s54, s54, 7168
    v_exp_f32_e64 v42, v42
    v_mfma_f32_16x16x32_bf16 v[232:235], a[184:187], v[52:55], v[232:235]
    buffer_load_dwordx4 v12, s[60:63], s54 offen offset:3072 lds
    v_mfma_f32_16x16x32_bf16 v[248:251], a[188:191], v[52:55], v[248:251]
    v_exp_f32 v43, v43
    v_mfma_f32_16x16x32_bf16 v[248:251], a[156:159], v[48:51], v[248:251]
    s_waitcnt lgkmcnt(1)
    s_xor_b32 s54, s80, 294912
    ds_read_b128 a[96:99], v2 offset:51296
    v_cvt_pk_bf16_f32 v61, v42, v43
    v_mfma_f32_16x16x32_bf16 v[32:35], a[64:67], a[0:3], v[16:19]
    s_add_u32 m0, s41, 66048
    v_exp_f32_e64 v44, v44
    v_mfma_f32_16x16x32_bf16 v[32:35], a[68:71], a[4:7], v[32:35]
    buffer_load_dwordx4 v12, s[60:63], s54 offen offset:0 lds
    v_mfma_f32_16x16x32_bf16 v[32:35], a[72:75], a[8:11], v[32:35]
    v_exp_f32_e64 v45, v45
    v_mfma_f32_16x16x32_bf16 v[32:35], a[76:79], a[12:15], v[32:35]
    ds_read_b128 a[100:103], v2 offset:51552
    v_cvt_pk_bf16_f32 v62, v44, v45
    v_mfma_f32_16x16x32_bf16 v[36:39], a[92:95], a[12:15], v[16:19]
    s_add_u32 s54, s54, 7168
    v_exp_f32_e64 v46, v46
    v_mfma_f32_16x16x32_bf16 v[36:39], a[88:91], a[8:11], v[36:39]
    buffer_load_dwordx4 v12, s[60:63], s54 offen offset:1024 lds
    v_mfma_f32_16x16x32_bf16 v[36:39], a[84:87], a[4:7], v[36:39]
    s_waitcnt lgkmcnt(1)
    v_exp_f32 v47, v47
    v_mfma_f32_16x16x32_bf16 v[36:39], a[80:83], a[0:3], v[36:39]
    ds_read_b128 a[120:123], v2 offset:52832
    v_cvt_pk_bf16_f32 v63, v46, v47
    v_mfma_f32_16x16x32_bf16 v[40:43], a[96:99], a[0:3], v[16:19]
    s_waitcnt lgkmcnt(1)
    s_add_u32 s54, s54, 7168
    v_exp_f32 v32, v32
    v_mfma_f32_16x16x32_bf16 v[40:43], a[100:103], a[4:7], v[40:43]
    buffer_load_dwordx4 v12, s[60:63], s54 offen offset:2048 lds
    v_mfma_f32_16x16x32_bf16 v[40:43], a[104:107], a[8:11], v[40:43]
    v_exp_f32_e64 v33, v33
    v_mfma_f32_16x16x32_bf16 v[40:43], a[108:111], a[12:15], v[40:43]
    ds_read_b64_tr_b16 v[98:99], v3 offset:50560
    v_cvt_pk_bf16_f32 v48, v32, v33
    v_mfma_f32_16x16x32_bf16 v[44:47], a[124:127], a[12:15], v[16:19]
    s_waitcnt lgkmcnt(1)
    s_add_u32 s54, s54, 7168
    v_exp_f32 v34, v34
    v_mfma_f32_16x16x32_bf16 v[44:47], a[120:123], a[8:11], v[44:47]
    s_waitcnt lgkmcnt(0)
    s_barrier
    buffer_load_dwordx4 v12, s[60:63], s54 offen offset:3072 lds
    v_mfma_f32_16x16x32_bf16 v[44:47], a[116:119], a[4:7], v[44:47]
    v_exp_f32_e64 v35, v35
    v_mfma_f32_16x16x32_bf16 v[44:47], a[112:115], a[0:3], v[44:47]
    ds_read_b64_tr_b16 v[104:105], v3 offset:51584
    v_cvt_pk_bf16_f32 v49, v34, v35
    v_smfmac_f32_16x16x64_bf16 a[204:207], v[8:11], v[56:63], v5
    s_xor_b32 s54, s80, 327680
    ds_read_b64_tr_b16 v[106:107], v3 offset:52608
    v_mfma_f32_16x16x32_bf16 v[140:143], a[128:131], v[56:59], v[140:143]
    s_add_u32 m0, s40, 49248
    v_exp_f32_e64 v36, v36
    v_mfma_f32_16x16x32_bf16 v[140:143], a[160:163], v[60:63], v[140:143]
    buffer_load_dwordx4 v12, s[60:63], s54 offen offset:0 lds
    v_mfma_f32_16x16x32_bf16 v[156:159], a[164:167], v[60:63], v[156:159]
    v_exp_f32_e64 v37, v37
    v_mfma_f32_16x16x32_bf16 v[156:159], a[132:135], v[56:59], v[156:159]
    ds_read_b64_tr_b16 v[108:109], v3 offset:51616
    v_cvt_pk_bf16_f32 v50, v36, v37
    v_mfma_f32_16x16x32_bf16 v[172:175], a[136:139], v[56:59], v[172:175]
    s_add_u32 s54, s54, 7168
    v_exp_f32_e64 v38, v38
    v_mfma_f32_16x16x32_bf16 v[172:175], a[168:171], v[60:63], v[172:175]
    buffer_load_dwordx4 v12, s[60:63], s54 offen offset:1024 lds
    v_mfma_f32_16x16x32_bf16 v[188:191], a[172:175], v[60:63], v[188:191]
    v_exp_f32_e64 v39, v39
    v_mfma_f32_16x16x32_bf16 v[188:191], a[140:143], v[56:59], v[188:191]
    ds_read_b64_tr_b16 v[110:111], v3 offset:52640
    v_cvt_pk_bf16_f32 v51, v38, v39
    v_mfma_f32_16x16x32_bf16 v[204:207], a[144:147], v[56:59], v[204:207]
    s_add_u32 s54, s54, 7168
    v_exp_f32_e64 v40, v40
    v_mfma_f32_16x16x32_bf16 v[204:207], a[176:179], v[60:63], v[204:207]
    buffer_load_dwordx4 v12, s[60:63], s54 offen offset:2048 lds
    v_mfma_f32_16x16x32_bf16 v[220:223], a[180:183], v[60:63], v[220:223]
    ds_read_b64_tr_b16 a[176:177], v3 offset:52096
    v_exp_f32_e64 v41, v41
    v_mfma_f32_16x16x32_bf16 v[220:223], a[148:151], v[56:59], v[220:223]
    ds_read_b64_tr_b16 v[100:101], v3 offset:49568
    v_cvt_pk_bf16_f32 v52, v40, v41
    v_mfma_f32_16x16x32_bf16 v[236:239], a[152:155], v[56:59], v[236:239]
    s_add_u32 s54, s54, 7168
    ds_read_b64_tr_b16 a[180:181], v3 offset:52128
    v_exp_f32_e64 v42, v42
    v_mfma_f32_16x16x32_bf16 v[236:239], a[184:187], v[60:63], v[236:239]
    buffer_load_dwordx4 v12, s[60:63], s54 offen offset:3072 lds
    v_mfma_f32_16x16x32_bf16 v[252:255], a[188:191], v[60:63], v[252:255]
    ds_read_b64_tr_b16 a[182:183], v3 offset:53152
    v_exp_f32_e64 v43, v43
    v_mfma_f32_16x16x32_bf16 v[252:255], a[156:159], v[56:59], v[252:255]
    ds_read_b64_tr_b16 v[102:103], v3 offset:50592
    v_cvt_pk_bf16_f32 v53, v42, v43
    v_mfma_f32_16x16x32_bf16 v[32:35], a[64:67], a[16:19], v[20:23]
    ds_read_b64_tr_b16 a[148:149], v3 offset:50080
    v_exp_f32_e64 v44, v44
    v_mfma_f32_16x16x32_bf16 v[32:35], a[68:71], a[20:23], v[32:35]
    ds_read_b64_tr_b16 a[136:137], v3 offset:49792
    v_mfma_f32_16x16x32_bf16 v[32:35], a[72:75], a[24:27], v[32:35]
    ds_read_b64_tr_b16 a[152:153], v3 offset:50304
    v_exp_f32_e64 v45, v45
    v_mfma_f32_16x16x32_bf16 v[32:35], a[76:79], a[28:31], v[32:35]
    ds_read_b64_tr_b16 a[138:139], v3 offset:50816
    v_cvt_pk_bf16_f32 v54, v44, v45
    v_mfma_f32_16x16x32_bf16 v[36:39], a[92:95], a[28:31], v[20:23]
    ds_read_b64_tr_b16 a[154:155], v3 offset:51328
    v_exp_f32_e64 v46, v46
    v_mfma_f32_16x16x32_bf16 v[36:39], a[88:91], a[24:27], v[36:39]
    ds_read_b64_tr_b16 a[168:169], v3 offset:51840
    v_mfma_f32_16x16x32_bf16 v[36:39], a[84:87], a[20:23], v[36:39]
    ds_read_b64_tr_b16 a[184:185], v3 offset:52352
    v_exp_f32_e64 v47, v47
    v_mfma_f32_16x16x32_bf16 v[36:39], a[80:83], a[16:19], v[36:39]
    ds_read_b64_tr_b16 a[170:171], v3 offset:52864
    v_cvt_pk_bf16_f32 v55, v46, v47
    v_mfma_f32_16x16x32_bf16 v[40:43], a[96:99], a[16:19], v[20:23]
    ds_read_b64_tr_b16 a[188:189], v3 offset:52384
    v_exp_f32_e64 v32, v32
    v_mfma_f32_16x16x32_bf16 v[40:43], a[100:103], a[20:23], v[40:43]
    ds_read_b64_tr_b16 a[172:173], v3 offset:51872
    v_mfma_f32_16x16x32_bf16 v[40:43], a[104:107], a[24:27], v[40:43]
    ds_read_b64_tr_b16 a[190:191], v3 offset:53408
    v_exp_f32_e64 v33, v33
    v_mfma_f32_16x16x32_bf16 v[40:43], a[108:111], a[28:31], v[40:43]
    ds_read_b64_tr_b16 a[174:175], v3 offset:52896
    v_cvt_pk_bf16_f32 v56, v32, v33
    v_mfma_f32_16x16x32_bf16 v[44:47], a[124:127], a[28:31], v[20:23]
    ds_read_b64_tr_b16 a[156:157], v3 offset:50336
    v_exp_f32 v34, v34
    v_mfma_f32_16x16x32_bf16 v[44:47], a[120:123], a[24:27], v[44:47]
L_hoo1:
    s_cbranch_execz L_hoo_back
    ds_read_b64_tr_b16 a[140:141], v3 offset:49824
    v_mfma_f32_16x16x32_bf16 v[44:47], a[116:119], a[20:23], v[44:47]
    v_exp_f32_e64 v35, v35
    v_mfma_f32_16x16x32_bf16 v[44:47], a[112:115], a[16:19], v[44:47]
    ds_read_b64_tr_b16 a[142:143], v3 offset:50848
    v_cvt_pk_bf16_f32 v57, v34, v35
    v_smfmac_f32_16x16x64_bf16 a[192:195], v[8:11], v[48:55], v5
    ds_read_b64_tr_b16 a[144:145], v3 offset:50048
    v_mfma_f32_16x16x32_bf16 v[128:131], v[96:99], v[48:51], v[128:131]
    s_waitcnt lgkmcnt(5)
    v_exp_f32 v36, v36
    v_mfma_f32_16x16x32_bf16 v[128:131], v[104:107], v[52:55], v[128:131]
    ds_read_b64_tr_b16 a[146:147], v3 offset:51072
    v_mfma_f32_16x16x32_bf16 v[144:147], v[108:111], v[52:55], v[144:147]
    v_exp_f32_e64 v37, v37
    v_mfma_f32_16x16x32_bf16 v[144:147], v[100:103], v[48:51], v[144:147]
    ds_read_b64_tr_b16 a[178:179], v3 offset:53120
    v_cvt_pk_bf16_f32 v58, v36, v37
    v_mfma_f32_16x16x32_bf16 v[160:163], a[136:139], v[48:51], v[160:163]
    v_exp_f32 v38, v38
    v_mfma_f32_16x16x32_bf16 v[160:163], a[168:171], v[52:55], v[160:163]
    s_waitcnt lgkmcnt(3)
    ds_read_b64_tr_b16 a[150:151], v3 offset:51104
    v_mfma_f32_16x16x32_bf16 v[176:179], a[172:175], v[52:55], v[176:179]
    v_exp_f32_e64 v39, v39
    v_mfma_f32_16x16x32_bf16 v[176:179], a[140:143], v[48:51], v[176:179]
    ds_read_b64_tr_b16 a[186:187], v3 offset:53376
    v_cvt_pk_bf16_f32 v59, v38, v39
    s_xor_b32 s52, s100, 0
    v_accvgpr_read_b32 v16, a192
    v_accvgpr_read_b32 v18, a193
    v_add_f32 v16, v16, v18
    v_rcp_f32 v18, v16
    s_waitcnt lgkmcnt(3)
    v_mfma_f32_16x16x32_bf16 v[192:195], a[144:147], v[48:51], v[192:195]
    s_waitcnt lgkmcnt(2)
    v_exp_f32 v40, v40
    v_maximum3_f32 v17, |v128|, |v129|, 0
    v_mul_f32 v128, v128, v18
    v_mul_f32 v129, v129, v18
    v_mfma_f32_16x16x32_bf16 v[192:195], a[176:179], v[52:55], v[192:195]
    ds_read_b64_tr_b16 a[158:159], v3 offset:51360
    v_maximum3_f32 v17, |v130|, |v131|, v17
    v_mul_f32 v130, v130, v18
    v_mul_f32 v131, v131, v18
    v_maximum3_f32 v17, |v144|, |v145|, v17
    v_mfma_f32_16x16x32_bf16 v[208:211], a[180:183], v[52:55], v[208:211]
    s_waitcnt lgkmcnt(2)
    v_exp_f32 v41, v41
    v_mul_f32 v144, v144, v18
    v_mul_f32 v145, v145, v18
    v_maximum3_f32 v17, |v146|, |v147|, v17
    v_mul_f32 v146, v146, v18
    v_mfma_f32_16x16x32_bf16 v[208:211], a[148:151], v[48:51], v[208:211]
    v_cvt_pk_bf16_f32 v60, v40, v41
    v_mul_f32 v147, v147, v18
    v_cvt_pk_bf16_f32 v128, v128, v129
    v_cvt_pk_bf16_f32 v129, v130, v131
    v_cvt_pk_bf16_f32 v130, v144, v145
    v_cvt_pk_bf16_f32 v131, v146, v147
    v_mfma_f32_16x16x32_bf16 v[224:227], a[152:155], v[48:51], v[224:227]
    s_waitcnt lgkmcnt(1)
    buffer_store_dwordx4 v[128:131], v13, s[20:23], s52 offen offset:0 sc1
    v_exp_f32 v42, v42
    v_mfma_f32_16x16x32_bf16 v[224:227], a[184:187], v[52:55], v[224:227]
    v_maximum3_f32 v17, |v160|, |v161|, v17
    v_mul_f32 v160, v160, v18
    v_mul_f32 v161, v161, v18
    v_mfma_f32_16x16x32_bf16 v[240:243], a[188:191], v[52:55], v[240:243]
    s_waitcnt lgkmcnt(0)
    v_exp_f32 v43, v43
    v_maximum3_f32 v17, |v162|, |v163|, v17
    v_mfma_f32_16x16x32_bf16 v[240:243], a[156:159], v[48:51], v[240:243]
    v_cvt_pk_bf16_f32 v61, v42, v43
    v_mul_f32 v162, v162, v18
    v_mul_f32 v163, v163, v18
    v_maximum3_f32 v17, |v176|, |v177|, v17
    v_mfma_f32_16x16x32_bf16 v[32:35], a[64:67], a[32:35], v[24:27]
    v_exp_f32 v44, v44
    v_mul_f32 v176, v176, v18
    v_mfma_f32_16x16x32_bf16 v[32:35], a[68:71], a[36:39], v[32:35]
    v_mul_f32 v177, v177, v18
    v_maximum3_f32 v17, |v178|, |v179|, v17
    v_mul_f32 v178, v178, v18
    v_mul_f32 v179, v179, v18
    v_mfma_f32_16x16x32_bf16 v[32:35], a[72:75], a[40:43], v[32:35]
    v_exp_f32 v45, v45
    v_cvt_pk_bf16_f32 v160, v160, v161
    v_mfma_f32_16x16x32_bf16 v[32:35], a[76:79], a[44:47], v[32:35]
    v_cvt_pk_bf16_f32 v62, v44, v45
    v_cvt_pk_bf16_f32 v161, v162, v163
    v_cvt_pk_bf16_f32 v162, v176, v177
    v_cvt_pk_bf16_f32 v163, v178, v179
    v_mfma_f32_16x16x32_bf16 v[36:39], a[92:95], a[44:47], v[24:27]
    buffer_store_dwordx4 v[160:163], v13, s[20:23], s52 offen offset:1024 sc1
    v_exp_f32 v46, v46
    v_mfma_f32_16x16x32_bf16 v[36:39], a[88:91], a[40:43], v[36:39]
    v_maximum3_f32 v17, |v192|, |v193|, v17
    v_mul_f32 v192, v192, v18
    v_mul_f32 v193, v193, v18
    v_mfma_f32_16x16x32_bf16 v[36:39], a[84:87], a[36:39], v[36:39]
    v_exp_f32 v47, v47
    v_maximum3_f32 v17, |v194|, |v195|, v17
    v_mfma_f32_16x16x32_bf16 v[36:39], a[80:83], a[32:35], v[36:39]
    v_cvt_pk_bf16_f32 v63, v46, v47
    v_mul_f32 v194, v194, v18
    v_mul_f32 v195, v195, v18
    v_maximum3_f32 v17, |v208|, |v209|, v17
    v_mfma_f32_16x16x32_bf16 v[40:43], a[96:99], a[32:35], v[24:27]
    v_exp_f32 v32, v32
    v_mul_f32 v208, v208, v18
    v_mfma_f32_16x16x32_bf16 v[40:43], a[100:103], a[36:39], v[40:43]
    v_mul_f32 v209, v209, v18
    v_maximum3_f32 v17, |v210|, |v211|, v17
    v_mul_f32 v210, v210, v18
    v_mul_f32 v211, v211, v18
    v_mfma_f32_16x16x32_bf16 v[40:43], a[104:107], a[40:43], v[40:43]
    v_exp_f32 v33, v33
    v_cvt_pk_bf16_f32 v192, v192, v193
    v_mfma_f32_16x16x32_bf16 v[40:43], a[108:111], a[44:47], v[40:43]
    v_cvt_pk_bf16_f32 v48, v32, v33
    v_cvt_pk_bf16_f32 v193, v194, v195
    v_cvt_pk_bf16_f32 v194, v208, v209
    v_cvt_pk_bf16_f32 v195, v210, v211
    v_mfma_f32_16x16x32_bf16 v[44:47], a[124:127], a[44:47], v[24:27]
    buffer_store_dwordx4 v[192:195], v13, s[20:23], s52 offen offset:2048 sc1
    v_exp_f32_e64 v34, v34
    v_mfma_f32_16x16x32_bf16 v[44:47], a[120:123], a[40:43], v[44:47]
    v_maximum3_f32 v17, |v224|, |v225|, v17
    v_mfma_f32_16x16x32_bf16 v[44:47], a[116:119], a[36:39], v[44:47]
    v_exp_f32 v35, v35
    v_mul_f32 v224, v224, v18
    v_mfma_f32_16x16x32_bf16 v[44:47], a[112:115], a[32:35], v[44:47]
    v_cvt_pk_bf16_f32 v49, v34, v35
    v_mul_f32 v225, v225, v18
    v_maximum3_f32 v17, |v226|, |v227|, v17
    v_smfmac_f32_16x16x64_bf16 a[196:199], v[8:11], v[56:63], v5
    v_mul_f32 v226, v226, v18
    v_mul_f32 v227, v227, v18
    v_maximum3_f32 v17, |v240|, |v241|, v17
    v_mfma_f32_16x16x32_bf16 v[132:135], v[96:99], v[56:59], v[132:135]
    v_exp_f32 v36, v36
    v_mfma_f32_16x16x32_bf16 v[132:135], v[104:107], v[60:63], v[132:135]
    v_mul_f32 v240, v240, v18
    v_mul_f32 v241, v241, v18
    v_maximum3_f32 v17, |v242|, |v243|, v17
    v_mfma_f32_16x16x32_bf16 v[148:151], v[108:111], v[60:63], v[148:151]
    v_exp_f32 v37, v37
    v_mul_f32 v242, v242, v18
    v_mfma_f32_16x16x32_bf16 v[148:151], v[100:103], v[56:59], v[148:151]
    v_cvt_pk_bf16_f32 v50, v36, v37
    v_mul_f32 v243, v243, v18
    v_cvt_pk_bf16_f32 v224, v224, v225
    v_mfma_f32_16x16x32_bf16 v[164:167], a[136:139], v[56:59], v[164:167]
    v_exp_f32 v38, v38
    v_mfma_f32_16x16x32_bf16 v[164:167], a[168:171], v[60:63], v[164:167]
    v_cvt_pk_bf16_f32 v225, v226, v227
    v_cvt_pk_bf16_f32 v226, v240, v241
    v_cvt_pk_bf16_f32 v227, v242, v243
    v_mfma_f32_16x16x32_bf16 v[180:183], a[172:175], v[60:63], v[180:183]
    buffer_store_dwordx4 v[224:227], v13, s[20:23], s52 offen offset:3072 sc1
    v_exp_f32_e64 v39, v39
    v_mfma_f32_16x16x32_bf16 v[180:183], a[140:143], v[56:59], v[180:183]
    v_cvt_pk_bf16_f32 v51, v38, v39
    s_xor_b32 s52, s100, 4096
    v_accvgpr_read_b32 v20, a196
    v_accvgpr_read_b32 v22, a197
    v_add_f32 v20, v20, v22
    v_mfma_f32_16x16x32_bf16 v[196:199], a[144:147], v[56:59], v[196:199]
    v_exp_f32 v40, v40
    v_rcp_f32 v22, v20
    v_mfma_f32_16x16x32_bf16 v[196:199], a[176:179], v[60:63], v[196:199]
    v_maximum3_f32 v21, |v132|, |v133|, 0
    v_mul_f32 v132, v132, v22
    v_mul_f32 v133, v133, v22
    v_maximum3_f32 v21, |v134|, |v135|, v21
    v_mfma_f32_16x16x32_bf16 v[212:215], a[180:183], v[60:63], v[212:215]
    v_exp_f32 v41, v41
    v_mul_f32 v134, v134, v22
    v_mfma_f32_16x16x32_bf16 v[212:215], a[148:151], v[56:59], v[212:215]
    v_cvt_pk_bf16_f32 v52, v40, v41
    v_mul_f32 v135, v135, v22
    v_maximum3_f32 v21, |v148|, |v149|, v21
    v_mul_f32 v148, v148, v22
    v_mfma_f32_16x16x32_bf16 v[228:231], a[152:155], v[56:59], v[228:231]
    v_exp_f32 v42, v42
    v_mul_f32 v149, v149, v22
    v_maximum3_f32 v21, |v150|, |v151|, v21
    v_mfma_f32_16x16x32_bf16 v[228:231], a[184:187], v[60:63], v[228:231]
    v_mul_f32 v150, v150, v22
    v_mul_f32_e64 v151, v151, v22
    v_cvt_pk_bf16_f32 v132, v132, v133
    v_cvt_pk_bf16_f32 v133, v134, v135
    v_mfma_f32_16x16x32_bf16 v[244:247], a[188:191], v[60:63], v[244:247]
    v_exp_f32_e64 v43, v43
    v_cvt_pk_bf16_f32 v134, v148, v149
    v_cvt_pk_bf16_f32 v135, v150, v151
    v_mfma_f32_16x16x32_bf16 v[244:247], a[156:159], v[56:59], v[244:247]
    buffer_store_dwordx4 v[132:135], v13, s[20:23], s52 offen offset:0 sc1
    v_cvt_pk_bf16_f32 v53, v42, v43
    v_mfma_f32_16x16x32_bf16 v[32:35], a[64:67], a[48:51], v[28:31]
    v_exp_f32 v44, v44
    v_maximum3_f32 v21, |v164|, |v165|, v21
    v_mul_f32 v164, v164, v22
    v_mfma_f32_16x16x32_bf16 v[32:35], a[68:71], a[52:55], v[32:35]
    v_mul_f32 v165, v165, v22
    v_maximum3_f32 v21, |v166|, |v167|, v21
    v_mul_f32 v166, v166, v22
    v_mfma_f32_16x16x32_bf16 v[32:35], a[72:75], a[56:59], v[32:35]
    v_exp_f32 v45, v45
    v_mul_f32 v167, v167, v22
    v_maximum3_f32 v21, |v180|, |v181|, v21
    v_mfma_f32_16x16x32_bf16 v[32:35], a[76:79], a[60:63], v[32:35]
    v_cvt_pk_bf16_f32 v54, v44, v45
    v_mul_f32 v180, v180, v22
    v_mul_f32 v181, v181, v22
    v_mfma_f32_16x16x32_bf16 v[36:39], a[92:95], a[60:63], v[28:31]
    v_exp_f32 v46, v46
    v_maximum3_f32 v21, |v182|, |v183|, v21
    v_mul_f32 v182, v182, v22
    v_mfma_f32_16x16x32_bf16 v[36:39], a[88:91], a[56:59], v[36:39]
    v_mul_f32_e64 v183, v183, v22
    v_cvt_pk_bf16_f32 v164, v164, v165
    v_cvt_pk_bf16_f32 v165, v166, v167
    v_mfma_f32_16x16x32_bf16 v[36:39], a[84:87], a[52:55], v[36:39]
    v_exp_f32_e64 v47, v47
    v_cvt_pk_bf16_f32 v166, v180, v181
    v_cvt_pk_bf16_f32 v167, v182, v183
    v_mfma_f32_16x16x32_bf16 v[36:39], a[80:83], a[48:51], v[36:39]
    buffer_store_dwordx4 v[164:167], v13, s[20:23], s52 offen offset:1024 sc1
    v_cvt_pk_bf16_f32 v55, v46, v47
    v_maximum3_f32 v21, |v196|, |v197|, v21
    v_mfma_f32_16x16x32_bf16 v[40:43], a[96:99], a[48:51], v[28:31]
    v_exp_f32 v32, v32
    v_mul_f32 v196, v196, v22
    v_mfma_f32_16x16x32_bf16 v[40:43], a[100:103], a[52:55], v[40:43]
    v_mul_f32 v197, v197, v22
    v_maximum3_f32 v21, |v198|, |v199|, v21
    v_mul_f32 v198, v198, v22
    v_mul_f32 v199, v199, v22
    v_mfma_f32_16x16x32_bf16 v[40:43], a[104:107], a[56:59], v[40:43]
    v_exp_f32 v33, v33
    v_maximum3_f32 v21, |v212|, |v213|, v21
    v_mul_f32 v212, v212, v22
    v_mfma_f32_16x16x32_bf16 v[40:43], a[108:111], a[60:63], v[40:43]
    v_cvt_pk_bf16_f32 v56, v32, v33
    v_mul_f32 v213, v213, v22
    v_maximum3_f32 v21, |v214|, |v215|, v21
    v_mul_f32 v214, v214, v22
    v_mfma_f32_16x16x32_bf16 v[44:47], a[124:127], a[60:63], v[28:31]
    v_exp_f32 v34, v34
    v_mul_f32_e64 v215, v215, v22
    v_mfma_f32_16x16x32_bf16 v[44:47], a[120:123], a[56:59], v[44:47]
    v_cvt_pk_bf16_f32 v196, v196, v197
    v_cvt_pk_bf16_f32 v197, v198, v199
    v_cvt_pk_bf16_f32 v198, v212, v213
    v_cvt_pk_bf16_f32 v199, v214, v215
    v_mfma_f32_16x16x32_bf16 v[44:47], a[116:119], a[52:55], v[44:47]
    buffer_store_dwordx4 v[196:199], v13, s[20:23], s52 offen offset:2048 sc1
    v_exp_f32_e64 v35, v35
    v_mfma_f32_16x16x32_bf16 v[44:47], a[112:115], a[48:51], v[44:47]
    v_cvt_pk_bf16_f32 v57, v34, v35
    v_maximum3_f32 v21, |v228|, |v229|, v21
    v_smfmac_f32_16x16x64_bf16 a[200:203], v[8:11], v[48:55], v5
    v_mul_f32 v228, v228, v22
    v_mul_f32 v229, v229, v22
    v_maximum3_f32 v21, |v230|, |v231|, v21
    v_mfma_f32_16x16x32_bf16 v[136:139], v[96:99], v[48:51], v[136:139]
    v_exp_f32 v36, v36
    v_mul_f32 v230, v230, v22
    v_mfma_f32_16x16x32_bf16 v[136:139], v[104:107], v[52:55], v[136:139]
    v_mul_f32 v231, v231, v22
    v_maximum3_f32 v21, |v244|, |v245|, v21
    v_mul_f32 v244, v244, v22
    v_mul_f32 v245, v245, v22
    v_mfma_f32_16x16x32_bf16 v[152:155], v[108:111], v[52:55], v[152:155]
    v_exp_f32 v37, v37
    v_maximum3_f32 v21, |v246|, |v247|, v21
    v_mfma_f32_16x16x32_bf16 v[152:155], v[100:103], v[48:51], v[152:155]
    v_cvt_pk_bf16_f32 v58, v36, v37
    v_mul_f32 v246, v246, v22
    v_mul_f32 v247, v247, v22
    v_mfma_f32_16x16x32_bf16 v[168:171], a[136:139], v[48:51], v[168:171]
    v_exp_f32_e64 v38, v38
    v_cvt_pk_bf16_f32 v228, v228, v229
    v_mfma_f32_16x16x32_bf16 v[168:171], a[168:171], v[52:55], v[168:171]
    v_cvt_pk_bf16_f32 v229, v230, v231
    v_cvt_pk_bf16_f32 v230, v244, v245
    v_cvt_pk_bf16_f32 v231, v246, v247
    v_mfma_f32_16x16x32_bf16 v[184:187], a[172:175], v[52:55], v[184:187]
    buffer_store_dwordx4 v[228:231], v13, s[20:23], s52 offen offset:3072 sc1
    v_exp_f32_e64 v39, v39
    v_mfma_f32_16x16x32_bf16 v[184:187], a[140:143], v[48:51], v[184:187]
    v_cvt_pk_bf16_f32 v59, v38, v39
    s_xor_b32 s52, s100, 8192
    v_accvgpr_read_b32 v24, a200
    v_accvgpr_read_b32 v26, a201
    v_add_f32 v24, v24, v26
    v_mfma_f32_16x16x32_bf16 v[200:203], a[144:147], v[48:51], v[200:203]
    v_exp_f32 v40, v40
    v_rcp_f32 v26, v24
    v_mfma_f32_16x16x32_bf16 v[200:203], a[176:179], v[52:55], v[200:203]
    v_maximum3_f32 v25, |v136|, |v137|, 0
    v_mul_f32 v136, v136, v26
    v_mul_f32 v137, v137, v26
    v_maximum3_f32 v25, |v138|, |v139|, v25
    v_mfma_f32_16x16x32_bf16 v[216:219], a[180:183], v[52:55], v[216:219]
    v_exp_f32 v41, v41
    v_mul_f32 v138, v138, v26
    v_mfma_f32_16x16x32_bf16 v[216:219], a[148:151], v[48:51], v[216:219]
    v_cvt_pk_bf16_f32 v60, v40, v41
    v_mul_f32 v139, v139, v26
    v_maximum3_f32 v25, |v152|, |v153|, v25
    v_mul_f32 v152, v152, v26
    v_mfma_f32_16x16x32_bf16 v[232:235], a[152:155], v[48:51], v[232:235]
    v_exp_f32 v42, v42
    v_mul_f32 v153, v153, v26
    v_maximum3_f32 v25, |v154|, |v155|, v25
    v_mfma_f32_16x16x32_bf16 v[232:235], a[184:187], v[52:55], v[232:235]
    v_mul_f32 v154, v154, v26
    v_mul_f32_e64 v155, v155, v26
    v_cvt_pk_bf16_f32 v136, v136, v137
    v_cvt_pk_bf16_f32 v137, v138, v139
    v_mfma_f32_16x16x32_bf16 v[248:251], a[188:191], v[52:55], v[248:251]
    v_exp_f32_e64 v43, v43
    v_cvt_pk_bf16_f32 v138, v152, v153
    v_cvt_pk_bf16_f32 v139, v154, v155
    v_mfma_f32_16x16x32_bf16 v[248:251], a[156:159], v[48:51], v[248:251]
    buffer_store_dwordx4 v[136:139], v13, s[20:23], s52 offen offset:0 sc1
    v_cvt_pk_bf16_f32 v61, v42, v43
    v_exp_f32 v44, v44
    v_exp_f32 v45, v45
    s_nop 0
    v_cvt_pk_bf16_f32 v62, v44, v45
    v_exp_f32 v46, v46
    v_maximum3_f32 v25, |v168|, |v169|, v25
    v_exp_f32 v47, v47
    s_nop 0
    v_cvt_pk_bf16_f32 v63, v46, v47
    v_mul_f32 v168, v168, v26
    v_mul_f32 v169, v169, v26
    v_maximum3_f32 v25, |v170|, |v171|, v25
    v_mul_f32 v170, v170, v26
    v_mul_f32 v171, v171, v26
    v_maximum3_f32 v25, |v184|, |v185|, v25
    v_mul_f32 v184, v184, v26
    v_mul_f32 v185, v185, v26
    v_maximum3_f32 v25, |v186|, |v187|, v25
    v_mul_f32 v186, v186, v26
    v_mul_f32 v187, v187, v26
    v_cvt_pk_bf16_f32 v168, v168, v169
    v_cvt_pk_bf16_f32 v169, v170, v171
    v_smfmac_f32_16x16x64_bf16 a[204:207], v[8:11], v[56:63], v5
    v_cvt_pk_bf16_f32 v170, v184, v185
    v_cvt_pk_bf16_f32 v171, v186, v187
    v_mfma_f32_16x16x32_bf16 v[140:143], v[96:99], v[56:59], v[140:143]
    buffer_store_dwordx4 v[168:171], v13, s[20:23], s52 offen offset:1024 sc1
    v_maximum3_f32 v25, |v200|, |v201|, v25
    v_mfma_f32_16x16x32_bf16 v[140:143], v[104:107], v[60:63], v[140:143]
    v_mul_f32 v200, v200, v26
    v_mul_f32 v201, v201, v26
    v_mfma_f32_16x16x32_bf16 v[156:159], v[108:111], v[60:63], v[156:159]
    v_maximum3_f32 v25, |v202|, |v203|, v25
    v_mul_f32 v202, v202, v26
    v_mul_f32 v203, v203, v26
    v_mfma_f32_16x16x32_bf16 v[156:159], v[100:103], v[56:59], v[156:159]
    v_maximum3_f32 v25, |v216|, |v217|, v25
    v_mul_f32 v216, v216, v26
    v_mfma_f32_16x16x32_bf16 v[172:175], a[136:139], v[56:59], v[172:175]
    v_mul_f32 v217, v217, v26
    v_maximum3_f32 v25, |v218|, |v219|, v25
    v_mul_f32 v218, v218, v26
    v_mfma_f32_16x16x32_bf16 v[172:175], a[168:171], v[60:63], v[172:175]
    v_mul_f32 v219, v219, v26
    v_cvt_pk_bf16_f32 v200, v200, v201
    v_mfma_f32_16x16x32_bf16 v[188:191], a[172:175], v[60:63], v[188:191]
    v_cvt_pk_bf16_f32 v201, v202, v203
    v_cvt_pk_bf16_f32 v202, v216, v217
    v_cvt_pk_bf16_f32 v203, v218, v219
    v_mfma_f32_16x16x32_bf16 v[188:191], a[140:143], v[56:59], v[188:191]
    buffer_store_dwordx4 v[200:203], v13, s[20:23], s52 offen offset:2048 sc1
    v_mfma_f32_16x16x32_bf16 v[204:207], a[144:147], v[56:59], v[204:207]
    v_maximum3_f32 v25, |v232|, |v233|, v25
    v_mul_f32 v232, v232, v26
    v_mfma_f32_16x16x32_bf16 v[204:207], a[176:179], v[60:63], v[204:207]
    v_mul_f32 v233, v233, v26
    v_maximum3_f32 v25, |v234|, |v235|, v25
    v_mul_f32 v234, v234, v26
    v_mfma_f32_16x16x32_bf16 v[220:223], a[180:183], v[60:63], v[220:223]
    v_mul_f32 v235, v235, v26
    v_maximum3_f32 v25, |v248|, |v249|, v25
    v_mfma_f32_16x16x32_bf16 v[220:223], a[148:151], v[56:59], v[220:223]
    v_mul_f32 v248, v248, v26
    v_mul_f32 v249, v249, v26
    v_mfma_f32_16x16x32_bf16 v[236:239], a[152:155], v[56:59], v[236:239]
    v_maximum3_f32 v25, |v250|, |v251|, v25
    v_mul_f32 v250, v250, v26
    v_mfma_f32_16x16x32_bf16 v[236:239], a[184:187], v[60:63], v[236:239]
    v_mul_f32 v251, v251, v26
    v_cvt_pk_bf16_f32 v232, v232, v233
    v_cvt_pk_bf16_f32 v233, v234, v235
    v_mfma_f32_16x16x32_bf16 v[252:255], a[188:191], v[60:63], v[252:255]
    v_cvt_pk_bf16_f32 v234, v248, v249
    v_cvt_pk_bf16_f32 v235, v250, v251
    v_mfma_f32_16x16x32_bf16 v[252:255], a[156:159], v[56:59], v[252:255]
    buffer_store_dwordx4 v[232:235], v13, s[20:23], s52 offen offset:3072 sc1
    s_xor_b32 s52, s100, 12288
    v_accvgpr_read_b32 v28, a204
    v_accvgpr_read_b32 v30, a205
    v_add_f32 v28, v28, v30
    v_rcp_f32 v30, v28
    v_maximum3_f32 v29, |v140|, |v141|, 0
    v_pk_mul_f32 v[140:141], v[140:141], v[30:31] op_sel_hi:[1,0]
    v_maximum3_f32 v29, |v142|, |v143|, v29
    v_pk_mul_f32 v[142:143], v[142:143], v[30:31] op_sel_hi:[1,0]
    v_maximum3_f32 v29, |v156|, |v157|, v29
    v_pk_mul_f32 v[156:157], v[156:157], v[30:31] op_sel_hi:[1,0]
    v_maximum3_f32 v29, |v158|, |v159|, v29
    v_pk_mul_f32 v[158:159], v[158:159], v[30:31] op_sel_hi:[1,0]
    v_cvt_pk_bf16_f32 v140, v140, v141
    v_cvt_pk_bf16_f32 v141, v142, v143
    v_cvt_pk_bf16_f32 v142, v156, v157
    v_cvt_pk_bf16_f32 v143, v158, v159
    buffer_store_dwordx4 v[140:143], v13, s[20:23], s52 offen offset:0 sc1
    v_maximum3_f32 v29, |v172|, |v173|, v29
    v_pk_mul_f32 v[172:173], v[172:173], v[30:31] op_sel_hi:[1,0]
    v_maximum3_f32 v29, |v174|, |v175|, v29
    v_pk_mul_f32 v[174:175], v[174:175], v[30:31] op_sel_hi:[1,0]
    v_maximum3_f32 v29, |v188|, |v189|, v29
    v_pk_mul_f32 v[188:189], v[188:189], v[30:31] op_sel_hi:[1,0]
    v_maximum3_f32 v29, |v190|, |v191|, v29
    v_pk_mul_f32 v[190:191], v[190:191], v[30:31] op_sel_hi:[1,0]
    v_cvt_pk_bf16_f32 v172, v172, v173
    v_cvt_pk_bf16_f32 v173, v174, v175
    v_cvt_pk_bf16_f32 v174, v188, v189
    v_cvt_pk_bf16_f32 v175, v190, v191
    buffer_store_dwordx4 v[172:175], v13, s[20:23], s52 offen offset:1024 sc1
    v_maximum3_f32 v29, |v204|, |v205|, v29
    v_pk_mul_f32 v[204:205], v[204:205], v[30:31] op_sel_hi:[1,0]
    v_maximum3_f32 v29, |v206|, |v207|, v29
    v_pk_mul_f32 v[206:207], v[206:207], v[30:31] op_sel_hi:[1,0]
    v_maximum3_f32 v29, |v220|, |v221|, v29
    v_pk_mul_f32 v[220:221], v[220:221], v[30:31] op_sel_hi:[1,0]
    v_maximum3_f32 v29, |v222|, |v223|, v29
    v_pk_mul_f32 v[222:223], v[222:223], v[30:31] op_sel_hi:[1,0]
    v_cvt_pk_bf16_f32 v204, v204, v205
    v_cvt_pk_bf16_f32 v205, v206, v207
    v_cvt_pk_bf16_f32 v206, v220, v221
    v_cvt_pk_bf16_f32 v207, v222, v223
    buffer_store_dwordx4 v[204:207], v13, s[20:23], s52 offen offset:2048 sc1
    v_maximum3_f32 v29, |v236|, |v237|, v29
    v_pk_mul_f32 v[236:237], v[236:237], v[30:31] op_sel_hi:[1,0]
    v_maximum3_f32 v29, |v238|, |v239|, v29
    v_pk_mul_f32 v[238:239], v[238:239], v[30:31] op_sel_hi:[1,0]
    v_maximum3_f32 v29, |v252|, |v253|, v29
    v_pk_mul_f32 v[252:253], v[252:253], v[30:31] op_sel_hi:[1,0]
    v_maximum3_f32 v29, |v254|, |v255|, v29
    v_pk_mul_f32 v[254:255], v[254:255], v[30:31] op_sel_hi:[1,0]
    v_cvt_pk_bf16_f32 v236, v236, v237
    v_cvt_pk_bf16_f32 v237, v238, v239
    v_cvt_pk_bf16_f32 v238, v252, v253
    v_cvt_pk_bf16_f32 v239, v254, v255
    buffer_store_dwordx4 v[236:239], v13, s[20:23], s52 offen offset:3072 sc1
    s_mov_b32 s56, 0x100
    s_mov_b64 s[58:59], -1
    v_cmp_le_f32 vcc, 0xc000000, v16
    s_nop 0
    s_and_b64 s[58:59], s[58:59], vcc
    v_cmp_class_f32 vcc, v17, s56
    s_nop 0
    s_and_b64 s[58:59], s[58:59], vcc
    v_cmp_class_f32 vcc, v18, s56
    s_nop 0
    s_and_b64 s[58:59], s[58:59], vcc
    v_cmp_le_f32 vcc, 0xc000000, v20
    s_nop 0
    s_and_b64 s[58:59], s[58:59], vcc
    v_cmp_class_f32 vcc, v21, s56
    s_nop 0
    s_and_b64 s[58:59], s[58:59], vcc
    v_cmp_class_f32 vcc, v22, s56
    s_nop 0
    s_and_b64 s[58:59], s[58:59], vcc
    v_cmp_le_f32 vcc, 0xc000000, v24
    s_nop 0
    s_and_b64 s[58:59], s[58:59], vcc
    v_cmp_class_f32 vcc, v25, s56
    s_nop 0
    s_and_b64 s[58:59], s[58:59], vcc
    v_cmp_class_f32 vcc, v26, s56
    s_nop 0
    s_and_b64 s[58:59], s[58:59], vcc
    v_cmp_le_f32 vcc, 0xc000000, v28
    s_nop 0
    s_and_b64 s[58:59], s[58:59], vcc
    v_cmp_class_f32 vcc, v29, s56
    s_nop 0
    s_and_b64 s[58:59], s[58:59], vcc
    v_cmp_class_f32 vcc, v30, s56
    s_nop 0
    s_and_b64 s[58:59], s[58:59], vcc
    s_cmp_eq_u64 s[58:59], -1
    s_cselect_b32 s56, 0, 1
    s_lshl_b32 s57, s36, 2
    s_add_u32 s57, s57, 157056
    v_mov_b32 v88, s57
    v_mov_b32 v89, s56
    ds_write_b32 v88, v89
    v_mov_b32 v40, 157056
    v_mov_b32 v41, 1
    s_lshl_b32 s59, s3, 7
    s_add_u32 s59, s59, s82
    s_lshl_b32 s59, s59, 3
    s_add_u32 s59, s59, 25165824
    s_waitcnt lgkmcnt(0)
L_bar1:
    s_barrier
    ds_read_b128 v[44:47], v40
    s_waitcnt lgkmcnt(0)
    v_or3_b32 v44, v44, v45, v46
    v_or_b32_e64 v44, v44, v47
    s_nop 0
    v_readfirstlane_b32 s56, v44
    s_nop 0
    s_andn2_b32 s56, s56, s50
    s_cmp_lg_u32 s56, 0
    s_cbranch_scc1 L_fallback
    s_waitcnt vmcnt(48)
    ds_read_b64_tr_b16 a[224:225], v82 offset:16512
    ds_read_b64_tr_b16 a[226:227], v82 offset:18560
    ds_read_b64_tr_b16 a[228:229], v83 offset:16512
    ds_read_b64_tr_b16 a[230:231], v83 offset:18560
    ds_read_b64_tr_b16 a[232:233], v82 offset:17024
    ds_read_b64_tr_b16 a[234:235], v82 offset:19072
    ds_read_b64_tr_b16 a[236:237], v83 offset:17024
    ds_read_b64_tr_b16 a[238:239], v83 offset:19072
    s_waitcnt vmcnt(40)
    ds_read_b64_tr_b16 a[128:129], v80 offset:0
    ds_read_b64_tr_b16 a[130:131], v80 offset:2048
    ds_read_b64_tr_b16 a[132:133], v81 offset:0
    ds_read_b64_tr_b16 a[134:135], v81 offset:2048
    ds_read_b64_tr_b16 a[160:161], v80 offset:512
    ds_read_b64_tr_b16 a[162:163], v80 offset:2560
    ds_read_b64_tr_b16 a[164:165], v81 offset:512
    ds_read_b64_tr_b16 a[166:167], v81 offset:2560
    s_waitcnt vmcnt(36)
    ds_read_b64_tr_b16 a[64:65], v82 offset:0
    ds_read_b64_tr_b16 a[66:67], v82 offset:2048
    ds_read_b64_tr_b16 a[68:69], v83 offset:0
    ds_read_b64_tr_b16 a[70:71], v83 offset:2048
    ds_read_b64_tr_b16 a[72:73], v82 offset:512
    ds_read_b64_tr_b16 a[74:75], v82 offset:2560
    ds_read_b64_tr_b16 a[76:77], v83 offset:512
    ds_read_b64_tr_b16 a[78:79], v83 offset:2560
    s_waitcnt vmcnt(32)
    ds_read_b64_tr_b16 a[80:81], v80 offset:16416
    ds_read_b64_tr_b16 a[82:83], v80 offset:18464
    ds_read_b64_tr_b16 a[84:85], v81 offset:16416
    ds_read_b64_tr_b16 a[86:87], v81 offset:18464
    ds_read_b64_tr_b16 a[88:89], v80 offset:16928
    ds_read_b64_tr_b16 a[90:91], v80 offset:18976
    ds_read_b64_tr_b16 a[92:93], v81 offset:16928
    ds_read_b64_tr_b16 a[94:95], v81 offset:18976
    s_waitcnt lgkmcnt(0)
    s_xor_b32 s54, s80, 360448
    s_add_u32 m0, s41, 49536
    s_nop 0
    buffer_load_dwordx4 v12, s[60:63], s54 offen offset:0 lds
    s_add_u32 s54, s54, 7168
    buffer_load_dwordx4 v12, s[60:63], s54 offen offset:1024 lds
    s_add_u32 s54, s54, 7168
    buffer_load_dwordx4 v12, s[60:63], s54 offen offset:2048 lds
    s_add_u32 s54, s54, 7168
    buffer_load_dwordx4 v12, s[60:63], s54 offen offset:3072 lds
    s_xor_b32 s54, s80, 393216
    s_add_u32 m0, s41, 16512
    s_nop 0
    buffer_load_dwordx4 v12, s[60:63], s54 offen offset:0 lds
    s_add_u32 s54, s54, 7168
    buffer_load_dwordx4 v12, s[60:63], s54 offen offset:1024 lds
    s_add_u32 s54, s54, 7168
    buffer_load_dwordx4 v12, s[60:63], s54 offen offset:2048 lds
    s_add_u32 s54, s54, 7168
    buffer_load_dwordx4 v12, s[60:63], s54 offen offset:3072 lds
    s_waitcnt vmcnt(8)
    s_barrier
    buffer_store_dword v41, v87, s[12:15], s89 offen sc1
    buffer_load_dword v1, v86, s[12:15], s59 offen sc1
    s_xor_b32 s54, s80, 425984
    s_add_u32 m0, s40, 0
    s_nop 0
    buffer_load_dwordx4 v12, s[60:63], s54 offen offset:0 lds
    s_add_u32 s54, s54, 7168
    buffer_load_dwordx4 v12, s[60:63], s54 offen offset:1024 lds
    s_add_u32 s54, s54, 7168
    buffer_load_dwordx4 v12, s[60:63], s54 offen offset:2048 lds
    s_add_u32 s54, s54, 7168
    buffer_load_dwordx4 v12, s[60:63], s54 offen offset:3072 lds
    s_mov_b64 exec, 0
    s_cmp_eq_u32 s36, 0
    s_cbranch_scc1 L_hoq0
    s_cmp_eq_u32 s36, 1
    s_cbranch_scc1 L_hoq1
    s_cmp_eq_u32 s36, 2
    s_cbranch_scc1 L_hoq2
    s_branch L_hoq3
L_hoq3:
L_hoq_back:
    s_mov_b64 exec, -1
    v_lshrrev_b32 v31, 4, v0
    v_lshlrev_b32 v31, 3, v31
    v_and_b32 v30, 15, v0
    s_lshl_b32 s52, s36, 11
    s_add_u32 s52, s52, 148224
    v_lshl_add_u32 v29, v30, 7, v31
    v_add_u32 v29, s52, v29
    v_mul_u32_u24 v30, 144, v30
    v_add3_u32 v30, v30, v31, s40
    v_lshrrev_b32 v31, 3, v0
    v_mul_u32_u24 v31, 144, v31
    v_and_b32 v28, 7, v0
L_hoq0:
    s_cbranch_execz L_hoq_back
    v_lshl_add_u32 v31, v28, 4, v31
    v_add_u32 v31, s40, v31
    s_xor_b32 s54, s80, 458752
    s_add_u32 m0, s41, 0
    s_nop 0
    buffer_load_dwordx4 v12, s[60:63], s54 offen offset:0 lds
    ds_read_b64 v[16:17], v29 offset:0
    ds_read_b64 v[18:19], v29 offset:32
    ds_read_b64 v[20:21], v29 offset:64
    ds_read_b64 v[22:23], v29 offset:96
    s_add_u32 s52, s41, 0
    v_add_u32 v32, s52, v13
    s_xor_b32 s52, s36, 1
    s_mul_i32 s52, s52, 4128
    s_add_u32 s52, s52, 65664
    v_add_u32 v36, s52, v13
    s_add_u32 s52, s41, 16512
    v_add_u32 v33, s52, v13
    s_xor_b32 s52, s36, 2
    s_mul_i32 s52, s52, 4128
    s_add_u32 s52, s52, 82176
    v_add_u32 v37, s52, v13
    s_add_u32 s52, s41, 33024
    v_add_u32 v34, s52, v13
    s_xor_b32 s52, s36, 3
    s_mul_i32 s52, s52, 4128
    s_add_u32 s52, s52, 98688
    v_add_u32 v38, s52, v13
    s_lshl_b32 s52, s2, 2
    s_add_u32 s52, s52, s36
    s_lshl_b32 s52, s52, 12
    s_add_u32 s52, s52, 26214400
    s_xor_b32 s53, s52, 65536
    s_lshl_b32 s56, s2, 7
    s_add_u32 s56, s56, 25182208
    s_waitcnt lgkmcnt(3)
    v_lshlrev_b32 v48, 16, v16
    v_and_b32 v49, 0xffff0000, v16
    v_lshlrev_b32 v50, 16, v17
    v_and_b32 v51, 0xffff0000, v17
    s_waitcnt lgkmcnt(2)
    v_lshlrev_b32 v52, 16, v18
    v_and_b32 v53, 0xffff0000, v18
    v_lshlrev_b32 v54, 16, v19
    v_and_b32 v55, 0xffff0000, v19
    s_waitcnt lgkmcnt(1)
    v_lshlrev_b32 v56, 16, v20
    v_and_b32 v57, 0xffff0000, v20
    v_lshlrev_b32 v58, 16, v21
    v_and_b32 v59, 0xffff0000, v21
    s_waitcnt lgkmcnt(0)
    v_lshlrev_b32 v60, 16, v22
    v_and_b32 v61, 0xffff0000, v22
    v_lshlrev_b32 v62, 16, v23
    v_and_b32 v63, 0xffff0000, v23
    s_add_u32 s54, s54, 7168
    buffer_load_dwordx4 v12, s[60:63], s54 offen offset:1024 lds
    ds_read_b64_tr_b16 a[96:97], v80 offset:32832
    ds_read_b64_tr_b16 a[98:99], v80 offset:34880
    ds_read_b64_tr_b16 a[100:101], v81 offset:32832
    ds_read_b64_tr_b16 a[102:103], v81 offset:34880
    ds_read_b64_tr_b16 a[104:105], v80 offset:33344
    ds_read_b64_tr_b16 a[106:107], v80 offset:35392
    ds_read_b64_tr_b16 a[108:109], v81 offset:33344
    ds_read_b64_tr_b16 a[110:111], v81 offset:35392
    s_add_u32 s54, s54, 7168
    buffer_load_dwordx4 v12, s[60:63], s54 offen offset:2048 lds
    ds_read_b64_tr_b16 a[112:113], v82 offset:33024
    ds_read_b64_tr_b16 a[114:115], v82 offset:35072
    ds_read_b64_tr_b16 a[116:117], v83 offset:33024
    ds_read_b64_tr_b16 a[118:119], v83 offset:35072
    ds_read_b64_tr_b16 a[120:121], v82 offset:33536
    ds_read_b64_tr_b16 a[122:123], v82 offset:35584
    ds_read_b64_tr_b16 a[124:125], v83 offset:33536
    ds_read_b64_tr_b16 a[126:127], v83 offset:35584
    s_add_u32 s54, s54, 7168
    buffer_load_dwordx4 v12, s[60:63], s54 offen offset:3072 lds
    ds_read_b64_tr_b16 a[136:137], v84 offset:0
    ds_read_b64_tr_b16 a[138:139], v84 offset:2048
    ds_read_b64_tr_b16 a[140:141], v85 offset:0
    ds_read_b64_tr_b16 a[142:143], v85 offset:2048
    ds_read_b64_tr_b16 a[144:145], v84 offset:512
    ds_read_b64_tr_b16 a[146:147], v84 offset:2560
    ds_read_b64_tr_b16 a[148:149], v85 offset:512
    ds_read_b64_tr_b16 a[150:151], v85 offset:2560
    s_xor_b32 s54, s80, 491520
    s_add_u32 m0, s40, 16416
    s_nop 0
    buffer_load_dwordx4 v12, s[60:63], s54 offen offset:0 lds
    ds_read_b64_tr_b16 a[152:153], v80 offset:49248
    ds_read_b64_tr_b16 a[154:155], v80 offset:51296
    ds_read_b64_tr_b16 a[156:157], v81 offset:49248
    ds_read_b64_tr_b16 a[158:159], v81 offset:51296
    ds_read_b64_tr_b16 a[168:169], v80 offset:49760
    ds_read_b64_tr_b16 a[170:171], v80 offset:51808
    ds_read_b64_tr_b16 a[172:173], v81 offset:49760
    ds_read_b64_tr_b16 a[174:175], v81 offset:51808
    s_add_u32 s54, s54, 7168
    buffer_load_dwordx4 v12, s[60:63], s54 offen offset:1024 lds
    s_add_u32 s54, s54, 7168
    buffer_load_dwordx4 v12, s[60:63], s54 offen offset:2048 lds
    s_add_u32 s54, s54, 7168
    buffer_load_dwordx4 v12, s[60:63], s54 offen offset:3072 lds
    s_waitcnt vmcnt(12)
    v_cmp_eq_u32 vcc, 1, v1
    s_nop 0
    s_cmp_eq_u64 vcc, -1
    s_cbranch_scc0 L_spin_fl
L_ok_fl:
    s_xor_b32 s55, s83, 4096
    buffer_load_dwordx4 v[192:195], v13, s[24:27], s55 offen sc1
    s_xor_b32 s55, s83, 5120
    buffer_load_dwordx4 v[196:199], v13, s[24:27], s55 offen sc1
    s_xor_b32 s55, s83, 6144
    buffer_load_dwordx4 v[200:203], v13, s[24:27], s55 offen sc1
    s_xor_b32 s55, s83, 7168
    buffer_load_dwordx4 v[204:207], v13, s[24:27], s55 offen sc1
    s_xor_b32 s55, s83, 20480
    buffer_load_dwordx4 v[208:211], v13, s[24:27], s55 offen sc1
    s_xor_b32 s55, s83, 21504
    buffer_load_dwordx4 v[212:215], v13, s[24:27], s55 offen sc1
    s_xor_b32 s55, s83, 22528
    buffer_load_dwordx4 v[216:219], v13, s[24:27], s55 offen sc1
    s_xor_b32 s55, s83, 23552
    buffer_load_dwordx4 v[220:223], v13, s[24:27], s55 offen sc1
    s_xor_b32 s55, s83, 36864
    buffer_load_dwordx4 v[224:227], v13, s[24:27], s55 offen sc1
    s_xor_b32 s55, s83, 37888
    buffer_load_dwordx4 v[228:231], v13, s[24:27], s55 offen sc1
    s_xor_b32 s55, s83, 38912
    buffer_load_dwordx4 v[232:235], v13, s[24:27], s55 offen sc1
    s_xor_b32 s55, s83, 39936
    buffer_load_dwordx4 v[236:239], v13, s[24:27], s55 offen sc1
    ds_read_b64_tr_b16 a[176:177], v82 offset:49536
    ds_read_b64_tr_b16 a[178:179], v82 offset:51584
    ds_read_b64_tr_b16 a[180:181], v83 offset:49536
    ds_read_b64_tr_b16 a[182:183], v83 offset:51584
    ds_read_b64_tr_b16 a[184:185], v82 offset:50048
    ds_read_b64_tr_b16 a[186:187], v82 offset:52096
    ds_read_b64_tr_b16 a[188:189], v83 offset:50048
    ds_read_b64_tr_b16 a[190:191], v83 offset:52096
    ds_read_b64_tr_b16 a[192:193], v82 offset:16512
    ds_read_b64_tr_b16 a[194:195], v82 offset:18560
    ds_read_b64_tr_b16 a[196:197], v83 offset:16512
    ds_read_b64_tr_b16 a[198:199], v83 offset:18560
    ds_read_b64_tr_b16 a[200:201], v82 offset:17024
    ds_read_b64_tr_b16 a[202:203], v82 offset:19072
    ds_read_b64_tr_b16 a[204:205], v83 offset:17024
    ds_read_b64_tr_b16 a[206:207], v83 offset:19072
    s_waitcnt vmcnt(20)
    ds_read_b64_tr_b16 a[0:1], v80 offset:0
    ds_read_b64_tr_b16 a[2:3], v80 offset:2048
    ds_read_b64_tr_b16 a[4:5], v81 offset:0
    ds_read_b64_tr_b16 a[6:7], v81 offset:2048
    ds_read_b64_tr_b16 a[8:9], v80 offset:512
    ds_read_b64_tr_b16 a[10:11], v80 offset:2560
    ds_read_b64_tr_b16 a[12:13], v81 offset:512
    ds_read_b64_tr_b16 a[14:15], v81 offset:2560
    s_waitcnt vmcnt(16)
    ds_read_b64_tr_b16 a[16:17], v82 offset:0
    ds_read_b64_tr_b16 a[18:19], v82 offset:2048
    ds_read_b64_tr_b16 a[20:21], v83 offset:0
    ds_read_b64_tr_b16 a[22:23], v83 offset:2048
    ds_read_b64_tr_b16 a[24:25], v82 offset:512
    ds_read_b64_tr_b16 a[26:27], v82 offset:2560
    ds_read_b64_tr_b16 a[28:29], v83 offset:512
    ds_read_b64_tr_b16 a[30:31], v83 offset:2560
    s_waitcnt vmcnt(12)
    ds_read_b64_tr_b16 a[32:33], v80 offset:16416
    ds_read_b64_tr_b16 a[34:35], v80 offset:18464
    ds_read_b64_tr_b16 a[36:37], v81 offset:16416
    ds_read_b64_tr_b16 a[38:39], v81 offset:18464
    ds_read_b64_tr_b16 a[40:41], v80 offset:16928
    ds_read_b64_tr_b16 a[42:43], v80 offset:18976
    ds_read_b64_tr_b16 a[44:45], v81 offset:16928
    ds_read_b64_tr_b16 a[46:47], v81 offset:18976
    s_xor_b32 s59, s89, 512
    s_waitcnt vmcnt(11)
    v_mfma_f32_16x16x32_bf16 v[144:147], a[240:243], v[192:195], 0
    s_waitcnt vmcnt(10)
    s_xor_b32 s55, s83, 53248
    v_mfma_f32_16x16x32_bf16 v[144:147], v[112:115], v[196:199], v[144:147]
    buffer_load_dwordx4 v[240:243], v13, s[24:27], s55 offen sc1
    v_mfma_f32_16x16x32_bf16 v[148:151], v[116:119], v[196:199], 0
    v_mfma_f32_16x16x32_bf16 v[148:151], a[244:247], v[192:195], v[148:151]
    v_mfma_f32_16x16x32_bf16 v[152:155], a[248:251], v[192:195], 0
    s_xor_b32 s55, s83, 54272
    v_mfma_f32_16x16x32_bf16 v[152:155], v[120:123], v[196:199], v[152:155]
    buffer_load_dwordx4 v[244:247], v13, s[24:27], s55 offen sc1
    v_mfma_f32_16x16x32_bf16 v[156:159], v[124:127], v[196:199], 0
    v_mfma_f32_16x16x32_bf16 v[156:159], a[252:255], v[192:195], v[156:159]
    s_waitcnt vmcnt(11)
    v_mfma_f32_16x16x32_bf16 v[144:147], a[208:211], v[200:203], v[144:147]
    s_waitcnt vmcnt(10)
    s_xor_b32 s55, s83, 55296
    v_mfma_f32_16x16x32_bf16 v[144:147], a[224:227], v[204:207], v[144:147]
    buffer_load_dwordx4 v[248:251], v13, s[24:27], s55 offen sc1
    v_mfma_f32_16x16x32_bf16 v[148:151], a[228:231], v[204:207], v[148:151]
    v_mfma_f32_16x16x32_bf16 v[148:151], a[212:215], v[200:203], v[148:151]
    v_mfma_f32_16x16x32_bf16 v[152:155], a[216:219], v[200:203], v[152:155]
    s_xor_b32 s55, s83, 56320
    v_mfma_f32_16x16x32_bf16 v[152:155], a[232:235], v[204:207], v[152:155]
    buffer_load_dwordx4 v[252:255], v13, s[24:27], s55 offen sc1
    v_mfma_f32_16x16x32_bf16 v[156:159], a[236:239], v[204:207], v[156:159]
    v_mfma_f32_16x16x32_bf16 v[156:159], a[220:223], v[200:203], v[156:159]
    s_waitcnt vmcnt(11)
    v_mfma_f32_16x16x32_bf16 v[144:147], a[128:131], v[208:211], v[144:147]
    s_waitcnt vmcnt(10)
    s_xor_b32 s55, s83, 8192
    v_mfma_f32_16x16x32_bf16 v[144:147], a[64:67], v[212:215], v[144:147]
    buffer_load_dwordx4 a[48:51], v13, s[24:27], s55 offen sc1
    v_mfma_f32_16x16x32_bf16 v[148:151], a[68:71], v[212:215], v[148:151]
    v_mfma_f32_16x16x32_bf16 v[148:151], a[132:135], v[208:211], v[148:151]
    v_mfma_f32_16x16x32_bf16 v[152:155], a[160:163], v[208:211], v[152:155]
    s_xor_b32 s55, s83, 9216
    v_mfma_f32_16x16x32_bf16 v[152:155], a[72:75], v[212:215], v[152:155]
    buffer_load_dwordx4 a[52:55], v13, s[24:27], s55 offen sc1
    v_mfma_f32_16x16x32_bf16 v[156:159], a[76:79], v[212:215], v[156:159]
    v_mfma_f32_16x16x32_bf16 v[156:159], a[164:167], v[208:211], v[156:159]
    s_waitcnt vmcnt(11)
    v_mfma_f32_16x16x32_bf16 v[144:147], a[80:83], v[216:219], v[144:147]
    s_waitcnt lgkmcnt(0) vmcnt(10)
    s_xor_b32 s55, s83, 10240
    v_mfma_f32_16x16x32_bf16 v[144:147], a[96:99], v[220:223], v[144:147]
    buffer_load_dwordx4 a[56:59], v13, s[24:27], s55 offen sc1
    v_mfma_f32_16x16x32_bf16 v[148:151], a[100:103], v[220:223], v[148:151]
    v_mfma_f32_16x16x32_bf16 v[148:151], a[84:87], v[216:219], v[148:151]
    v_mfma_f32_16x16x32_bf16 v[152:155], a[88:91], v[216:219], v[152:155]
    s_xor_b32 s55, s83, 11264
    v_mfma_f32_16x16x32_bf16 v[152:155], a[104:107], v[220:223], v[152:155]
    buffer_load_dwordx4 a[60:63], v13, s[24:27], s55 offen sc1
    v_mfma_f32_16x16x32_bf16 v[156:159], a[108:111], v[220:223], v[156:159]
    v_mfma_f32_16x16x32_bf16 v[156:159], a[92:95], v[216:219], v[156:159]
    s_waitcnt vmcnt(11)
    v_mfma_f32_16x16x32_bf16 v[144:147], a[112:115], v[224:227], v[144:147]
    s_waitcnt vmcnt(10)
    s_xor_b32 s55, s83, 24576
    v_mfma_f32_16x16x32_bf16 v[144:147], a[136:139], v[228:231], v[144:147]
    buffer_load_dwordx4 v[192:195], v13, s[24:27], s55 offen sc1
    v_mfma_f32_16x16x32_bf16 v[148:151], a[140:143], v[228:231], v[148:151]
    v_mfma_f32_16x16x32_bf16 v[148:151], a[116:119], v[224:227], v[148:151]
    v_mfma_f32_16x16x32_bf16 v[152:155], a[120:123], v[224:227], v[152:155]
    s_xor_b32 s55, s83, 25600
    v_mfma_f32_16x16x32_bf16 v[152:155], a[144:147], v[228:231], v[152:155]
    buffer_load_dwordx4 v[196:199], v13, s[24:27], s55 offen sc1
    v_mfma_f32_16x16x32_bf16 v[156:159], a[148:151], v[228:231], v[156:159]
    v_mfma_f32_16x16x32_bf16 v[156:159], a[124:127], v[224:227], v[156:159]
    s_waitcnt vmcnt(11)
    v_mfma_f32_16x16x32_bf16 v[144:147], a[152:155], v[232:235], v[144:147]
    s_waitcnt vmcnt(10)
    s_xor_b32 s55, s83, 26624
    v_mfma_f32_16x16x32_bf16 v[144:147], a[176:179], v[236:239], v[144:147]
    buffer_load_dwordx4 v[200:203], v13, s[24:27], s55 offen sc1
    v_mfma_f32_16x16x32_bf16 v[148:151], a[180:183], v[236:239], v[148:151]
    v_mfma_f32_16x16x32_bf16 v[148:151], a[156:159], v[232:235], v[148:151]
    v_mfma_f32_16x16x32_bf16 v[152:155], a[168:171], v[232:235], v[152:155]
    s_xor_b32 s55, s83, 27648
    v_mfma_f32_16x16x32_bf16 v[152:155], a[184:187], v[236:239], v[152:155]
    buffer_load_dwordx4 v[204:207], v13, s[24:27], s55 offen sc1
    v_mfma_f32_16x16x32_bf16 v[156:159], a[188:191], v[236:239], v[156:159]
    v_mfma_f32_16x16x32_bf16 v[156:159], a[172:175], v[232:235], v[156:159]
    s_waitcnt vmcnt(11)
    v_mfma_f32_16x16x32_bf16 v[144:147], a[192:195], v[240:243], v[144:147]
    s_waitcnt vmcnt(10)
    s_xor_b32 s55, s83, 40960
    v_mfma_f32_16x16x32_bf16 v[144:147], a[0:3], v[244:247], v[144:147]
    buffer_load_dwordx4 v[208:211], v13, s[24:27], s55 offen sc1
    v_mfma_f32_16x16x32_bf16 v[148:151], a[4:7], v[244:247], v[148:151]
    v_mfma_f32_16x16x32_bf16 v[148:151], a[196:199], v[240:243], v[148:151]
    v_mfma_f32_16x16x32_bf16 v[152:155], a[200:203], v[240:243], v[152:155]
    s_xor_b32 s55, s83, 41984
    v_mfma_f32_16x16x32_bf16 v[152:155], a[8:11], v[244:247], v[152:155]
    buffer_load_dwordx4 v[212:215], v13, s[24:27], s55 offen sc1
    v_mfma_f32_16x16x32_bf16 v[156:159], a[12:15], v[244:247], v[156:159]
    v_mfma_f32_16x16x32_bf16 v[156:159], a[204:207], v[240:243], v[156:159]
    s_waitcnt vmcnt(11)
    v_mfma_f32_16x16x32_bf16 v[144:147], a[16:19], v[248:251], v[144:147]
    s_waitcnt vmcnt(10)
    s_xor_b32 s55, s83, 43008
    v_mfma_f32_16x16x32_bf16 v[144:147], a[32:35], v[252:255], v[144:147]
    buffer_load_dwordx4 v[216:219], v13, s[24:27], s55 offen sc1
    v_mfma_f32_16x16x32_bf16 v[148:151], a[36:39], v[252:255], v[148:151]
    v_mfma_f32_16x16x32_bf16 v[148:151], a[20:23], v[248:251], v[148:151]
    v_mfma_f32_16x16x32_bf16 v[152:155], a[24:27], v[248:251], v[152:155]
    s_xor_b32 s55, s83, 44032
    v_mfma_f32_16x16x32_bf16 v[152:155], a[40:43], v[252:255], v[152:155]
    buffer_load_dwordx4 v[220:223], v13, s[24:27], s55 offen sc1
    v_mfma_f32_16x16x32_bf16 v[156:159], a[44:47], v[252:255], v[156:159]
    v_mfma_f32_16x16x32_bf16 v[156:159], a[28:31], v[248:251], v[156:159]
    s_waitcnt vmcnt(11)
    v_mfma_f32_16x16x32_bf16 v[160:163], a[240:243], a[48:51], 0
    s_waitcnt vmcnt(10)
    s_xor_b32 s55, s83, 57344
    v_mfma_f32_16x16x32_bf16 v[160:163], v[112:115], a[52:55], v[160:163]
    buffer_load_dwordx4 v[224:227], v13, s[24:27], s55 offen sc1
    v_mfma_f32_16x16x32_bf16 v[164:167], v[116:119], a[52:55], 0
    v_mfma_f32_16x16x32_bf16 v[164:167], a[244:247], a[48:51], v[164:167]
    v_mfma_f32_16x16x32_bf16 v[168:171], a[248:251], a[48:51], 0
    s_xor_b32 s55, s83, 58368
    ds_write_b128 v32, v[144:147] offset:0
    v_mfma_f32_16x16x32_bf16 v[168:171], v[120:123], a[52:55], v[168:171]
    buffer_load_dwordx4 v[228:231], v13, s[24:27], s55 offen sc1
    v_mfma_f32_16x16x32_bf16 v[172:175], v[124:127], a[52:55], 0
    ds_write_b128 v32, v[148:151] offset:1024
    v_mfma_f32_16x16x32_bf16 v[172:175], a[252:255], a[48:51], v[172:175]
    s_waitcnt vmcnt(11)
    v_mfma_f32_16x16x32_bf16 v[160:163], a[208:211], a[56:59], v[160:163]
    s_waitcnt vmcnt(10)
    s_xor_b32 s55, s83, 59392
    ds_write_b128 v32, v[152:155] offset:2048
    v_mfma_f32_16x16x32_bf16 v[160:163], a[224:227], a[60:63], v[160:163]
    buffer_load_dwordx4 v[232:235], v13, s[24:27], s55 offen sc1
    v_mfma_f32_16x16x32_bf16 v[164:167], a[228:231], a[60:63], v[164:167]
    ds_write_b128 v32, v[156:159] offset:3072
    v_mfma_f32_16x16x32_bf16 v[164:167], a[212:215], a[56:59], v[164:167]
    v_mfma_f32_16x16x32_bf16 v[168:171], a[216:219], a[56:59], v[168:171]
    s_xor_b32 s55, s83, 60416
    v_mfma_f32_16x16x32_bf16 v[168:171], a[232:235], a[60:63], v[168:171]
    buffer_load_dwordx4 v[236:239], v13, s[24:27], s55 offen sc1
    v_mfma_f32_16x16x32_bf16 v[172:175], a[236:239], a[60:63], v[172:175]
    v_mfma_f32_16x16x32_bf16 v[172:175], a[220:223], a[56:59], v[172:175]
    s_waitcnt vmcnt(11)
    v_mfma_f32_16x16x32_bf16 v[160:163], a[128:131], v[192:195], v[160:163]
    s_waitcnt vmcnt(10)
    s_xor_b32 s55, s83, 12288
    v_mfma_f32_16x16x32_bf16 v[160:163], a[64:67], v[196:199], v[160:163]
    buffer_load_dwordx4 v[240:243], v13, s[24:27], s55 offen sc1
    v_mfma_f32_16x16x32_bf16 v[164:167], a[68:71], v[196:199], v[164:167]
    v_mfma_f32_16x16x32_bf16 v[164:167], a[132:135], v[192:195], v[164:167]
    v_mfma_f32_16x16x32_bf16 v[168:171], a[160:163], v[192:195], v[168:171]
    s_xor_b32 s55, s83, 13312
    v_mfma_f32_16x16x32_bf16 v[168:171], a[72:75], v[196:199], v[168:171]
    buffer_load_dwordx4 v[244:247], v13, s[24:27], s55 offen sc1
    v_mfma_f32_16x16x32_bf16 v[172:175], a[76:79], v[196:199], v[172:175]
    v_mfma_f32_16x16x32_bf16 v[172:175], a[164:167], v[192:195], v[172:175]
    s_waitcnt vmcnt(11)
    v_mfma_f32_16x16x32_bf16 v[160:163], a[80:83], v[200:203], v[160:163]
    s_waitcnt vmcnt(10)
    s_xor_b32 s55, s83, 14336
    v_mfma_f32_16x16x32_bf16 v[160:163], a[96:99], v[204:207], v[160:163]
    buffer_load_dwordx4 v[248:251], v13, s[24:27], s55 offen sc1
    v_mfma_f32_16x16x32_bf16 v[164:167], a[100:103], v[204:207], v[164:167]
    v_mfma_f32_16x16x32_bf16 v[164:167], a[84:87], v[200:203], v[164:167]
    v_mfma_f32_16x16x32_bf16 v[168:171], a[88:91], v[200:203], v[168:171]
    s_xor_b32 s55, s83, 15360
    v_mfma_f32_16x16x32_bf16 v[168:171], a[104:107], v[204:207], v[168:171]
    buffer_load_dwordx4 v[252:255], v13, s[24:27], s55 offen sc1
    v_mfma_f32_16x16x32_bf16 v[172:175], a[108:111], v[204:207], v[172:175]
    v_mfma_f32_16x16x32_bf16 v[172:175], a[92:95], v[200:203], v[172:175]
    s_waitcnt vmcnt(11)
    v_mfma_f32_16x16x32_bf16 v[160:163], a[112:115], v[208:211], v[160:163]
    s_waitcnt vmcnt(10)
    s_xor_b32 s55, s83, 28672
    v_mfma_f32_16x16x32_bf16 v[160:163], a[136:139], v[212:215], v[160:163]
    buffer_load_dwordx4 a[48:51], v13, s[24:27], s55 offen sc1
    v_mfma_f32_16x16x32_bf16 v[164:167], a[140:143], v[212:215], v[164:167]
    v_mfma_f32_16x16x32_bf16 v[164:167], a[116:119], v[208:211], v[164:167]
    v_mfma_f32_16x16x32_bf16 v[168:171], a[120:123], v[208:211], v[168:171]
    s_xor_b32 s55, s83, 29696
    buffer_load_dword v1, off, s[12:15], s59 sc1
    v_mfma_f32_16x16x32_bf16 v[168:171], a[144:147], v[212:215], v[168:171]
    buffer_load_dwordx4 a[52:55], v13, s[24:27], s55 offen sc1
    v_mfma_f32_16x16x32_bf16 v[172:175], a[148:151], v[212:215], v[172:175]
    v_mfma_f32_16x16x32_bf16 v[172:175], a[124:127], v[208:211], v[172:175]
    s_waitcnt vmcnt(12)
    v_mfma_f32_16x16x32_bf16 v[160:163], a[152:155], v[216:219], v[160:163]
    s_waitcnt vmcnt(11)
    s_xor_b32 s55, s83, 30720
    v_mfma_f32_16x16x32_bf16 v[160:163], a[176:179], v[220:223], v[160:163]
    buffer_load_dwordx4 a[56:59], v13, s[24:27], s55 offen sc1
    v_mfma_f32_16x16x32_bf16 v[164:167], a[180:183], v[220:223], v[164:167]
    v_mfma_f32_16x16x32_bf16 v[164:167], a[156:159], v[216:219], v[164:167]
    v_mfma_f32_16x16x32_bf16 v[168:171], a[168:171], v[216:219], v[168:171]
    s_xor_b32 s55, s83, 31744
    v_mfma_f32_16x16x32_bf16 v[168:171], a[184:187], v[220:223], v[168:171]
    buffer_load_dwordx4 a[60:63], v13, s[24:27], s55 offen sc1
    v_mfma_f32_16x16x32_bf16 v[172:175], a[188:191], v[220:223], v[172:175]
    v_mfma_f32_16x16x32_bf16 v[172:175], a[172:175], v[216:219], v[172:175]
    s_waitcnt vmcnt(12)
    v_mfma_f32_16x16x32_bf16 v[160:163], a[192:195], v[224:227], v[160:163]
    s_waitcnt vmcnt(11)
    s_xor_b32 s55, s83, 45056
    v_mfma_f32_16x16x32_bf16 v[160:163], a[0:3], v[228:231], v[160:163]
    buffer_load_dwordx4 v[192:195], v13, s[24:27], s55 offen sc1
    v_mfma_f32_16x16x32_bf16 v[164:167], a[4:7], v[228:231], v[164:167]
    v_mfma_f32_16x16x32_bf16 v[164:167], a[196:199], v[224:227], v[164:167]
    v_mfma_f32_16x16x32_bf16 v[168:171], a[200:203], v[224:227], v[168:171]
    s_xor_b32 s55, s83, 46080
    v_mfma_f32_16x16x32_bf16 v[168:171], a[8:11], v[228:231], v[168:171]
    buffer_load_dwordx4 v[196:199], v13, s[24:27], s55 offen sc1
    v_mfma_f32_16x16x32_bf16 v[172:175], a[12:15], v[228:231], v[172:175]
    v_mfma_f32_16x16x32_bf16 v[172:175], a[204:207], v[224:227], v[172:175]
    s_waitcnt vmcnt(12)
    v_mfma_f32_16x16x32_bf16 v[160:163], a[16:19], v[232:235], v[160:163]
    s_waitcnt vmcnt(11)
    s_xor_b32 s55, s83, 47104
    v_mfma_f32_16x16x32_bf16 v[160:163], a[32:35], v[236:239], v[160:163]
    buffer_load_dwordx4 v[200:203], v13, s[24:27], s55 offen sc1
    v_mfma_f32_16x16x32_bf16 v[164:167], a[36:39], v[236:239], v[164:167]
    v_mfma_f32_16x16x32_bf16 v[164:167], a[20:23], v[232:235], v[164:167]
    v_mfma_f32_16x16x32_bf16 v[168:171], a[24:27], v[232:235], v[168:171]
    s_xor_b32 s55, s83, 48128
    v_mfma_f32_16x16x32_bf16 v[168:171], a[40:43], v[236:239], v[168:171]
    buffer_load_dwordx4 v[204:207], v13, s[24:27], s55 offen sc1
    v_mfma_f32_16x16x32_bf16 v[172:175], a[44:47], v[236:239], v[172:175]
    v_mfma_f32_16x16x32_bf16 v[172:175], a[28:31], v[232:235], v[172:175]
    s_waitcnt vmcnt(12)
    v_mfma_f32_16x16x32_bf16 v[176:179], a[240:243], v[240:243], 0
    s_waitcnt vmcnt(11)
    s_xor_b32 s55, s83, 61440
    v_mfma_f32_16x16x32_bf16 v[176:179], v[112:115], v[244:247], v[176:179]
    buffer_load_dwordx4 v[208:211], v13, s[24:27], s55 offen sc1
    v_mfma_f32_16x16x32_bf16 v[180:183], v[116:119], v[244:247], 0
    v_mfma_f32_16x16x32_bf16 v[180:183], a[244:247], v[240:243], v[180:183]
    v_mfma_f32_16x16x32_bf16 v[184:187], a[248:251], v[240:243], 0
    s_xor_b32 s55, s83, 62464
    ds_write_b128 v33, v[160:163] offset:0
    v_mfma_f32_16x16x32_bf16 v[184:187], v[120:123], v[244:247], v[184:187]
    buffer_load_dwordx4 v[212:215], v13, s[24:27], s55 offen sc1
    v_mfma_f32_16x16x32_bf16 v[188:191], v[124:127], v[244:247], 0
    ds_write_b128 v33, v[164:167] offset:1024
    v_mfma_f32_16x16x32_bf16 v[188:191], a[252:255], v[240:243], v[188:191]
    s_waitcnt vmcnt(12)
    v_mfma_f32_16x16x32_bf16 v[176:179], a[208:211], v[248:251], v[176:179]
    s_waitcnt vmcnt(11)
    s_xor_b32 s55, s83, 63488
    ds_write_b128 v33, v[168:171] offset:2048
    v_mfma_f32_16x16x32_bf16 v[176:179], a[224:227], v[252:255], v[176:179]
    buffer_load_dwordx4 v[216:219], v13, s[24:27], s55 offen sc1
    v_mfma_f32_16x16x32_bf16 v[180:183], a[228:231], v[252:255], v[180:183]
    ds_write_b128 v33, v[172:175] offset:3072
    v_mfma_f32_16x16x32_bf16 v[180:183], a[212:215], v[248:251], v[180:183]
    v_mfma_f32_16x16x32_bf16 v[184:187], a[216:219], v[248:251], v[184:187]
    s_xor_b32 s55, s83, 64512
    v_mfma_f32_16x16x32_bf16 v[184:187], a[232:235], v[252:255], v[184:187]
    buffer_load_dwordx4 v[220:223], v13, s[24:27], s55 offen sc1
    v_mfma_f32_16x16x32_bf16 v[188:191], a[236:239], v[252:255], v[188:191]
    v_mfma_f32_16x16x32_bf16 v[188:191], a[220:223], v[248:251], v[188:191]
    s_waitcnt vmcnt(12)
    v_mfma_f32_16x16x32_bf16 v[176:179], a[128:131], a[48:51], v[176:179]
    s_waitcnt vmcnt(10)
    s_xor_b32 s55, s83, 0
    v_mfma_f32_16x16x32_bf16 v[176:179], a[64:67], a[52:55], v[176:179]
    buffer_load_dwordx4 v[224:227], v13, s[24:27], s55 offen sc1
    v_mfma_f32_16x16x32_bf16 v[180:183], a[68:71], a[52:55], v[180:183]
    v_mfma_f32_16x16x32_bf16 v[180:183], a[132:135], a[48:51], v[180:183]
    v_mfma_f32_16x16x32_bf16 v[184:187], a[160:163], a[48:51], v[184:187]
    s_xor_b32 s55, s83, 1024
    v_mfma_f32_16x16x32_bf16 v[184:187], a[72:75], a[52:55], v[184:187]
    buffer_load_dwordx4 v[228:231], v13, s[24:27], s55 offen sc1
    v_mfma_f32_16x16x32_bf16 v[188:191], a[76:79], a[52:55], v[188:191]
    v_mfma_f32_16x16x32_bf16 v[188:191], a[164:167], a[48:51], v[188:191]
    s_waitcnt vmcnt(11)
    v_mfma_f32_16x16x32_bf16 v[176:179], a[80:83], a[56:59], v[176:179]
    s_waitcnt vmcnt(10)
    s_xor_b32 s55, s83, 2048
    v_mfma_f32_16x16x32_bf16 v[176:179], a[96:99], a[60:63], v[176:179]
    buffer_load_dwordx4 v[232:235], v13, s[24:27], s55 offen sc1
    v_mfma_f32_16x16x32_bf16 v[180:183], a[100:103], a[60:63], v[180:183]
    v_mfma_f32_16x16x32_bf16 v[180:183], a[84:87], a[56:59], v[180:183]
    v_mfma_f32_16x16x32_bf16 v[184:187], a[88:91], a[56:59], v[184:187]
    s_xor_b32 s55, s83, 3072
    v_mfma_f32_16x16x32_bf16 v[184:187], a[104:107], a[60:63], v[184:187]
    buffer_load_dwordx4 v[236:239], v13, s[24:27], s55 offen sc1
    v_mfma_f32_16x16x32_bf16 v[188:191], a[108:111], a[60:63], v[188:191]
    v_mfma_f32_16x16x32_bf16 v[188:191], a[92:95], a[56:59], v[188:191]
    s_waitcnt vmcnt(11)
    v_mfma_f32_16x16x32_bf16 v[176:179], a[112:115], v[192:195], v[176:179]
    s_xor_b32 s55, s83, 16384
    v_cmp_eq_u32 vcc, 1, v1
    s_nop 0
    s_cmp_eq_u64 vcc, -1
    s_cbranch_scc0 L_spin_f3
L_ok_f3:
    s_xor_b32 s59, s56, 512
    s_waitcnt vmcnt(10)
    v_mfma_f32_16x16x32_bf16 v[176:179], a[136:139], v[196:199], v[176:179]
    buffer_load_dwordx4 v[240:243], v13, s[24:27], s55 offen sc1
    v_mfma_f32_16x16x32_bf16 v[180:183], a[140:143], v[196:199], v[180:183]
    buffer_load_dwordx4 v[104:107], v13, s[12:15], s53 offen offset:2048 sc1
    v_mfma_f32_16x16x32_bf16 v[180:183], a[116:119], v[192:195], v[180:183]
    buffer_load_dwordx4 v[108:111], v13, s[12:15], s53 offen offset:3072 sc1
    v_mfma_f32_16x16x32_bf16 v[184:187], a[120:123], v[192:195], v[184:187]
    s_xor_b32 s55, s83, 17408
    v_mfma_f32_16x16x32_bf16 v[184:187], a[144:147], v[196:199], v[184:187]
    buffer_load_dwordx4 v[244:247], v13, s[24:27], s55 offen sc1
    v_mfma_f32_16x16x32_bf16 v[188:191], a[148:151], v[196:199], v[188:191]
    v_mfma_f32_16x16x32_bf16 v[188:191], a[124:127], v[192:195], v[188:191]
    s_waitcnt vmcnt(13)
    v_mfma_f32_16x16x32_bf16 v[176:179], a[152:155], v[200:203], v[176:179]
    s_waitcnt vmcnt(12)
    s_xor_b32 s55, s83, 18432
    v_mfma_f32_16x16x32_bf16 v[176:179], a[176:179], v[204:207], v[176:179]
    buffer_load_dwordx4 v[248:251], v13, s[24:27], s55 offen sc1
    v_mfma_f32_16x16x32_bf16 v[180:183], a[180:183], v[204:207], v[180:183]
    v_mfma_f32_16x16x32_bf16 v[180:183], a[156:159], v[200:203], v[180:183]
    v_mfma_f32_16x16x32_bf16 v[184:187], a[168:171], v[200:203], v[184:187]
    s_xor_b32 s55, s83, 19456
    v_mfma_f32_16x16x32_bf16 v[184:187], a[184:187], v[204:207], v[184:187]
    buffer_load_dwordx4 v[252:255], v13, s[24:27], s55 offen sc1
    v_mfma_f32_16x16x32_bf16 v[188:191], a[188:191], v[204:207], v[188:191]
    v_mfma_f32_16x16x32_bf16 v[188:191], a[172:175], v[200:203], v[188:191]
    s_waitcnt vmcnt(13)
    v_mfma_f32_16x16x32_bf16 v[176:179], a[192:195], v[208:211], v[176:179]
    s_waitcnt vmcnt(12)
    s_xor_b32 s55, s83, 32768
    v_mfma_f32_16x16x32_bf16 v[176:179], a[0:3], v[212:215], v[176:179]
    buffer_load_dwordx4 a[48:51], v13, s[24:27], s55 offen sc1
    v_mfma_f32_16x16x32_bf16 v[180:183], a[4:7], v[212:215], v[180:183]
    v_mfma_f32_16x16x32_bf16 v[180:183], a[196:199], v[208:211], v[180:183]
    v_mfma_f32_16x16x32_bf16 v[184:187], a[200:203], v[208:211], v[184:187]
    s_xor_b32 s55, s83, 33792
    v_mfma_f32_16x16x32_bf16 v[184:187], a[8:11], v[212:215], v[184:187]
    buffer_load_dwordx4 a[52:55], v13, s[24:27], s55 offen sc1
    v_mfma_f32_16x16x32_bf16 v[188:191], a[12:15], v[212:215], v[188:191]
    v_mfma_f32_16x16x32_bf16 v[188:191], a[204:207], v[208:211], v[188:191]
    s_waitcnt vmcnt(13)
    v_mfma_f32_16x16x32_bf16 v[176:179], a[16:19], v[216:219], v[176:179]
    s_waitcnt vmcnt(12)
    s_xor_b32 s55, s83, 34816
    v_mfma_f32_16x16x32_bf16 v[176:179], a[32:35], v[220:223], v[176:179]
    buffer_load_dwordx4 a[56:59], v13, s[24:27], s55 offen sc1
    v_mfma_f32_16x16x32_bf16 v[180:183], a[36:39], v[220:223], v[180:183]
    v_mfma_f32_16x16x32_bf16 v[180:183], a[20:23], v[216:219], v[180:183]
    v_mfma_f32_16x16x32_bf16 v[184:187], a[24:27], v[216:219], v[184:187]
    s_xor_b32 s55, s83, 35840
    v_mfma_f32_16x16x32_bf16 v[184:187], a[40:43], v[220:223], v[184:187]
    buffer_load_dwordx4 a[60:63], v13, s[24:27], s55 offen sc1
    v_mfma_f32_16x16x32_bf16 v[188:191], a[44:47], v[220:223], v[188:191]
    v_mfma_f32_16x16x32_bf16 v[188:191], a[28:31], v[216:219], v[188:191]
    s_waitcnt vmcnt(13)
    v_mfma_f32_16x16x32_bf16 v[128:131], a[240:243], v[224:227], 0
    s_waitcnt vmcnt(12)
    s_xor_b32 s55, s83, 49152
    v_mfma_f32_16x16x32_bf16 v[128:131], v[112:115], v[228:231], v[128:131]
    buffer_load_dwordx4 v[192:195], v13, s[24:27], s55 offen sc1
    v_mfma_f32_16x16x32_bf16 v[132:135], v[116:119], v[228:231], 0
    v_mfma_f32_16x16x32_bf16 v[132:135], a[244:247], v[224:227], v[132:135]
    v_mfma_f32_16x16x32_bf16 v[136:139], a[248:251], v[224:227], 0
    s_xor_b32 s55, s83, 50176
    ds_write_b128 v34, v[176:179] offset:0
    v_mfma_f32_16x16x32_bf16 v[136:139], v[120:123], v[228:231], v[136:139]
    buffer_load_dwordx4 v[196:199], v13, s[24:27], s55 offen sc1
    v_mfma_f32_16x16x32_bf16 v[140:143], v[124:127], v[228:231], 0
    ds_write_b128 v34, v[180:183] offset:1024
    v_mfma_f32_16x16x32_bf16 v[140:143], a[252:255], v[224:227], v[140:143]
    s_waitcnt vmcnt(13)
    v_mfma_f32_16x16x32_bf16 v[128:131], a[208:211], v[232:235], v[128:131]
    s_waitcnt vmcnt(12)
    s_xor_b32 s55, s83, 51200
    ds_write_b128 v34, v[184:187] offset:2048
    v_mfma_f32_16x16x32_bf16 v[128:131], a[224:227], v[236:239], v[128:131]
    buffer_load_dwordx4 v[200:203], v13, s[24:27], s55 offen sc1
    v_mfma_f32_16x16x32_bf16 v[132:135], a[228:231], v[236:239], v[132:135]
    ds_write_b128 v34, v[188:191] offset:3072
    v_mfma_f32_16x16x32_bf16 v[132:135], a[212:215], v[232:235], v[132:135]
    v_mfma_f32_16x16x32_bf16 v[136:139], a[216:219], v[232:235], v[136:139]
    s_xor_b32 s55, s83, 52224
    v_mfma_f32_16x16x32_bf16 v[136:139], a[232:235], v[236:239], v[136:139]
    buffer_load_dwordx4 v[204:207], v13, s[24:27], s55 offen sc1
    v_mfma_f32_16x16x32_bf16 v[140:143], a[236:239], v[236:239], v[140:143]
L_hoq1:
    s_cbranch_execz L_hoq_back
    v_mfma_f32_16x16x32_bf16 v[140:143], a[220:223], v[232:235], v[140:143]
    s_waitcnt lgkmcnt(0)
    s_barrier
    ds_read_b128 v[144:147], v36 offset:0
    s_waitcnt vmcnt(13)
    v_mfma_f32_16x16x32_bf16 v[128:131], a[128:131], v[240:243], v[128:131]
    s_waitcnt vmcnt(10)
    s_xor_b32 s55, s83, 4096
    ds_read_b128 v[160:163], v37 offset:0
    v_mfma_f32_16x16x32_bf16 v[128:131], a[64:67], v[244:247], v[128:131]
    buffer_load_dwordx4 v[208:211], v13, s[16:19], s55 offen sc1
    v_mfma_f32_16x16x32_bf16 v[132:135], a[68:71], v[244:247], v[132:135]
    ds_read_b128 v[176:179], v38 offset:0
    v_mfma_f32_16x16x32_bf16 v[132:135], a[132:135], v[240:243], v[132:135]
    ds_read_b128 v[148:151], v36 offset:1024
    v_mfma_f32_16x16x32_bf16 v[136:139], a[160:163], v[240:243], v[136:139]
    s_xor_b32 s55, s83, 5120
    ds_read_b128 v[164:167], v37 offset:1024
    v_mfma_f32_16x16x32_bf16 v[136:139], a[72:75], v[244:247], v[136:139]
    buffer_load_dwordx4 v[212:215], v13, s[16:19], s55 offen sc1
    v_mfma_f32_16x16x32_bf16 v[140:143], a[76:79], v[244:247], v[140:143]
    ds_read_b128 v[180:183], v38 offset:1024
    v_mfma_f32_16x16x32_bf16 v[140:143], a[164:167], v[240:243], v[140:143]
    s_waitcnt vmcnt(11)
    ds_read_b128 v[152:155], v36 offset:2048
    v_lshlrev_b32 v96, 16, v104
    v_mfma_f32_16x16x32_bf16 v[128:131], a[80:83], v[248:251], v[128:131]
    s_waitcnt vmcnt(10)
    s_xor_b32 s55, s83, 6144
    ds_read_b128 v[168:171], v37 offset:2048
    v_and_b32 v97, 0xffff0000, v104
    v_mfma_f32_16x16x32_bf16 v[128:131], a[96:99], v[252:255], v[128:131]
    buffer_load_dwordx4 v[216:219], v13, s[16:19], s55 offen sc1
    v_mfma_f32_16x16x32_bf16 v[132:135], a[100:103], v[252:255], v[132:135]
    ds_read_b128 v[184:187], v38 offset:2048
    v_lshlrev_b32 v98, 16, v105
    v_mfma_f32_16x16x32_bf16 v[132:135], a[84:87], v[248:251], v[132:135]
    s_waitcnt lgkmcnt(4)
    ds_read_b128 v[156:159], v36 offset:3072
    v_add_f32_e64 v176, v176, v144
    v_mfma_f32_16x16x32_bf16 v[136:139], a[88:91], v[248:251], v[136:139]
    s_xor_b32 s55, s83, 7168
    ds_read_b128 v[172:175], v37 offset:3072
    v_add_f32 v177, v177, v145
    v_mfma_f32_16x16x32_bf16 v[136:139], a[104:107], v[252:255], v[136:139]
    buffer_load_dwordx4 v[220:223], v13, s[16:19], s55 offen sc1
    v_add_f32 v178, v178, v146
    v_mfma_f32_16x16x32_bf16 v[140:143], a[108:111], v[252:255], v[140:143]
    ds_read_b128 v[188:191], v38 offset:3072
    v_add_f32 v179, v179, v147
    v_mfma_f32_16x16x32_bf16 v[140:143], a[92:95], v[248:251], v[140:143]
    s_waitcnt vmcnt(11)
    v_add_f32 v176, v176, v160
    v_and_b32 v99, 0xffff0000, v105
    v_mfma_f32_16x16x32_bf16 v[128:131], a[112:115], a[48:51], v[128:131]
    s_waitcnt vmcnt(10)
    s_xor_b32 s55, s83, 20480
    v_add_f32 v177, v177, v161
    v_lshlrev_b32 v100, 16, v106
    v_mfma_f32_16x16x32_bf16 v[128:131], a[136:139], a[52:55], v[128:131]
    buffer_load_dwordx4 v[224:227], v13, s[16:19], s55 offen sc1
    v_add_f32 v178, v178, v162
    v_mfma_f32_16x16x32_bf16 v[132:135], a[140:143], a[52:55], v[132:135]
    v_add_f32 v179, v179, v163
    v_and_b32 v101, 0xffff0000, v106
    v_mfma_f32_16x16x32_bf16 v[132:135], a[116:119], a[48:51], v[132:135]
    s_waitcnt lgkmcnt(1)
    v_add_f32 v180, v180, v148
    v_lshlrev_b32 v102, 16, v107
    v_mfma_f32_16x16x32_bf16 v[136:139], a[120:123], a[48:51], v[136:139]
    s_xor_b32 s55, s83, 21504
    v_add_f32 v181, v181, v149
    v_and_b32 v103, 0xffff0000, v107
    v_mfma_f32_16x16x32_bf16 v[136:139], a[144:147], a[52:55], v[136:139]
    buffer_load_dwordx4 v[228:231], v13, s[16:19], s55 offen sc1
    v_add_f32 v182, v182, v150
    v_mfma_f32_16x16x32_bf16 v[140:143], a[148:151], a[52:55], v[140:143]
    v_lshlrev_b32 v104, 16, v108
    v_mfma_f32_16x16x32_bf16 v[140:143], a[124:127], a[48:51], v[140:143]
    s_waitcnt vmcnt(11)
    v_add_f32 v183, v183, v151
    v_and_b32 v105, 0xffff0000, v108
    v_mfma_f32_16x16x32_bf16 v[128:131], a[152:155], a[56:59], v[128:131]
    s_waitcnt vmcnt(10)
    s_xor_b32 s55, s83, 22528
    v_add_f32 v180, v180, v164
    v_lshlrev_b32 v106, 16, v109
    v_mfma_f32_16x16x32_bf16 v[128:131], a[176:179], a[60:63], v[128:131]
    buffer_load_dwordx4 v[232:235], v13, s[16:19], s55 offen sc1
    v_add_f32 v181, v181, v165
    v_mfma_f32_16x16x32_bf16 v[132:135], a[180:183], a[60:63], v[132:135]
    v_add_f32 v182, v182, v166
    v_and_b32 v107, 0xffff0000, v109
    v_mfma_f32_16x16x32_bf16 v[132:135], a[156:159], a[56:59], v[132:135]
    v_add_f32 v183, v183, v167
    v_lshlrev_b32 v108, 16, v110
    v_mfma_f32_16x16x32_bf16 v[136:139], a[168:171], a[56:59], v[136:139]
    s_xor_b32 s55, s83, 23552
    v_add_f32 v184, v184, v152
    v_and_b32 v109, 0xffff0000, v110
    v_mfma_f32_16x16x32_bf16 v[136:139], a[184:187], a[60:63], v[136:139]
    buffer_load_dwordx4 v[236:239], v13, s[16:19], s55 offen sc1
    v_add_f32 v185, v185, v153
    v_mfma_f32_16x16x32_bf16 v[140:143], a[188:191], a[60:63], v[140:143]
    v_add_f32 v186, v186, v154
    v_lshlrev_b32 v110, 16, v111
    v_mfma_f32_16x16x32_bf16 v[140:143], a[172:175], a[56:59], v[140:143]
    s_waitcnt vmcnt(11)
    v_add_f32 v187, v187, v155
    v_and_b32 v111, 0xffff0000, v111
    v_mfma_f32_16x16x32_bf16 v[128:131], a[192:195], v[192:195], v[128:131]
    s_waitcnt vmcnt(10)
    s_xor_b32 s55, s83, 36864
    v_add_f32 v184, v184, v168
    v_add_f32 v64, v64, v96
    v_mfma_f32_16x16x32_bf16 v[128:131], a[0:3], v[196:199], v[128:131]
    buffer_load_dwordx4 v[240:243], v13, s[16:19], s55 offen sc1
    v_add_f32 v185, v185, v169
    v_mfma_f32_16x16x32_bf16 v[132:135], a[4:7], v[196:199], v[132:135]
    v_add_f32 v65, v65, v97
    v_mfma_f32_16x16x32_bf16 v[132:135], a[196:199], v[192:195], v[132:135]
    v_add_f32 v186, v186, v170
    v_add_f32 v66, v66, v98
    v_mfma_f32_16x16x32_bf16 v[136:139], a[200:203], v[192:195], v[136:139]
    s_xor_b32 s55, s83, 37888
    v_add_f32 v187, v187, v171
    v_add_f32 v67, v67, v99
    v_mfma_f32_16x16x32_bf16 v[136:139], a[8:11], v[196:199], v[136:139]
    s_waitcnt lgkmcnt(0)
    buffer_load_dwordx4 v[244:247], v13, s[16:19], s55 offen sc1
    v_add_f32 v188, v188, v156
    v_mfma_f32_16x16x32_bf16 v[140:143], a[12:15], v[196:199], v[140:143]
    v_add_f32 v189, v189, v157
    v_add_f32 v68, v68, v100
    v_mfma_f32_16x16x32_bf16 v[140:143], a[204:207], v[192:195], v[140:143]
    s_waitcnt vmcnt(11)
    v_add_f32 v190, v190, v158
    v_add_f32 v69, v69, v101
    v_mfma_f32_16x16x32_bf16 v[128:131], a[16:19], v[200:203], v[128:131]
    s_waitcnt vmcnt(10)
    s_xor_b32 s55, s83, 38912
    v_add_f32 v191, v191, v159
    v_add_f32 v70, v70, v102
    v_mfma_f32_16x16x32_bf16 v[128:131], a[32:35], v[204:207], v[128:131]
    buffer_load_dwordx4 v[248:251], v13, s[16:19], s55 offen sc1
    v_add_f32 v188, v188, v172
    v_mfma_f32_16x16x32_bf16 v[132:135], a[36:39], v[204:207], v[132:135]
    v_add_f32 v189, v189, v173
    v_add_f32 v71, v71, v103
    v_mfma_f32_16x16x32_bf16 v[132:135], a[20:23], v[200:203], v[132:135]
    v_add_f32 v190, v190, v174
    v_add_f32 v72, v72, v104
    v_mfma_f32_16x16x32_bf16 v[136:139], a[24:27], v[200:203], v[136:139]
    s_xor_b32 s55, s83, 39936
    v_add_f32 v191, v191, v175
    v_add_f32_e64 v73, v73, v105
    v_mfma_f32_16x16x32_bf16 v[136:139], a[40:43], v[204:207], v[136:139]
    buffer_load_dwordx4 v[252:255], v13, s[16:19], s55 offen sc1
    v_mfma_f32_16x16x32_bf16 v[140:143], a[44:47], v[204:207], v[140:143]
    v_add_f32 v74, v74, v106
    v_mfma_f32_16x16x32_bf16 v[140:143], a[28:31], v[200:203], v[140:143]
    s_waitcnt vmcnt(11)
    v_add_f32 v75, v75, v107
    v_mfma_f32_16x16x32_bf16 v[144:147], a[240:243], v[208:211], 0
    s_waitcnt vmcnt(10)
    s_xor_b32 s55, s83, 53248
    v_add_f32_e64 v76, v76, v108
    v_mfma_f32_16x16x32_bf16 v[144:147], v[112:115], v[212:215], v[144:147]
    buffer_load_dwordx4 a[48:51], v13, s[16:19], s55 offen sc1
    v_mfma_f32_16x16x32_bf16 v[148:151], v[116:119], v[212:215], 0
    v_add_f32 v77, v77, v109
    v_mfma_f32_16x16x32_bf16 v[148:151], a[244:247], v[208:211], v[148:151]
    v_add_f32 v78, v78, v110
    v_mfma_f32_16x16x32_bf16 v[152:155], a[248:251], v[208:211], 0
    s_xor_b32 s55, s83, 54272
    v_add_f32 v128, v128, v176
    v_add_f32 v129, v129, v177
    v_mfma_f32_16x16x32_bf16 v[152:155], v[120:123], v[212:215], v[152:155]
    buffer_load_dwordx4 a[52:55], v13, s[16:19], s55 offen sc1
    v_add_f32 v130, v130, v178
    v_add_f32 v131, v131, v179
    v_mfma_f32_16x16x32_bf16 v[156:159], v[124:127], v[212:215], 0
    v_add_f32 v132, v132, v180
    v_add_f32 v133, v133, v181
    v_mfma_f32_16x16x32_bf16 v[156:159], a[252:255], v[208:211], v[156:159]
    s_waitcnt vmcnt(11)
    v_add_f32 v134, v134, v182
    v_add_f32 v135, v135, v183
    v_mfma_f32_16x16x32_bf16 v[144:147], a[208:211], v[216:219], v[144:147]
    s_waitcnt vmcnt(10)
    s_xor_b32 s55, s83, 55296
    v_add_f32 v136, v136, v184
    v_add_f32 v137, v137, v185
    v_mfma_f32_16x16x32_bf16 v[144:147], a[224:227], v[220:223], v[144:147]
    buffer_load_dwordx4 a[56:59], v13, s[16:19], s55 offen sc1
    v_add_f32 v138, v138, v186
    v_add_f32 v139, v139, v187
    v_mfma_f32_16x16x32_bf16 v[148:151], a[228:231], v[220:223], v[148:151]
    v_add_f32 v140, v140, v188
    v_add_f32 v141, v141, v189
    v_mfma_f32_16x16x32_bf16 v[148:151], a[212:215], v[216:219], v[148:151]
    v_add_f32 v142, v142, v190
    v_add_f32 v143, v143, v191
    v_mfma_f32_16x16x32_bf16 v[152:155], a[216:219], v[216:219], v[152:155]
    s_xor_b32 s55, s83, 56320
    v_cvt_pk_bf16_f32 v128, v128, v129
    v_cvt_pk_bf16_f32 v129, v130, v131
    v_mfma_f32_16x16x32_bf16 v[152:155], a[232:235], v[220:223], v[152:155]
    buffer_load_dwordx4 a[60:63], v13, s[16:19], s55 offen sc1
    v_cvt_pk_bf16_f32 v130, v132, v133
    v_cvt_pk_bf16_f32 v131, v134, v135
    v_mfma_f32_16x16x32_bf16 v[156:159], a[236:239], v[220:223], v[156:159]
    v_cvt_pk_bf16_f32 v132, v136, v137
    v_cvt_pk_bf16_f32 v133, v138, v139
    v_mfma_f32_16x16x32_bf16 v[156:159], a[220:223], v[216:219], v[156:159]
    s_waitcnt vmcnt(11)
    v_cvt_pk_bf16_f32 v134, v140, v141
    v_cvt_pk_bf16_f32 v135, v142, v143
    v_mfma_f32_16x16x32_bf16 v[144:147], a[128:131], v[224:227], v[144:147]
    s_waitcnt vmcnt(10)
    s_xor_b32 s55, s83, 8192
    buffer_store_dwordx4 v[128:131], v13, s[12:15], s52 offen offset:0 sc1
    v_mfma_f32_16x16x32_bf16 v[144:147], a[64:67], v[228:231], v[144:147]
    buffer_load_dwordx4 v[192:195], v13, s[16:19], s55 offen sc1
    v_mfma_f32_16x16x32_bf16 v[148:151], a[68:71], v[228:231], v[148:151]
    buffer_store_dwordx4 v[132:135], v13, s[12:15], s52 offen offset:1024 sc1
    v_mfma_f32_16x16x32_bf16 v[148:151], a[132:135], v[224:227], v[148:151]
    v_add_f32_e64 v79, v79, v111
    v_mfma_f32_16x16x32_bf16 v[152:155], a[160:163], v[224:227], v[152:155]
    s_xor_b32 s55, s83, 9216
    v_mul_f32 v96, 0xbfb8aa3b, v64
    v_mfma_f32_16x16x32_bf16 v[152:155], a[72:75], v[228:231], v[152:155]
    buffer_load_dwordx4 v[196:199], v13, s[16:19], s55 offen sc1
    v_mfma_f32_16x16x32_bf16 v[156:159], a[76:79], v[228:231], v[156:159]
    v_mul_f32 v97, 0xbfb8aa3b, v65
    v_mfma_f32_16x16x32_bf16 v[156:159], a[164:167], v[224:227], v[156:159]
    s_waitcnt vmcnt(13)
    v_mul_f32 v98, 0xbfb8aa3b, v66
    v_mfma_f32_16x16x32_bf16 v[144:147], a[80:83], v[232:235], v[144:147]
    s_waitcnt vmcnt(12)
    s_xor_b32 s55, s83, 10240
    v_mul_f32 v99, 0xbfb8aa3b, v67
    v_mfma_f32_16x16x32_bf16 v[144:147], a[96:99], v[236:239], v[144:147]
    buffer_load_dwordx4 v[200:203], v13, s[16:19], s55 offen sc1
    v_mfma_f32_16x16x32_bf16 v[148:151], a[100:103], v[236:239], v[148:151]
    v_mul_f32 v100, 0xbfb8aa3b, v68
    v_mfma_f32_16x16x32_bf16 v[148:151], a[84:87], v[232:235], v[148:151]
    v_mul_f32 v101, 0xbfb8aa3b, v69
    v_mfma_f32_16x16x32_bf16 v[152:155], a[88:91], v[232:235], v[152:155]
    s_xor_b32 s55, s83, 11264
    v_mul_f32 v102, 0xbfb8aa3b, v70
    v_mfma_f32_16x16x32_bf16 v[152:155], a[104:107], v[236:239], v[152:155]
    buffer_load_dwordx4 v[204:207], v13, s[16:19], s55 offen sc1
    v_mfma_f32_16x16x32_bf16 v[156:159], a[108:111], v[236:239], v[156:159]
    v_mul_f32 v103, 0xbfb8aa3b, v71
    v_mfma_f32_16x16x32_bf16 v[156:159], a[92:95], v[232:235], v[156:159]
    s_waitcnt vmcnt(13)
    v_mul_f32 v104, 0xbfb8aa3b, v72
    v_mfma_f32_16x16x32_bf16 v[144:147], a[112:115], v[240:243], v[144:147]
    s_waitcnt vmcnt(12)
    s_xor_b32 s55, s83, 24576
    v_mul_f32 v105, 0xbfb8aa3b, v73
    v_mfma_f32_16x16x32_bf16 v[144:147], a[136:139], v[244:247], v[144:147]
    buffer_load_dwordx4 v[208:211], v13, s[16:19], s55 offen sc1
    v_mfma_f32_16x16x32_bf16 v[148:151], a[140:143], v[244:247], v[148:151]
    v_mul_f32 v106, 0xbfb8aa3b, v74
    v_mfma_f32_16x16x32_bf16 v[148:151], a[116:119], v[240:243], v[148:151]
    v_mul_f32 v107, 0xbfb8aa3b, v75
    v_mfma_f32_16x16x32_bf16 v[152:155], a[120:123], v[240:243], v[152:155]
    s_xor_b32 s55, s83, 25600
    v_mul_f32 v108, 0xbfb8aa3b, v76
    v_mfma_f32_16x16x32_bf16 v[152:155], a[144:147], v[244:247], v[152:155]
    buffer_load_dwordx4 v[212:215], v13, s[16:19], s55 offen sc1
    v_mfma_f32_16x16x32_bf16 v[156:159], a[148:151], v[244:247], v[156:159]
    v_mul_f32 v109, 0xbfb8aa3b, v77
    v_mfma_f32_16x16x32_bf16 v[156:159], a[124:127], v[240:243], v[156:159]
    s_waitcnt vmcnt(13)
    v_mul_f32 v110, 0xbfb8aa3b, v78
    v_mfma_f32_16x16x32_bf16 v[144:147], a[152:155], v[248:251], v[144:147]
    s_waitcnt vmcnt(12)
    s_xor_b32 s55, s83, 26624
    v_mul_f32 v111, 0xbfb8aa3b, v79
    v_mfma_f32_16x16x32_bf16 v[144:147], a[176:179], v[252:255], v[144:147]
    buffer_load_dwordx4 v[216:219], v13, s[16:19], s55 offen sc1
    v_mfma_f32_16x16x32_bf16 v[148:151], a[180:183], v[252:255], v[148:151]
    v_exp_f32 v96, v96
    v_mfma_f32_16x16x32_bf16 v[148:151], a[156:159], v[248:251], v[148:151]
    v_exp_f32 v97, v97
    v_mfma_f32_16x16x32_bf16 v[152:155], a[168:171], v[248:251], v[152:155]
    s_xor_b32 s55, s83, 27648
    v_exp_f32_e64 v98, v98
    v_mfma_f32_16x16x32_bf16 v[152:155], a[184:187], v[252:255], v[152:155]
    buffer_load_dwordx4 v[220:223], v13, s[16:19], s55 offen sc1
    v_mfma_f32_16x16x32_bf16 v[156:159], a[188:191], v[252:255], v[156:159]
    v_exp_f32 v99, v99
    v_mfma_f32_16x16x32_bf16 v[156:159], a[172:175], v[248:251], v[156:159]
    s_waitcnt vmcnt(13)
    v_exp_f32 v100, v100
    v_mfma_f32_16x16x32_bf16 v[144:147], a[192:195], a[48:51], v[144:147]
    s_waitcnt vmcnt(12)
    s_xor_b32 s55, s83, 40960
    v_exp_f32_e64 v101, v101
    v_mfma_f32_16x16x32_bf16 v[144:147], a[0:3], a[52:55], v[144:147]
    buffer_load_dwordx4 v[224:227], v13, s[16:19], s55 offen sc1
    v_mfma_f32_16x16x32_bf16 v[148:151], a[4:7], a[52:55], v[148:151]
    v_exp_f32 v102, v102
    v_mfma_f32_16x16x32_bf16 v[148:151], a[196:199], a[48:51], v[148:151]
    v_exp_f32 v103, v103
    v_mfma_f32_16x16x32_bf16 v[152:155], a[200:203], a[48:51], v[152:155]
    s_xor_b32 s55, s83, 41984
    v_exp_f32_e64 v104, v104
    v_mfma_f32_16x16x32_bf16 v[152:155], a[8:11], a[52:55], v[152:155]
    buffer_load_dwordx4 v[228:231], v13, s[16:19], s55 offen sc1
    v_mfma_f32_16x16x32_bf16 v[156:159], a[12:15], a[52:55], v[156:159]
    v_exp_f32 v105, v105
    v_mfma_f32_16x16x32_bf16 v[156:159], a[204:207], a[48:51], v[156:159]
    s_waitcnt vmcnt(13)
    v_exp_f32 v106, v106
    v_mfma_f32_16x16x32_bf16 v[144:147], a[16:19], a[56:59], v[144:147]
    s_waitcnt vmcnt(12)
    s_xor_b32 s55, s83, 43008
    v_exp_f32_e64 v107, v107
    v_mfma_f32_16x16x32_bf16 v[144:147], a[32:35], a[60:63], v[144:147]
    buffer_load_dwordx4 v[232:235], v13, s[16:19], s55 offen sc1
    v_mfma_f32_16x16x32_bf16 v[148:151], a[36:39], a[60:63], v[148:151]
    v_exp_f32 v108, v108
    v_mfma_f32_16x16x32_bf16 v[148:151], a[20:23], a[56:59], v[148:151]
    v_exp_f32 v109, v109
    v_mfma_f32_16x16x32_bf16 v[152:155], a[24:27], a[56:59], v[152:155]
    s_xor_b32 s55, s83, 44032
    v_exp_f32_e64 v110, v110
    v_mfma_f32_16x16x32_bf16 v[152:155], a[40:43], a[60:63], v[152:155]
    buffer_load_dwordx4 v[236:239], v13, s[16:19], s55 offen sc1
    v_mfma_f32_16x16x32_bf16 v[156:159], a[44:47], a[60:63], v[156:159]
    v_exp_f32 v111, v111
    v_mfma_f32_16x16x32_bf16 v[156:159], a[28:31], a[56:59], v[156:159]
    s_waitcnt vmcnt(12)
    v_add_f32 v96, 1.0, v96
    v_mfma_f32_16x16x32_bf16 v[160:163], a[240:243], v[192:195], 0
    s_waitcnt vmcnt(10)
    s_xor_b32 s55, s83, 57344
    v_add_f32_e64 v97, 1.0, v97
    v_mfma_f32_16x16x32_bf16 v[160:163], v[112:115], v[196:199], v[160:163]
    s_waitcnt lgkmcnt(0)
    s_barrier
    buffer_load_dwordx4 v[240:243], v13, s[16:19], s55 offen sc1
    v_mfma_f32_16x16x32_bf16 v[164:167], v[116:119], v[196:199], 0
    buffer_store_dword v41, v87, s[12:15], s56 offen sc1
    v_mfma_f32_16x16x32_bf16 v[164:167], a[244:247], v[192:195], v[164:167]
    v_add_f32_e64 v98, 1.0, v98
    v_mfma_f32_16x16x32_bf16 v[168:171], a[248:251], v[192:195], 0
    s_xor_b32 s55, s83, 58368
    ds_write_b128 v32, v[144:147] offset:0
    v_add_f32_e64 v99, 1.0, v99
    v_mfma_f32_16x16x32_bf16 v[168:171], v[120:123], v[196:199], v[168:171]
    buffer_load_dwordx4 v[244:247], v13, s[16:19], s55 offen sc1
    v_mfma_f32_16x16x32_bf16 v[172:175], v[124:127], v[196:199], 0
    ds_write_b128 v32, v[148:151] offset:1024
    v_add_f32 v100, 1.0, v100
    v_mfma_f32_16x16x32_bf16 v[172:175], a[252:255], v[192:195], v[172:175]
    s_waitcnt vmcnt(12)
    v_add_f32 v101, 1.0, v101
    v_mfma_f32_16x16x32_bf16 v[160:163], a[208:211], v[200:203], v[160:163]
    s_waitcnt vmcnt(11)
    s_xor_b32 s55, s83, 59392
    ds_write_b128 v32, v[152:155] offset:2048
    v_add_f32_e64 v102, 1.0, v102
    v_mfma_f32_16x16x32_bf16 v[160:163], a[224:227], v[204:207], v[160:163]
    buffer_load_dwordx4 v[248:251], v13, s[16:19], s55 offen sc1
    v_mfma_f32_16x16x32_bf16 v[164:167], a[228:231], v[204:207], v[164:167]
    ds_write_b128 v32, v[156:159] offset:3072
    v_add_f32 v103, 1.0, v103
    v_mfma_f32_16x16x32_bf16 v[164:167], a[212:215], v[200:203], v[164:167]
    v_add_f32 v104, 1.0, v104
    v_mfma_f32_16x16x32_bf16 v[168:171], a[216:219], v[200:203], v[168:171]
    s_xor_b32 s55, s83, 60416
    v_add_f32_e64 v105, 1.0, v105
    v_mfma_f32_16x16x32_bf16 v[168:171], a[232:235], v[204:207], v[168:171]
    buffer_load_dwordx4 v[252:255], v13, s[16:19], s55 offen sc1
    v_mfma_f32_16x16x32_bf16 v[172:175], a[236:239], v[204:207], v[172:175]
    v_add_f32 v106, 1.0, v106
    v_mfma_f32_16x16x32_bf16 v[172:175], a[220:223], v[200:203], v[172:175]
    s_waitcnt vmcnt(12)
    v_add_f32 v107, 1.0, v107
    v_mfma_f32_16x16x32_bf16 v[160:163], a[128:131], v[208:211], v[160:163]
    s_waitcnt vmcnt(11)
    s_xor_b32 s55, s83, 12288
    v_add_f32_e64 v108, 1.0, v108
    v_mfma_f32_16x16x32_bf16 v[160:163], a[64:67], v[212:215], v[160:163]
    buffer_load_dwordx4 a[48:51], v13, s[16:19], s55 offen sc1
    v_mfma_f32_16x16x32_bf16 v[164:167], a[68:71], v[212:215], v[164:167]
    v_add_f32 v109, 1.0, v109
    v_mfma_f32_16x16x32_bf16 v[164:167], a[132:135], v[208:211], v[164:167]
    v_add_f32 v110, 1.0, v110
    v_mfma_f32_16x16x32_bf16 v[168:171], a[160:163], v[208:211], v[168:171]
    s_xor_b32 s55, s83, 13312
    v_add_f32_e64 v111, 1.0, v111
    v_mfma_f32_16x16x32_bf16 v[168:171], a[72:75], v[212:215], v[168:171]
    buffer_load_dwordx4 a[52:55], v13, s[16:19], s55 offen sc1
    v_mfma_f32_16x16x32_bf16 v[172:175], a[76:79], v[212:215], v[172:175]
    v_rcp_f32 v96, v96
    v_mfma_f32_16x16x32_bf16 v[172:175], a[164:167], v[208:211], v[172:175]
    s_waitcnt vmcnt(12)
    v_rcp_f32 v97, v97
    v_mfma_f32_16x16x32_bf16 v[160:163], a[80:83], v[216:219], v[160:163]
    s_waitcnt vmcnt(11)
    s_xor_b32 s55, s83, 14336
    v_rcp_f32_e64 v98, v98
    v_mfma_f32_16x16x32_bf16 v[160:163], a[96:99], v[220:223], v[160:163]
    buffer_load_dwordx4 a[56:59], v13, s[16:19], s55 offen sc1
    v_mfma_f32_16x16x32_bf16 v[164:167], a[100:103], v[220:223], v[164:167]
    v_rcp_f32 v99, v99
    v_mfma_f32_16x16x32_bf16 v[164:167], a[84:87], v[216:219], v[164:167]
    v_rcp_f32 v100, v100
    v_mfma_f32_16x16x32_bf16 v[168:171], a[88:91], v[216:219], v[168:171]
    s_xor_b32 s55, s83, 15360
    v_rcp_f32_e64 v101, v101
    v_mfma_f32_16x16x32_bf16 v[168:171], a[104:107], v[220:223], v[168:171]
    buffer_load_dwordx4 a[60:63], v13, s[16:19], s55 offen sc1
    v_mfma_f32_16x16x32_bf16 v[172:175], a[108:111], v[220:223], v[172:175]
    v_rcp_f32 v102, v102
    v_mfma_f32_16x16x32_bf16 v[172:175], a[92:95], v[216:219], v[172:175]
    s_waitcnt vmcnt(12)
    v_rcp_f32 v103, v103
    v_mfma_f32_16x16x32_bf16 v[160:163], a[112:115], v[224:227], v[160:163]
    s_waitcnt vmcnt(11)
    s_xor_b32 s55, s83, 28672
    v_rcp_f32_e64 v104, v104
    v_mfma_f32_16x16x32_bf16 v[160:163], a[136:139], v[228:231], v[160:163]
    buffer_load_dwordx4 v[192:195], v13, s[16:19], s55 offen sc1
    v_mfma_f32_16x16x32_bf16 v[164:167], a[140:143], v[228:231], v[164:167]
    v_rcp_f32 v105, v105
    v_mfma_f32_16x16x32_bf16 v[164:167], a[116:119], v[224:227], v[164:167]
    v_rcp_f32 v106, v106
    v_mfma_f32_16x16x32_bf16 v[168:171], a[120:123], v[224:227], v[168:171]
    s_xor_b32 s55, s83, 29696
    v_rcp_f32_e64 v107, v107
    v_mfma_f32_16x16x32_bf16 v[168:171], a[144:147], v[228:231], v[168:171]
    buffer_load_dwordx4 v[196:199], v13, s[16:19], s55 offen sc1
    v_mfma_f32_16x16x32_bf16 v[172:175], a[148:151], v[228:231], v[172:175]
    v_rcp_f32 v108, v108
    v_mfma_f32_16x16x32_bf16 v[172:175], a[124:127], v[224:227], v[172:175]
    s_waitcnt vmcnt(12)
    v_rcp_f32 v109, v109
    v_mfma_f32_16x16x32_bf16 v[160:163], a[152:155], v[232:235], v[160:163]
    s_waitcnt vmcnt(11)
    s_xor_b32 s55, s83, 30720
    v_rcp_f32_e64 v110, v110
    v_mfma_f32_16x16x32_bf16 v[160:163], a[176:179], v[236:239], v[160:163]
    buffer_load_dwordx4 v[200:203], v13, s[16:19], s55 offen sc1
    v_mfma_f32_16x16x32_bf16 v[164:167], a[180:183], v[236:239], v[164:167]
    v_rcp_f32 v111, v111
    v_mfma_f32_16x16x32_bf16 v[164:167], a[156:159], v[232:235], v[164:167]
    v_mul_f32 v64, v64, v96
    v_mfma_f32_16x16x32_bf16 v[168:171], a[168:171], v[232:235], v[168:171]
    s_xor_b32 s55, s83, 31744
    v_mul_f32_e64 v65, v65, v97
    v_mfma_f32_16x16x32_bf16 v[168:171], a[184:187], v[236:239], v[168:171]
    buffer_load_dwordx4 v[204:207], v13, s[16:19], s55 offen sc1
    v_mfma_f32_16x16x32_bf16 v[172:175], a[188:191], v[236:239], v[172:175]
    v_mul_f32 v66, v66, v98
    v_mfma_f32_16x16x32_bf16 v[172:175], a[172:175], v[232:235], v[172:175]
    s_waitcnt vmcnt(12)
    v_mul_f32 v67, v67, v99
    v_mfma_f32_16x16x32_bf16 v[160:163], a[192:195], v[240:243], v[160:163]
    s_waitcnt vmcnt(10)
    s_xor_b32 s55, s83, 45056
    v_mul_f32_e64 v68, v68, v100
    v_mfma_f32_16x16x32_bf16 v[160:163], a[0:3], v[244:247], v[160:163]
    buffer_load_dwordx4 v[208:211], v13, s[16:19], s55 offen sc1
    v_mfma_f32_16x16x32_bf16 v[164:167], a[4:7], v[244:247], v[164:167]
    v_mul_f32 v69, v69, v101
    v_mfma_f32_16x16x32_bf16 v[164:167], a[196:199], v[240:243], v[164:167]
    v_mul_f32 v70, v70, v102
    v_mfma_f32_16x16x32_bf16 v[168:171], a[200:203], v[240:243], v[168:171]
    s_xor_b32 s55, s83, 46080
    v_mul_f32_e64 v71, v71, v103
    v_mfma_f32_16x16x32_bf16 v[168:171], a[8:11], v[244:247], v[168:171]
    buffer_load_dwordx4 v[212:215], v13, s[16:19], s55 offen sc1
    v_mfma_f32_16x16x32_bf16 v[172:175], a[12:15], v[244:247], v[172:175]
    v_mul_f32 v72, v72, v104
    v_mfma_f32_16x16x32_bf16 v[172:175], a[204:207], v[240:243], v[172:175]
    s_waitcnt vmcnt(11)
    v_mul_f32 v73, v73, v105
    v_mfma_f32_16x16x32_bf16 v[160:163], a[16:19], v[248:251], v[160:163]
    s_waitcnt vmcnt(10)
    s_xor_b32 s55, s83, 47104
    v_mul_f32_e64 v74, v74, v106
    v_mfma_f32_16x16x32_bf16 v[160:163], a[32:35], v[252:255], v[160:163]
    buffer_load_dwordx4 v[216:219], v13, s[16:19], s55 offen sc1
    v_mfma_f32_16x16x32_bf16 v[164:167], a[36:39], v[252:255], v[164:167]
    v_mul_f32 v75, v75, v107
    v_mfma_f32_16x16x32_bf16 v[164:167], a[20:23], v[248:251], v[164:167]
    v_mul_f32 v76, v76, v108
    v_mfma_f32_16x16x32_bf16 v[168:171], a[24:27], v[248:251], v[168:171]
    s_xor_b32 s55, s83, 48128
    v_mul_f32_e64 v77, v77, v109
    v_mfma_f32_16x16x32_bf16 v[168:171], a[40:43], v[252:255], v[168:171]
    buffer_load_dwordx4 v[220:223], v13, s[16:19], s55 offen sc1
    v_mfma_f32_16x16x32_bf16 v[172:175], a[44:47], v[252:255], v[172:175]
    v_mul_f32 v78, v78, v110
    v_mfma_f32_16x16x32_bf16 v[172:175], a[28:31], v[248:251], v[172:175]
    s_waitcnt vmcnt(11)
    v_mul_f32 v79, v79, v111
    v_mfma_f32_16x16x32_bf16 v[176:179], a[240:243], a[48:51], 0
    s_waitcnt vmcnt(10)
    s_xor_b32 s55, s83, 61440
    buffer_load_dword v1, off, s[12:15], s59 sc1
    v_mfma_f32_16x16x32_bf16 v[176:179], v[112:115], a[52:55], v[176:179]
    buffer_load_dwordx4 v[224:227], v13, s[16:19], s55 offen sc1
    v_mfma_f32_16x16x32_bf16 v[180:183], v[116:119], a[52:55], 0
    v_mfma_f32_16x16x32_bf16 v[180:183], a[244:247], a[48:51], v[180:183]
    v_mfma_f32_16x16x32_bf16 v[184:187], a[248:251], a[48:51], 0
    s_xor_b32 s55, s83, 62464
    ds_write_b128 v33, v[160:163] offset:0
    v_mfma_f32_16x16x32_bf16 v[184:187], v[120:123], a[52:55], v[184:187]
    buffer_load_dwordx4 v[228:231], v13, s[16:19], s55 offen sc1
    v_mfma_f32_16x16x32_bf16 v[188:191], v[124:127], a[52:55], 0
    ds_write_b128 v33, v[164:167] offset:1024
    v_mfma_f32_16x16x32_bf16 v[188:191], a[252:255], a[48:51], v[188:191]
    s_waitcnt vmcnt(12)
    v_mfma_f32_16x16x32_bf16 v[176:179], a[208:211], a[56:59], v[176:179]
    s_waitcnt vmcnt(11)
    s_xor_b32 s55, s83, 63488
    ds_write_b128 v33, v[168:171] offset:2048
    v_mfma_f32_16x16x32_bf16 v[176:179], a[224:227], a[60:63], v[176:179]
    buffer_load_dwordx4 v[232:235], v13, s[16:19], s55 offen sc1
    v_mfma_f32_16x16x32_bf16 v[180:183], a[228:231], a[60:63], v[180:183]
    ds_write_b128 v33, v[172:175] offset:3072
    v_mfma_f32_16x16x32_bf16 v[180:183], a[212:215], a[56:59], v[180:183]
    v_mfma_f32_16x16x32_bf16 v[184:187], a[216:219], a[56:59], v[184:187]
    s_xor_b32 s55, s83, 64512
    v_mfma_f32_16x16x32_bf16 v[184:187], a[232:235], a[60:63], v[184:187]
    buffer_load_dwordx4 v[236:239], v13, s[16:19], s55 offen sc1
    v_mfma_f32_16x16x32_bf16 v[188:191], a[236:239], a[60:63], v[188:191]
    v_mfma_f32_16x16x32_bf16 v[188:191], a[220:223], a[56:59], v[188:191]
    s_waitcnt vmcnt(12)
    v_mfma_f32_16x16x32_bf16 v[176:179], a[128:131], v[192:195], v[176:179]
    s_waitcnt vmcnt(11)
    s_xor_b32 s55, s83, 0
    v_mfma_f32_16x16x32_bf16 v[176:179], a[64:67], v[196:199], v[176:179]
    buffer_load_dwordx4 v[240:243], v13, s[16:19], s55 offen sc1
    v_mfma_f32_16x16x32_bf16 v[180:183], a[68:71], v[196:199], v[180:183]
    v_mfma_f32_16x16x32_bf16 v[180:183], a[132:135], v[192:195], v[180:183]
    v_mfma_f32_16x16x32_bf16 v[184:187], a[160:163], v[192:195], v[184:187]
    s_xor_b32 s55, s83, 1024
    v_mfma_f32_16x16x32_bf16 v[184:187], a[72:75], v[196:199], v[184:187]
    buffer_load_dwordx4 v[244:247], v13, s[16:19], s55 offen sc1
    v_mfma_f32_16x16x32_bf16 v[188:191], a[76:79], v[196:199], v[188:191]
    v_mfma_f32_16x16x32_bf16 v[188:191], a[164:167], v[192:195], v[188:191]
    s_waitcnt vmcnt(12)
    v_mfma_f32_16x16x32_bf16 v[176:179], a[80:83], v[200:203], v[176:179]
    s_waitcnt vmcnt(11)
    s_xor_b32 s55, s83, 2048
    v_mfma_f32_16x16x32_bf16 v[176:179], a[96:99], v[204:207], v[176:179]
    buffer_load_dwordx4 v[248:251], v13, s[16:19], s55 offen sc1
    v_mfma_f32_16x16x32_bf16 v[180:183], a[100:103], v[204:207], v[180:183]
    v_mfma_f32_16x16x32_bf16 v[180:183], a[84:87], v[200:203], v[180:183]
    v_mfma_f32_16x16x32_bf16 v[184:187], a[88:91], v[200:203], v[184:187]
    s_xor_b32 s55, s83, 3072
    v_mfma_f32_16x16x32_bf16 v[184:187], a[104:107], v[204:207], v[184:187]
    buffer_load_dwordx4 v[252:255], v13, s[16:19], s55 offen sc1
    v_mfma_f32_16x16x32_bf16 v[188:191], a[108:111], v[204:207], v[188:191]
    v_mfma_f32_16x16x32_bf16 v[188:191], a[92:95], v[200:203], v[188:191]
    s_waitcnt vmcnt(12)
    v_mfma_f32_16x16x32_bf16 v[176:179], a[112:115], v[208:211], v[176:179]
    s_waitcnt vmcnt(11)
    s_xor_b32 s55, s83, 16384
    v_mfma_f32_16x16x32_bf16 v[176:179], a[136:139], v[212:215], v[176:179]
    buffer_load_dwordx4 a[48:51], v13, s[16:19], s55 offen sc1
    v_mfma_f32_16x16x32_bf16 v[180:183], a[140:143], v[212:215], v[180:183]
    v_mfma_f32_16x16x32_bf16 v[180:183], a[116:119], v[208:211], v[180:183]
    v_mfma_f32_16x16x32_bf16 v[184:187], a[120:123], v[208:211], v[184:187]
    s_xor_b32 s55, s83, 17408
    v_mfma_f32_16x16x32_bf16 v[184:187], a[144:147], v[212:215], v[184:187]
    buffer_load_dwordx4 a[52:55], v13, s[16:19], s55 offen sc1
    v_mfma_f32_16x16x32_bf16 v[188:191], a[148:151], v[212:215], v[188:191]
    v_mfma_f32_16x16x32_bf16 v[188:191], a[124:127], v[208:211], v[188:191]
    s_waitcnt vmcnt(12)
    v_mfma_f32_16x16x32_bf16 v[176:179], a[152:155], v[216:219], v[176:179]
    s_waitcnt vmcnt(11)
    s_xor_b32 s55, s83, 18432
    v_mfma_f32_16x16x32_bf16 v[176:179], a[176:179], v[220:223], v[176:179]
    buffer_load_dwordx4 a[56:59], v13, s[16:19], s55 offen sc1
    v_mfma_f32_16x16x32_bf16 v[180:183], a[180:183], v[220:223], v[180:183]
    v_mfma_f32_16x16x32_bf16 v[180:183], a[156:159], v[216:219], v[180:183]
    v_mfma_f32_16x16x32_bf16 v[184:187], a[168:171], v[216:219], v[184:187]
    s_xor_b32 s55, s83, 19456
    v_mfma_f32_16x16x32_bf16 v[184:187], a[184:187], v[220:223], v[184:187]
    buffer_load_dwordx4 a[60:63], v13, s[16:19], s55 offen sc1
    v_mfma_f32_16x16x32_bf16 v[188:191], a[188:191], v[220:223], v[188:191]
    v_mfma_f32_16x16x32_bf16 v[188:191], a[172:175], v[216:219], v[188:191]
    s_waitcnt vmcnt(11)
    v_mfma_f32_16x16x32_bf16 v[176:179], a[192:195], v[224:227], v[176:179]
    s_waitcnt vmcnt(10)
    s_xor_b32 s55, s83, 32768
    v_mfma_f32_16x16x32_bf16 v[176:179], a[0:3], v[228:231], v[176:179]
    buffer_load_dwordx4 v[192:195], v13, s[16:19], s55 offen sc1
    v_mfma_f32_16x16x32_bf16 v[180:183], a[4:7], v[228:231], v[180:183]
    v_mfma_f32_16x16x32_bf16 v[180:183], a[196:199], v[224:227], v[180:183]
L_hoq2:
    s_cbranch_execz L_hoq_back
    v_mfma_f32_16x16x32_bf16 v[184:187], a[200:203], v[224:227], v[184:187]
    s_xor_b32 s55, s83, 33792
    v_cmp_eq_u32 vcc, 1, v1
    s_nop 0
    s_cmp_eq_u64 vcc, -1
    s_cbranch_scc0 L_spin_f2
L_ok_f2:
    v_mfma_f32_16x16x32_bf16 v[184:187], a[8:11], v[228:231], v[184:187]
    buffer_load_dwordx4 v[196:199], v13, s[16:19], s55 offen sc1
    v_mfma_f32_16x16x32_bf16 v[188:191], a[12:15], v[228:231], v[188:191]
    buffer_load_dwordx4 v[104:107], v13, s[12:15], s53 offen offset:0 sc1
    v_mfma_f32_16x16x32_bf16 v[188:191], a[204:207], v[224:227], v[188:191]
    s_waitcnt vmcnt(12)
    buffer_load_dwordx4 v[108:111], v13, s[12:15], s53 offen offset:1024 sc1
    v_mfma_f32_16x16x32_bf16 v[176:179], a[16:19], v[232:235], v[176:179]
    s_waitcnt vmcnt(12)
    s_xor_b32 s55, s83, 34816
    v_mfma_f32_16x16x32_bf16 v[176:179], a[32:35], v[236:239], v[176:179]
    buffer_load_dwordx4 v[200:203], v13, s[16:19], s55 offen sc1
    v_mfma_f32_16x16x32_bf16 v[180:183], a[36:39], v[236:239], v[180:183]
    v_mfma_f32_16x16x32_bf16 v[180:183], a[20:23], v[232:235], v[180:183]
    v_mfma_f32_16x16x32_bf16 v[184:187], a[24:27], v[232:235], v[184:187]
    s_xor_b32 s55, s83, 35840
    v_mfma_f32_16x16x32_bf16 v[184:187], a[40:43], v[236:239], v[184:187]
    buffer_load_dwordx4 v[204:207], v13, s[16:19], s55 offen sc1
    v_mfma_f32_16x16x32_bf16 v[188:191], a[44:47], v[236:239], v[188:191]
    v_mfma_f32_16x16x32_bf16 v[188:191], a[28:31], v[232:235], v[188:191]
    s_waitcnt vmcnt(13)
    v_mfma_f32_16x16x32_bf16 v[128:131], a[240:243], v[240:243], 0
    s_waitcnt vmcnt(12)
    s_xor_b32 s55, s83, 49152
    v_mfma_f32_16x16x32_bf16 v[128:131], v[112:115], v[244:247], v[128:131]
    buffer_load_dwordx4 v[208:211], v13, s[16:19], s55 offen sc1
    v_mfma_f32_16x16x32_bf16 v[132:135], v[116:119], v[244:247], 0
    v_mfma_f32_16x16x32_bf16 v[132:135], a[244:247], v[240:243], v[132:135]
    v_mfma_f32_16x16x32_bf16 v[136:139], a[248:251], v[240:243], 0
    s_xor_b32 s55, s83, 50176
    ds_write_b128 v34, v[176:179] offset:0
    v_mfma_f32_16x16x32_bf16 v[136:139], v[120:123], v[244:247], v[136:139]
    buffer_load_dwordx4 v[212:215], v13, s[16:19], s55 offen sc1
    v_mfma_f32_16x16x32_bf16 v[140:143], v[124:127], v[244:247], 0
    ds_write_b128 v34, v[180:183] offset:1024
    v_mfma_f32_16x16x32_bf16 v[140:143], a[252:255], v[240:243], v[140:143]
    s_waitcnt vmcnt(13)
    v_mfma_f32_16x16x32_bf16 v[128:131], a[208:211], v[248:251], v[128:131]
    s_waitcnt vmcnt(12)
    s_xor_b32 s55, s83, 51200
    ds_write_b128 v34, v[184:187] offset:2048
    v_mfma_f32_16x16x32_bf16 v[128:131], a[224:227], v[252:255], v[128:131]
    buffer_load_dwordx4 v[216:219], v13, s[16:19], s55 offen sc1
    v_mfma_f32_16x16x32_bf16 v[132:135], a[228:231], v[252:255], v[132:135]
    ds_write_b128 v34, v[188:191] offset:3072
    v_mfma_f32_16x16x32_bf16 v[132:135], a[212:215], v[248:251], v[132:135]
    v_mfma_f32_16x16x32_bf16 v[136:139], a[216:219], v[248:251], v[136:139]
    s_xor_b32 s55, s83, 52224
    v_mfma_f32_16x16x32_bf16 v[136:139], a[232:235], v[252:255], v[136:139]
    buffer_load_dwordx4 v[220:223], v13, s[16:19], s55 offen sc1
    v_mfma_f32_16x16x32_bf16 v[140:143], a[236:239], v[252:255], v[140:143]
    v_mfma_f32_16x16x32_bf16 v[140:143], a[220:223], v[248:251], v[140:143]
    s_waitcnt lgkmcnt(0)
    s_barrier
    ds_read_b128 v[144:147], v36 offset:0
    s_waitcnt vmcnt(13)
    v_mfma_f32_16x16x32_bf16 v[128:131], a[128:131], a[48:51], v[128:131]
    s_waitcnt vmcnt(12)
    ds_read_b128 v[160:163], v37 offset:0
    v_mfma_f32_16x16x32_bf16 v[128:131], a[64:67], a[52:55], v[128:131]
    ds_read_b128 v[176:179], v38 offset:0
    v_mfma_f32_16x16x32_bf16 v[132:135], a[68:71], a[52:55], v[132:135]
    ds_read_b128 v[148:151], v36 offset:1024
    v_mfma_f32_16x16x32_bf16 v[132:135], a[132:135], a[48:51], v[132:135]
    ds_read_b128 v[164:167], v37 offset:1024
    v_mfma_f32_16x16x32_bf16 v[136:139], a[160:163], a[48:51], v[136:139]
    ds_read_b128 v[180:183], v38 offset:1024
    v_mfma_f32_16x16x32_bf16 v[136:139], a[72:75], a[52:55], v[136:139]
    ds_read_b128 v[152:155], v36 offset:2048
    v_mfma_f32_16x16x32_bf16 v[140:143], a[76:79], a[52:55], v[140:143]
    ds_read_b128 v[168:171], v37 offset:2048
    v_mfma_f32_16x16x32_bf16 v[140:143], a[164:167], a[48:51], v[140:143]
    s_waitcnt lgkmcnt(5) vmcnt(11)
    ds_read_b128 v[184:187], v38 offset:2048
    v_add_f32 v176, v176, v144
    v_mfma_f32_16x16x32_bf16 v[128:131], a[80:83], a[56:59], v[128:131]
    s_waitcnt vmcnt(10)
    ds_read_b128 v[156:159], v36 offset:3072
    v_add_f32 v177, v177, v145
    v_mfma_f32_16x16x32_bf16 v[128:131], a[96:99], a[60:63], v[128:131]
    ds_read_b128 v[172:175], v37 offset:3072
    v_add_f32 v178, v178, v146
    v_mfma_f32_16x16x32_bf16 v[132:135], a[100:103], a[60:63], v[132:135]
    ds_read_b128 v[188:191], v38 offset:3072
    v_add_f32 v179, v179, v147
    v_mfma_f32_16x16x32_bf16 v[132:135], a[84:87], a[56:59], v[132:135]
    v_add_f32 v176, v176, v160
    v_mfma_f32_16x16x32_bf16 v[136:139], a[88:91], a[56:59], v[136:139]
    v_mfma_f32_16x16x32_bf16 v[136:139], a[104:107], a[60:63], v[136:139]
    v_add_f32 v177, v177, v161
    v_mfma_f32_16x16x32_bf16 v[140:143], a[108:111], a[60:63], v[140:143]
    v_add_f32 v178, v178, v162
    v_mfma_f32_16x16x32_bf16 v[140:143], a[92:95], a[56:59], v[140:143]
    s_waitcnt vmcnt(9)
    v_add_f32 v179, v179, v163
    v_mfma_f32_16x16x32_bf16 v[128:131], a[112:115], v[192:195], v[128:131]
    s_waitcnt lgkmcnt(1) vmcnt(8)
    v_add_f32 v180, v180, v148
    v_mfma_f32_16x16x32_bf16 v[128:131], a[136:139], v[196:199], v[128:131]
    v_add_f32 v181, v181, v149
    v_mfma_f32_16x16x32_bf16 v[132:135], a[140:143], v[196:199], v[132:135]
    v_mfma_f32_16x16x32_bf16 v[132:135], a[116:119], v[192:195], v[132:135]
    v_add_f32 v182, v182, v150
    v_mfma_f32_16x16x32_bf16 v[136:139], a[120:123], v[192:195], v[136:139]
    v_add_f32 v183, v183, v151
    v_mfma_f32_16x16x32_bf16 v[136:139], a[144:147], v[196:199], v[136:139]
    v_add_f32 v180, v180, v164
    v_mfma_f32_16x16x32_bf16 v[140:143], a[148:151], v[196:199], v[140:143]
    v_add_f32 v181, v181, v165
    v_mfma_f32_16x16x32_bf16 v[140:143], a[124:127], v[192:195], v[140:143]
    s_waitcnt vmcnt(5)
    v_mfma_f32_16x16x32_bf16 v[128:131], a[152:155], v[200:203], v[128:131]
    s_waitcnt vmcnt(4)
    v_add_f32 v182, v182, v166
    v_mfma_f32_16x16x32_bf16 v[128:131], a[176:179], v[204:207], v[128:131]
    v_add_f32 v183, v183, v167
    v_mfma_f32_16x16x32_bf16 v[132:135], a[180:183], v[204:207], v[132:135]
    v_add_f32 v184, v184, v152
    v_mfma_f32_16x16x32_bf16 v[132:135], a[156:159], v[200:203], v[132:135]
    v_add_f32 v185, v185, v153
    v_mfma_f32_16x16x32_bf16 v[136:139], a[168:171], v[200:203], v[136:139]
    v_add_f32 v186, v186, v154
    v_mfma_f32_16x16x32_bf16 v[136:139], a[184:187], v[204:207], v[136:139]
    v_mfma_f32_16x16x32_bf16 v[140:143], a[188:191], v[204:207], v[140:143]
    v_add_f32 v187, v187, v155
    v_mfma_f32_16x16x32_bf16 v[140:143], a[172:175], v[200:203], v[140:143]
    s_waitcnt vmcnt(3)
    v_add_f32 v184, v184, v168
    v_mfma_f32_16x16x32_bf16 v[128:131], a[192:195], v[208:211], v[128:131]
    s_waitcnt vmcnt(2)
    v_lshlrev_b32 v96, 16, v104
    v_add_f32 v185, v185, v169
    v_mfma_f32_16x16x32_bf16 v[128:131], a[0:3], v[212:215], v[128:131]
    v_and_b32 v97, 0xffff0000, v104
    v_add_f32 v186, v186, v170
    v_mfma_f32_16x16x32_bf16 v[132:135], a[4:7], v[212:215], v[132:135]
    v_lshlrev_b32 v98, 16, v105
    v_mfma_f32_16x16x32_bf16 v[132:135], a[196:199], v[208:211], v[132:135]
    v_and_b32 v99, 0xffff0000, v105
    v_add_f32 v187, v187, v171
    v_mfma_f32_16x16x32_bf16 v[136:139], a[200:203], v[208:211], v[136:139]
    s_waitcnt lgkmcnt(0)
    v_lshlrev_b32 v100, 16, v106
    v_add_f32 v188, v188, v156
    v_mfma_f32_16x16x32_bf16 v[136:139], a[8:11], v[212:215], v[136:139]
    v_and_b32 v101, 0xffff0000, v106
    v_add_f32 v189, v189, v157
    v_mfma_f32_16x16x32_bf16 v[140:143], a[12:15], v[212:215], v[140:143]
    v_lshlrev_b32 v102, 16, v107
    v_add_f32 v190, v190, v158
    v_mfma_f32_16x16x32_bf16 v[140:143], a[204:207], v[208:211], v[140:143]
    s_waitcnt vmcnt(1)
    v_and_b32 v103, 0xffff0000, v107
    v_add_f32 v191, v191, v159
    v_mfma_f32_16x16x32_bf16 v[128:131], a[16:19], v[216:219], v[128:131]
    s_waitcnt vmcnt(0)
    v_lshlrev_b32 v104, 16, v108
    v_mfma_f32_16x16x32_bf16 v[128:131], a[32:35], v[220:223], v[128:131]
    v_and_b32 v105, 0xffff0000, v108
    v_add_f32 v188, v188, v172
    v_mfma_f32_16x16x32_bf16 v[132:135], a[36:39], v[220:223], v[132:135]
    v_lshlrev_b32 v106, 16, v109
    v_add_f32 v189, v189, v173
    v_mfma_f32_16x16x32_bf16 v[132:135], a[20:23], v[216:219], v[132:135]
    v_and_b32 v107, 0xffff0000, v109
    v_add_f32 v190, v190, v174
    v_mfma_f32_16x16x32_bf16 v[136:139], a[24:27], v[216:219], v[136:139]
    v_lshlrev_b32 v108, 16, v110
    v_add_f32 v191, v191, v175
    v_mfma_f32_16x16x32_bf16 v[136:139], a[40:43], v[220:223], v[136:139]
    v_and_b32 v109, 0xffff0000, v110
    v_mfma_f32_16x16x32_bf16 v[140:143], a[44:47], v[220:223], v[140:143]
    v_lshlrev_b32_e64 v110, 16, v111
    v_mfma_f32_16x16x32_bf16 v[140:143], a[28:31], v[216:219], v[140:143]
    v_and_b32 v111, 0xffff0000, v111
    v_pk_add_f32 v[176:177], v[176:177], v[96:97]
    v_pk_add_f32 v[178:179], v[178:179], v[98:99]
    v_pk_add_f32 v[180:181], v[180:181], v[100:101]
    v_pk_add_f32 v[182:183], v[182:183], v[102:103]
    v_pk_add_f32 v[184:185], v[184:185], v[104:105]
    v_pk_add_f32 v[186:187], v[186:187], v[106:107]
    v_pk_add_f32 v[188:189], v[188:189], v[108:109]
    v_pk_add_f32 v[190:191], v[190:191], v[110:111]
    v_pk_add_f32 v[128:129], v[128:129], v[176:177]
    v_pk_add_f32 v[130:131], v[130:131], v[178:179]
    v_pk_add_f32 v[132:133], v[132:133], v[180:181]
    v_pk_add_f32 v[134:135], v[134:135], v[182:183]
    v_pk_fma_f32 v[128:129], v[128:129], v[64:65], v[48:49]
    v_pk_fma_f32 v[130:131], v[130:131], v[66:67], v[50:51]
    v_pk_fma_f32 v[132:133], v[132:133], v[68:69], v[52:53]
    v_pk_fma_f32 v[134:135], v[134:135], v[70:71], v[54:55]
    v_cvt_pk_bf16_f32 v16, v128, v129
    v_cvt_pk_bf16_f32 v17, v130, v131
    v_cvt_pk_bf16_f32 v18, v132, v133
    v_cvt_pk_bf16_f32 v19, v134, v135
    ds_write_b64 v30, v[16:17] offset:0
    ds_write_b64 v30, v[18:19] offset:32
    v_pk_add_f32 v[136:137], v[136:137], v[184:185]
    v_pk_add_f32 v[138:139], v[138:139], v[186:187]
    v_pk_add_f32 v[140:141], v[140:141], v[188:189]
    v_pk_add_f32 v[142:143], v[142:143], v[190:191]
    v_pk_fma_f32 v[136:137], v[136:137], v[72:73], v[56:57]
    v_pk_fma_f32 v[138:139], v[138:139], v[74:75], v[58:59]
    v_pk_fma_f32 v[140:141], v[140:141], v[76:77], v[60:61]
    v_pk_fma_f32 v[142:143], v[142:143], v[78:79], v[62:63]
    v_cvt_pk_bf16_f32 v20, v136, v137
    v_cvt_pk_bf16_f32 v21, v138, v139
    v_cvt_pk_bf16_f32 v22, v140, v141
    v_cvt_pk_bf16_f32 v23, v142, v143
    ds_write_b64 v30, v[20:21] offset:64
    ds_write_b64 v30, v[22:23] offset:96
    s_mov_b32 s52, 8192
    ds_read_b128 v[128:131], v31 offset:0
    ds_read_b128 v[132:135], v31 offset:1152
    s_waitcnt lgkmcnt(1)
    buffer_store_dwordx4 v[128:131], v7, s[72:75], 0 offen sc1
    s_waitcnt lgkmcnt(0)
    buffer_store_dwordx4 v[132:135], v7, s[72:75], s52 offen sc1
L_endA:
    s_endpgm
L_rc_a:
L_hoo2:
    s_cbranch_execz L_hoo_back
    s_mov_b32 s58, -120
    v_accvgpr_read_b32 v90, a200
    v_accvgpr_read_b32 v91, a204
    v_accvgpr_read_b32 v92, a201
    v_accvgpr_read_b32 v93, a205
    v_add_f32 v90, v90, v92
    v_add_f32 v91, v91, v93
    v_frexp_exp_i32_f32 v88, v90
    v_frexp_exp_i32_f32 v89, v91
    v_sub_u32 v88, -101, v88
    v_sub_u32 v89, -101, v89
    v_med3_i32 v88, v88, 0, s58
    v_med3_i32 v89, v89, 0, s58
    v_cvt_f32_i32 v92, v88
    v_cvt_f32_i32 v93, v89
    v_ldexp_f32 v90, v90, v88
    v_ldexp_f32 v91, v91, v89
    v_ldexp_f32 v88, 1.0, v88
    v_ldexp_f32 v89, 1.0, v89
    v_accvgpr_write_b32 a200, v90
    v_accvgpr_write_b32 a204, v91
    v_accvgpr_write_b32 a201, 0
    v_accvgpr_write_b32 a205, 0
    v_add_f32 v24, v24, v92
    v_add_f32 v28, v28, v93
    v_add_f32 v25, v25, v92
    v_add_f32 v29, v29, v93
    v_add_f32 v26, v26, v92
    v_add_f32 v30, v30, v93
    v_add_f32 v27, v27, v92
    v_add_f32 v31, v31, v93
    v_pk_mul_f32 v[136:137], v[136:137], v[88:89] op_sel_hi:[1,0]
    v_pk_mul_f32 v[138:139], v[138:139], v[88:89] op_sel_hi:[1,0]
    v_pk_mul_f32 v[152:153], v[152:153], v[88:89] op_sel_hi:[1,0]
    v_pk_mul_f32 v[154:155], v[154:155], v[88:89] op_sel_hi:[1,0]
    v_pk_mul_f32 v[168:169], v[168:169], v[88:89] op_sel_hi:[1,0]
    v_pk_mul_f32 v[170:171], v[170:171], v[88:89] op_sel_hi:[1,0]
    v_pk_mul_f32 v[184:185], v[184:185], v[88:89] op_sel_hi:[1,0]
    v_pk_mul_f32 v[186:187], v[186:187], v[88:89] op_sel_hi:[1,0]
    v_pk_mul_f32 v[200:201], v[200:201], v[88:89] op_sel_hi:[1,0]
    v_pk_mul_f32 v[202:203], v[202:203], v[88:89] op_sel_hi:[1,0]
    v_pk_mul_f32 v[216:217], v[216:217], v[88:89] op_sel_hi:[1,0]
    v_pk_mul_f32 v[218:219], v[218:219], v[88:89] op_sel_hi:[1,0]
    v_pk_mul_f32 v[232:233], v[232:233], v[88:89] op_sel_hi:[1,0]
    v_pk_mul_f32 v[234:235], v[234:235], v[88:89] op_sel_hi:[1,0]
    v_pk_mul_f32 v[248:249], v[248:249], v[88:89] op_sel_hi:[1,0]
    v_pk_mul_f32 v[250:251], v[250:251], v[88:89] op_sel_hi:[1,0]
    v_pk_mul_f32 v[140:141], v[140:141], v[88:89] op_sel:[0,1] op_sel_hi:[1,1]
    v_pk_mul_f32 v[142:143], v[142:143], v[88:89] op_sel:[0,1] op_sel_hi:[1,1]
    v_pk_mul_f32 v[156:157], v[156:157], v[88:89] op_sel:[0,1] op_sel_hi:[1,1]
    v_pk_mul_f32 v[158:159], v[158:159], v[88:89] op_sel:[0,1] op_sel_hi:[1,1]
    v_pk_mul_f32 v[172:173], v[172:173], v[88:89] op_sel:[0,1] op_sel_hi:[1,1]
    v_pk_mul_f32 v[174:175], v[174:175], v[88:89] op_sel:[0,1] op_sel_hi:[1,1]
    v_pk_mul_f32 v[188:189], v[188:189], v[88:89] op_sel:[0,1] op_sel_hi:[1,1]
    v_pk_mul_f32 v[190:191], v[190:191], v[88:89] op_sel:[0,1] op_sel_hi:[1,1]
    v_pk_mul_f32 v[204:205], v[204:205], v[88:89] op_sel:[0,1] op_sel_hi:[1,1]
    v_pk_mul_f32 v[206:207], v[206:207], v[88:89] op_sel:[0,1] op_sel_hi:[1,1]
    v_pk_mul_f32 v[220:221], v[220:221], v[88:89] op_sel:[0,1] op_sel_hi:[1,1]
    v_pk_mul_f32 v[222:223], v[222:223], v[88:89] op_sel:[0,1] op_sel_hi:[1,1]
    v_pk_mul_f32 v[236:237], v[236:237], v[88:89] op_sel:[0,1] op_sel_hi:[1,1]
    v_pk_mul_f32 v[238:239], v[238:239], v[88:89] op_sel:[0,1] op_sel_hi:[1,1]
    v_pk_mul_f32 v[252:253], v[252:253], v[88:89] op_sel:[0,1] op_sel_hi:[1,1]
    v_pk_mul_f32 v[254:255], v[254:255], v[88:89] op_sel:[0,1] op_sel_hi:[1,1]
    s_branch L_rc_a_back
L_rc_b:
L_hop7:
    s_cbranch_execz L_hop_back
    s_mov_b32 s58, -120
    v_accvgpr_read_b32 v90, a192
    v_accvgpr_read_b32 v91, a196
    v_accvgpr_read_b32 v92, a193
    v_accvgpr_read_b32 v93, a197
    v_add_f32 v90, v90, v92
    v_add_f32 v91, v91, v93
    v_frexp_exp_i32_f32 v88, v90
    v_frexp_exp_i32_f32 v89, v91
    v_sub_u32 v88, -101, v88
    v_sub_u32 v89, -101, v89
    v_med3_i32 v88, v88, 0, s58
    v_med3_i32 v89, v89, 0, s58
    v_cvt_f32_i32 v92, v88
    v_cvt_f32_i32 v93, v89
    v_ldexp_f32 v90, v90, v88
    v_ldexp_f32 v91, v91, v89
    v_ldexp_f32 v88, 1.0, v88
    v_ldexp_f32 v89, 1.0, v89
    v_accvgpr_write_b32 a192, v90
    v_accvgpr_write_b32 a196, v91
    v_accvgpr_write_b32 a193, 0
    v_accvgpr_write_b32 a197, 0
    v_add_f32 v16, v16, v92
    v_add_f32 v20, v20, v93
    v_add_f32 v17, v17, v92
    v_add_f32 v21, v21, v93
    v_add_f32 v18, v18, v92
    v_add_f32 v22, v22, v93
    v_add_f32 v19, v19, v92
    v_add_f32 v23, v23, v93
    v_pk_mul_f32 v[128:129], v[128:129], v[88:89] op_sel_hi:[1,0]
    v_pk_mul_f32 v[130:131], v[130:131], v[88:89] op_sel_hi:[1,0]
    v_pk_mul_f32 v[144:145], v[144:145], v[88:89] op_sel_hi:[1,0]
    v_pk_mul_f32 v[146:147], v[146:147], v[88:89] op_sel_hi:[1,0]
    v_pk_mul_f32 v[160:161], v[160:161], v[88:89] op_sel_hi:[1,0]
    v_pk_mul_f32 v[162:163], v[162:163], v[88:89] op_sel_hi:[1,0]
    v_pk_mul_f32 v[176:177], v[176:177], v[88:89] op_sel_hi:[1,0]
    v_pk_mul_f32 v[178:179], v[178:179], v[88:89] op_sel_hi:[1,0]
    v_pk_mul_f32 v[192:193], v[192:193], v[88:89] op_sel_hi:[1,0]
    v_pk_mul_f32 v[194:195], v[194:195], v[88:89] op_sel_hi:[1,0]
    v_pk_mul_f32 v[208:209], v[208:209], v[88:89] op_sel_hi:[1,0]
    v_pk_mul_f32 v[210:211], v[210:211], v[88:89] op_sel_hi:[1,0]
    v_pk_mul_f32 v[224:225], v[224:225], v[88:89] op_sel_hi:[1,0]
    v_pk_mul_f32 v[226:227], v[226:227], v[88:89] op_sel_hi:[1,0]
    v_pk_mul_f32 v[240:241], v[240:241], v[88:89] op_sel_hi:[1,0]
    v_pk_mul_f32 v[242:243], v[242:243], v[88:89] op_sel_hi:[1,0]
    v_pk_mul_f32 v[132:133], v[132:133], v[88:89] op_sel:[0,1] op_sel_hi:[1,1]
    v_pk_mul_f32 v[134:135], v[134:135], v[88:89] op_sel:[0,1] op_sel_hi:[1,1]
    v_pk_mul_f32 v[148:149], v[148:149], v[88:89] op_sel:[0,1] op_sel_hi:[1,1]
    v_pk_mul_f32 v[150:151], v[150:151], v[88:89] op_sel:[0,1] op_sel_hi:[1,1]
    v_pk_mul_f32 v[164:165], v[164:165], v[88:89] op_sel:[0,1] op_sel_hi:[1,1]
    v_pk_mul_f32 v[166:167], v[166:167], v[88:89] op_sel:[0,1] op_sel_hi:[1,1]
    v_pk_mul_f32 v[180:181], v[180:181], v[88:89] op_sel:[0,1] op_sel_hi:[1,1]
    v_pk_mul_f32 v[182:183], v[182:183], v[88:89] op_sel:[0,1] op_sel_hi:[1,1]
    v_pk_mul_f32 v[196:197], v[196:197], v[88:89] op_sel:[0,1] op_sel_hi:[1,1]
    v_pk_mul_f32 v[198:199], v[198:199], v[88:89] op_sel:[0,1] op_sel_hi:[1,1]
    v_pk_mul_f32 v[212:213], v[212:213], v[88:89] op_sel:[0,1] op_sel_hi:[1,1]
    v_pk_mul_f32 v[214:215], v[214:215], v[88:89] op_sel:[0,1] op_sel_hi:[1,1]
    v_pk_mul_f32 v[228:229], v[228:229], v[88:89] op_sel:[0,1] op_sel_hi:[1,1]
    v_pk_mul_f32 v[230:231], v[230:231], v[88:89] op_sel:[0,1] op_sel_hi:[1,1]
    v_pk_mul_f32 v[244:245], v[244:245], v[88:89] op_sel:[0,1] op_sel_hi:[1,1]
    v_pk_mul_f32 v[246:247], v[246:247], v[88:89] op_sel:[0,1] op_sel_hi:[1,1]
    s_branch L_rc_b_back
L_spin_st:
    s_mov_b32 s58, 0x40000
L_spin_st_l:
    buffer_load_dword v1, off, s[32:35], s59 offset:4 sc1
    s_waitcnt vmcnt(0)
    v_cmp_le_u32 vcc, 32, v1
    s_nop 0
    s_cmp_eq_u64 vcc, -1
    s_cbranch_scc1 L_ok_st
    s_sub_u32 s58, s58, 1
    s_cmp_lg_u32 s58, 0
    s_cbranch_scc1 L_spin_st_l
    s_branch L_ok_st
L_spin_cnt:
    s_mov_b32 s58, 0x40000
L_spin_cnt_l:
    buffer_load_dword v1, off, s[32:35], s59 sc1
    s_waitcnt vmcnt(0)
    v_cmp_le_u32 vcc, 32, v1
    s_nop 0
    s_cmp_eq_u64 vcc, -1
    s_cbranch_scc1 L_ok_cnt
    s_sub_u32 s58, s58, 1
    s_cmp_lg_u32 s58, 0
    s_cbranch_scc1 L_spin_cnt_l
    s_branch L_ok_cnt
L_spin_fl:
    s_mov_b32 s58, 0x40000
L_spin_fl_l:
    buffer_load_dword v1, v86, s[12:15], s59 offen sc1
    s_waitcnt vmcnt(0)
    v_cmp_eq_u32 vcc, 1, v1
    s_nop 0
    s_cmp_eq_u64 vcc, -1
    s_cbranch_scc1 L_ok_fl
    s_sub_u32 s58, s58, 1
    s_cmp_lg_u32 s58, 0
    s_cbranch_scc1 L_spin_fl_l
    s_branch L_ok_fl
L_spin_f2:
    s_mov_b32 s58, 0x40000
L_spin_f2_l:
    buffer_load_dword v1, off, s[12:15], s59 sc1
    s_waitcnt vmcnt(0)
    v_cmp_eq_u32 vcc, 1, v1
    s_nop 0
    s_cmp_eq_u64 vcc, -1
    s_cbranch_scc1 L_ok_f2
    s_sub_u32 s58, s58, 1
    s_cmp_lg_u32 s58, 0
    s_cbranch_scc1 L_spin_f2_l
    s_branch L_ok_f2
L_spin_f3:
    s_mov_b32 s58, 0x40000
L_spin_f3_l:
    buffer_load_dword v1, off, s[12:15], s59 sc1
    s_waitcnt vmcnt(0)
    v_cmp_eq_u32 vcc, 1, v1
    s_nop 0
    s_cmp_eq_u64 vcc, -1
    s_cbranch_scc1 L_ok_f3
    s_sub_u32 s58, s58, 1
    s_cmp_lg_u32 s58, 0
    s_cbranch_scc1 L_spin_f3_l
    s_branch L_ok_f3
L_fallback:
    s_mov_b32 s50, 1
    s_mov_b32 s93, 0
    s_mov_b32 s43, 0
    v_mov_b32 v88, 0xff800000
    v_mov_b32 v89, 0xff800000
    v_mov_b32 v90, 0xff800000
    v_mov_b32 v91, 0xff800000
L_fb_loop:
    s_waitcnt vmcnt(0) lgkmcnt(0)
    s_barrier
    s_mov_b32 m0, s40
    s_nop 0
    buffer_load_dwordx4 v4, s[4:7], s43 offen offset:0 lds
    buffer_load_dwordx4 v4, s[4:7], s43 offen offset:1024 lds
    buffer_load_dwordx4 v4, s[4:7], s43 offen offset:2048 lds
    buffer_load_dwordx4 v4, s[4:7], s43 offen offset:3072 lds
    s_waitcnt vmcnt(0)
    s_barrier
    ds_read_b128 a[64:67], v2 offset:0
    ds_read_b128 a[68:71], v2 offset:256
    ds_read_b128 a[72:75], v2 offset:512
    ds_read_b128 a[76:79], v2 offset:768
    ds_read_b128 a[92:95], v2 offset:1792
    ds_read_b128 a[88:91], v2 offset:1536
    ds_read_b128 a[84:87], v2 offset:1280
    ds_read_b128 a[80:83], v2 offset:1024
    s_waitcnt lgkmcnt(0)
    ds_read_b128 a[96:99], v2 offset:2048
    ds_read_b128 a[100:103], v2 offset:2304
    ds_read_b128 a[104:107], v2 offset:2560
    ds_read_b128 a[108:111], v2 offset:2816
    ds_read_b128 a[124:127], v2 offset:3840
    ds_read_b128 a[120:123], v2 offset:3584
    ds_read_b128 a[116:119], v2 offset:3328
    ds_read_b128 a[112:115], v2 offset:3072
    s_waitcnt lgkmcnt(0)
    v_mfma_f32_16x16x32_bf16 v[128:131], a[64:67], a[0:3], 0
    v_mfma_f32_16x16x32_bf16 v[128:131], a[68:71], a[4:7], v[128:131]
    v_mfma_f32_16x16x32_bf16 v[128:131], a[72:75], a[8:11], v[128:131]
    v_mfma_f32_16x16x32_bf16 v[128:131], a[76:79], a[12:15], v[128:131]
    v_mfma_f32_16x16x32_bf16 v[144:147], a[92:95], a[12:15], 0
    v_mfma_f32_16x16x32_bf16 v[144:147], a[88:91], a[8:11], v[144:147]
    v_mfma_f32_16x16x32_bf16 v[144:147], a[84:87], a[4:7], v[144:147]
    v_mfma_f32_16x16x32_bf16 v[144:147], a[80:83], a[0:3], v[144:147]
    v_mfma_f32_16x16x32_bf16 v[160:163], a[96:99], a[0:3], 0
    v_mfma_f32_16x16x32_bf16 v[160:163], a[100:103], a[4:7], v[160:163]
    v_mfma_f32_16x16x32_bf16 v[160:163], a[104:107], a[8:11], v[160:163]
    v_mfma_f32_16x16x32_bf16 v[160:163], a[108:111], a[12:15], v[160:163]
    v_mfma_f32_16x16x32_bf16 v[176:179], a[124:127], a[12:15], 0
    v_mfma_f32_16x16x32_bf16 v[176:179], a[120:123], a[8:11], v[176:179]
    v_mfma_f32_16x16x32_bf16 v[176:179], a[116:119], a[4:7], v[176:179]
    v_mfma_f32_16x16x32_bf16 v[176:179], a[112:115], a[0:3], v[176:179]
    v_mfma_f32_16x16x32_bf16 v[132:135], a[64:67], a[16:19], 0
    v_mfma_f32_16x16x32_bf16 v[132:135], a[68:71], a[20:23], v[132:135]
    v_mfma_f32_16x16x32_bf16 v[132:135], a[72:75], a[24:27], v[132:135]
    v_mfma_f32_16x16x32_bf16 v[132:135], a[76:79], a[28:31], v[132:135]
    v_mfma_f32_16x16x32_bf16 v[148:151], a[92:95], a[28:31], 0
    v_mfma_f32_16x16x32_bf16 v[148:151], a[88:91], a[24:27], v[148:151]
    v_mfma_f32_16x16x32_bf16 v[148:151], a[84:87], a[20:23], v[148:151]
    v_mfma_f32_16x16x32_bf16 v[148:151], a[80:83], a[16:19], v[148:151]
    v_mfma_f32_16x16x32_bf16 v[164:167], a[96:99], a[16:19], 0
    v_mfma_f32_16x16x32_bf16 v[164:167], a[100:103], a[20:23], v[164:167]
    v_mfma_f32_16x16x32_bf16 v[164:167], a[104:107], a[24:27], v[164:167]
    v_mfma_f32_16x16x32_bf16 v[164:167], a[108:111], a[28:31], v[164:167]
    v_mfma_f32_16x16x32_bf16 v[180:183], a[124:127], a[28:31], 0
    v_mfma_f32_16x16x32_bf16 v[180:183], a[120:123], a[24:27], v[180:183]
    v_mfma_f32_16x16x32_bf16 v[180:183], a[116:119], a[20:23], v[180:183]
    v_mfma_f32_16x16x32_bf16 v[180:183], a[112:115], a[16:19], v[180:183]
    v_mfma_f32_16x16x32_bf16 v[136:139], a[64:67], a[32:35], 0
    v_mfma_f32_16x16x32_bf16 v[136:139], a[68:71], a[36:39], v[136:139]
    v_mfma_f32_16x16x32_bf16 v[136:139], a[72:75], a[40:43], v[136:139]
    v_mfma_f32_16x16x32_bf16 v[136:139], a[76:79], a[44:47], v[136:139]
    v_mfma_f32_16x16x32_bf16 v[152:155], a[92:95], a[44:47], 0
    v_mfma_f32_16x16x32_bf16 v[152:155], a[88:91], a[40:43], v[152:155]
    v_mfma_f32_16x16x32_bf16 v[152:155], a[84:87], a[36:39], v[152:155]
    v_mfma_f32_16x16x32_bf16 v[152:155], a[80:83], a[32:35], v[152:155]
    v_mfma_f32_16x16x32_bf16 v[168:171], a[96:99], a[32:35], 0
    v_mfma_f32_16x16x32_bf16 v[168:171], a[100:103], a[36:39], v[168:171]
    v_mfma_f32_16x16x32_bf16 v[168:171], a[104:107], a[40:43], v[168:171]
    v_mfma_f32_16x16x32_bf16 v[168:171], a[108:111], a[44:47], v[168:171]
    v_mfma_f32_16x16x32_bf16 v[184:187], a[124:127], a[44:47], 0
    v_mfma_f32_16x16x32_bf16 v[184:187], a[120:123], a[40:43], v[184:187]
    v_mfma_f32_16x16x32_bf16 v[184:187], a[116:119], a[36:39], v[184:187]
    v_mfma_f32_16x16x32_bf16 v[184:187], a[112:115], a[32:35], v[184:187]
    v_mfma_f32_16x16x32_bf16 v[140:143], a[64:67], a[48:51], 0
    v_mfma_f32_16x16x32_bf16 v[140:143], a[68:71], a[52:55], v[140:143]
    v_mfma_f32_16x16x32_bf16 v[140:143], a[72:75], a[56:59], v[140:143]
    v_mfma_f32_16x16x32_bf16 v[140:143], a[76:79], a[60:63], v[140:143]
    v_mfma_f32_16x16x32_bf16 v[156:159], a[92:95], a[60:63], 0
    v_mfma_f32_16x16x32_bf16 v[156:159], a[88:91], a[56:59], v[156:159]
    v_mfma_f32_16x16x32_bf16 v[156:159], a[84:87], a[52:55], v[156:159]
    v_mfma_f32_16x16x32_bf16 v[156:159], a[80:83], a[48:51], v[156:159]
    v_mfma_f32_16x16x32_bf16 v[172:175], a[96:99], a[48:51], 0
    v_mfma_f32_16x16x32_bf16 v[172:175], a[100:103], a[52:55], v[172:175]
    v_mfma_f32_16x16x32_bf16 v[172:175], a[104:107], a[56:59], v[172:175]
    v_mfma_f32_16x16x32_bf16 v[172:175], a[108:111], a[60:63], v[172:175]
    v_mfma_f32_16x16x32_bf16 v[188:191], a[124:127], a[60:63], 0
    v_mfma_f32_16x16x32_bf16 v[188:191], a[120:123], a[56:59], v[188:191]
    v_mfma_f32_16x16x32_bf16 v[188:191], a[116:119], a[52:55], v[188:191]
    v_mfma_f32_16x16x32_bf16 v[188:191], a[112:115], a[48:51], v[188:191]
    s_nop 7
    v_max3_f32 v88, v88, v128, v129
    v_max3_f32 v88, v88, v130, v131
    v_max3_f32 v88, v88, v144, v145
    v_max3_f32 v88, v88, v146, v147
    v_max3_f32 v88, v88, v160, v161
    v_max3_f32 v88, v88, v162, v163
    v_max3_f32 v88, v88, v176, v177
    v_max3_f32 v88, v88, v178, v179
    v_max3_f32 v89, v89, v132, v133
    v_max3_f32 v89, v89, v134, v135
    v_max3_f32 v89, v89, v148, v149
    v_max3_f32 v89, v89, v150, v151
    v_max3_f32 v89, v89, v164, v165
    v_max3_f32 v89, v89, v166, v167
    v_max3_f32 v89, v89, v180, v181
    v_max3_f32 v89, v89, v182, v183
    v_max3_f32 v90, v90, v136, v137
    v_max3_f32 v90, v90, v138, v139
    v_max3_f32 v90, v90, v152, v153
    v_max3_f32 v90, v90, v154, v155
    v_max3_f32 v90, v90, v168, v169
    v_max3_f32 v90, v90, v170, v171
    v_max3_f32 v90, v90, v184, v185
    v_max3_f32 v90, v90, v186, v187
    v_max3_f32 v91, v91, v140, v141
    v_max3_f32 v91, v91, v142, v143
    v_max3_f32 v91, v91, v156, v157
    v_max3_f32 v91, v91, v158, v159
    v_max3_f32 v91, v91, v172, v173
    v_max3_f32 v91, v91, v174, v175
    v_max3_f32 v91, v91, v188, v189
    v_max3_f32 v91, v91, v190, v191
    s_add_u32 s43, s43, 0x4000
    s_cmp_lt_u32 s43, 0x80000
    s_cbranch_scc1 L_fb_loop
    v_mov_b32 v48, v88
    v_mov_b32 v49, v89
    v_mov_b32 v50, v90
    v_mov_b32 v51, v91
    v_permlane32_swap_b32 v88, v48
    v_permlane32_swap_b32 v89, v49
    v_permlane32_swap_b32 v90, v50
    v_permlane32_swap_b32 v91, v51
    v_max_f32 v88, v88, v48
    v_max_f32 v89, v89, v49
    v_max_f32 v90, v90, v50
    v_max_f32 v91, v91, v51
    v_mov_b32 v48, v88
    v_mov_b32 v49, v89
    v_mov_b32 v50, v90
    v_mov_b32 v51, v91
    v_permlane16_swap_b32 v88, v48
    v_permlane16_swap_b32 v89, v49
    v_permlane16_swap_b32 v90, v50
    v_permlane16_swap_b32 v91, v51
    v_max_f32 v88, v88, v48
    v_max_f32 v89, v89, v49
    v_max_f32 v90, v90, v50
    v_max_f32_e64 v91, v91, v51
    s_barrier
    s_mov_b32 s59, 0
    s_add_u32 m0, s40, 0
    s_nop 0
    buffer_load_dwordx4 v4, s[4:7], s59 offen offset:0 lds
    buffer_load_dwordx4 v4, s[4:7], s59 offen offset:1024 lds
    buffer_load_dwordx4 v4, s[4:7], s59 offen offset:2048 lds
    buffer_load_dwordx4 v4, s[4:7], s59 offen offset:3072 lds
    s_mov_b32 s59, 0
    s_add_u32 m0, s41, 0
    s_nop 0
    buffer_load_dwordx4 v4, s[8:11], s59 offen offset:0 lds
    buffer_load_dwordx4 v4, s[8:11], s59 offen offset:1024 lds
    buffer_load_dwordx4 v4, s[8:11], s59 offen offset:2048 lds
    buffer_load_dwordx4 v4, s[8:11], s59 offen offset:3072 lds
    s_mov_b32 s59, 16384
    s_add_u32 m0, s40, 16416
    s_nop 0
    buffer_load_dwordx4 v4, s[4:7], s59 offen offset:0 lds
    buffer_load_dwordx4 v4, s[4:7], s59 offen offset:1024 lds
    buffer_load_dwordx4 v4, s[4:7], s59 offen offset:2048 lds
    buffer_load_dwordx4 v4, s[4:7], s59 offen offset:3072 lds
    s_mov_b32 s59, 16384
    s_add_u32 m0, s41, 16512
    s_nop 0
    buffer_load_dwordx4 v4, s[8:11], s59 offen offset:0 lds
    buffer_load_dwordx4 v4, s[8:11], s59 offen offset:1024 lds
    buffer_load_dwordx4 v4, s[8:11], s59 offen offset:2048 lds
    buffer_load_dwordx4 v4, s[8:11], s59 offen offset:3072 lds
    s_mov_b32 s59, 32768
    s_add_u32 m0, s40, 32832
    s_nop 0
    buffer_load_dwordx4 v4, s[4:7], s59 offen offset:0 lds
    buffer_load_dwordx4 v4, s[4:7], s59 offen offset:1024 lds
    buffer_load_dwordx4 v4, s[4:7], s59 offen offset:2048 lds
    buffer_load_dwordx4 v4, s[4:7], s59 offen offset:3072 lds
    s_mov_b32 s59, 32768
    s_add_u32 m0, s41, 33024
    s_nop 0
    buffer_load_dwordx4 v4, s[8:11], s59 offen offset:0 lds
    buffer_load_dwordx4 v4, s[8:11], s59 offen offset:1024 lds
    buffer_load_dwordx4 v4, s[8:11], s59 offen offset:2048 lds
    buffer_load_dwordx4 v4, s[8:11], s59 offen offset:3072 lds
    s_mov_b32 s59, 49152
    s_add_u32 m0, s40, 49248
    s_nop 0
    buffer_load_dwordx4 v4, s[4:7], s59 offen offset:0 lds
    buffer_load_dwordx4 v4, s[4:7], s59 offen offset:1024 lds
    buffer_load_dwordx4 v4, s[4:7], s59 offen offset:2048 lds
    buffer_load_dwordx4 v4, s[4:7], s59 offen offset:3072 lds
    s_mov_b32 s59, 49152
    s_add_u32 m0, s41, 49536
    s_nop 0
    buffer_load_dwordx4 v4, s[8:11], s59 offen offset:0 lds
    buffer_load_dwordx4 v4, s[8:11], s59 offen offset:1024 lds
    buffer_load_dwordx4 v4, s[8:11], s59 offen offset:2048 lds
    buffer_load_dwordx4 v4, s[8:11], s59 offen offset:3072 lds
    v_lshrrev_b32 v1, 4, v0
    v_lshlrev_b32_e64 v1, 3, v1
    buffer_load_dwordx2 v[72:73], v1, s[76:79], 0 offen offset:0
    buffer_load_dwordx2 v[74:75], v1, s[76:79], 0 offen offset:32
    buffer_load_dwordx2 v[76:77], v1, s[76:79], 0 offen offset:64
    buffer_load_dwordx2 v[78:79], v1, s[76:79], 0 offen offset:96
    s_mov_b32 s42, 49152
    s_lshl_b32 s85, s36, 13
    s_sub_u32 s85, s85, 0x8000
    s_sub_u32 s86, s84, 0x1000
    s_and_b32 s52, s101, 1
    s_mul_i32 s52, s52, 86016
    s_add_u32 s86, s86, s52
    s_lshl_b32 s52, s52, 3
    s_add_u32 s85, s85, s52
    s_mov_b32 s43, 7
    v_mov_b32 v1, 0x10000000
    s_add_u32 m0, s81, 0
    s_nop 0
    buffer_load_dwordx4 v1, s[68:71], 0 offen lds
    s_waitcnt vmcnt(0)
    s_barrier
    ds_read_b128 a[64:67], v2 offset:0
    ds_read_b128 a[68:71], v2 offset:256
    ds_read_b128 a[72:75], v2 offset:512
    ds_read_b128 a[76:79], v2 offset:768
    ds_read_b128 a[92:95], v2 offset:1792
    ds_read_b128 a[88:91], v2 offset:1536
    ds_read_b128 a[84:87], v2 offset:1280
    ds_read_b128 a[80:83], v2 offset:1024
    s_waitcnt lgkmcnt(0)
    ds_read_b128 a[96:99], v2 offset:2048
    ds_read_b128 a[100:103], v2 offset:2304
    ds_read_b128 a[104:107], v2 offset:2560
    ds_read_b128 a[108:111], v2 offset:2816
    ds_read_b128 a[124:127], v2 offset:3840
    ds_read_b128 a[120:123], v2 offset:3584
    ds_read_b128 a[116:119], v2 offset:3328
    ds_read_b128 a[112:115], v2 offset:3072
    s_waitcnt lgkmcnt(0)
    ds_read_b64_tr_b16 a[128:129], v3 offset:0
    ds_read_b64_tr_b16 a[130:131], v3 offset:1024
    ds_read_b64_tr_b16 a[160:161], v3 offset:2048
    ds_read_b64_tr_b16 a[162:163], v3 offset:3072
    ds_read_b64_tr_b16 a[164:165], v3 offset:2080
    ds_read_b64_tr_b16 a[166:167], v3 offset:3104
    ds_read_b64_tr_b16 a[132:133], v3 offset:32
    ds_read_b64_tr_b16 a[134:135], v3 offset:1056
    s_waitcnt lgkmcnt(0)
    ds_read_b64_tr_b16 a[136:137], v3 offset:256
    ds_read_b64_tr_b16 a[138:139], v3 offset:1280
    ds_read_b64_tr_b16 a[168:169], v3 offset:2304
    ds_read_b64_tr_b16 a[170:171], v3 offset:3328
    ds_read_b64_tr_b16 a[172:173], v3 offset:2336
    ds_read_b64_tr_b16 a[174:175], v3 offset:3360
    ds_read_b64_tr_b16 a[140:141], v3 offset:288
    ds_read_b64_tr_b16 a[142:143], v3 offset:1312
    s_waitcnt lgkmcnt(0)
    ds_read_b64_tr_b16 a[144:145], v3 offset:512
    ds_read_b64_tr_b16 a[146:147], v3 offset:1536
    ds_read_b64_tr_b16 a[176:177], v3 offset:2560
    ds_read_b64_tr_b16 a[178:179], v3 offset:3584
    ds_read_b64_tr_b16 a[180:181], v3 offset:2592
    ds_read_b64_tr_b16 a[182:183], v3 offset:3616
    ds_read_b64_tr_b16 a[148:149], v3 offset:544
    ds_read_b64_tr_b16 a[150:151], v3 offset:1568
    s_waitcnt lgkmcnt(0)
    ds_read_b64_tr_b16 a[152:153], v3 offset:768
    ds_read_b64_tr_b16 a[154:155], v3 offset:1792
    ds_read_b64_tr_b16 a[184:185], v3 offset:2816
    ds_read_b64_tr_b16 a[186:187], v3 offset:3840
    ds_read_b64_tr_b16 a[188:189], v3 offset:2848
    ds_read_b64_tr_b16 a[190:191], v3 offset:3872
    ds_read_b64_tr_b16 a[156:157], v3 offset:800
    ds_read_b64_tr_b16 a[158:159], v3 offset:1824
    s_waitcnt lgkmcnt(0)
    v_accvgpr_write_b32 a192, 0
    v_accvgpr_write_b32 a193, 0
    v_accvgpr_write_b32 a194, 0
    v_accvgpr_write_b32 a195, 0
    v_accvgpr_write_b32 a196, 0
    v_accvgpr_write_b32 a197, 0
    v_accvgpr_write_b32 a198, 0
    v_accvgpr_write_b32 a199, 0
    v_accvgpr_write_b32 a200, 0
    v_accvgpr_write_b32 a201, 0
    v_accvgpr_write_b32 a202, 0
    v_accvgpr_write_b32 a203, 0
    v_accvgpr_write_b32 a204, 0
    v_accvgpr_write_b32 a205, 0
    v_accvgpr_write_b32 a206, 0
    v_accvgpr_write_b32 a207, 0
    v_accvgpr_write_b32 a224, 0
    v_accvgpr_write_b32 a225, 0
    v_accvgpr_write_b32 a226, 0
    v_accvgpr_write_b32 a227, 0
    v_accvgpr_write_b32 a228, 0
    v_accvgpr_write_b32 a229, 0
    v_accvgpr_write_b32 a230, 0
    v_accvgpr_write_b32 a231, 0
    v_lshlrev_b32 v64, 16, v72
    v_and_b32 v65, 0xffff0000, v72
    v_lshlrev_b32 v66, 16, v73
    v_and_b32 v67, 0xffff0000, v73
    v_lshlrev_b32 v68, 16, v74
    v_and_b32 v69, 0xffff0000, v74
    v_lshlrev_b32 v70, 16, v75
    v_and_b32 v71, 0xffff0000, v75
    v_lshlrev_b32 v72, 16, v76
    v_and_b32 v73, 0xffff0000, v76
    v_lshlrev_b32 v74, 16, v77
    v_and_b32 v75, 0xffff0000, v77
    v_lshlrev_b32 v76, 16, v78
    v_and_b32 v77, 0xffff0000, v78
    v_lshlrev_b32 v78, 16, v79
    v_and_b32 v79, 0xffff0000, v79
    v_mov_b32 v112, 0
    v_mov_b32 v113, 0
    v_mov_b32 v114, 0
    v_mov_b32 v115, 0
    v_mov_b32 v116, 0
    v_mov_b32 v117, 0
    v_mov_b32 v118, 0
    v_mov_b32 v119, 0
    v_mov_b32 v120, 0
    v_mov_b32 v121, 0
    v_mov_b32 v122, 0
    v_mov_b32 v123, 0
    v_mov_b32 v124, 0
    v_mov_b32 v125, 0
    v_mov_b32 v126, 0
    v_mov_b32 v127, 0
    v_sub_f32 v16, 0, v88
    v_sub_f32 v17, 0, v88
    v_sub_f32 v18, 0, v88
    v_sub_f32 v19, 0, v88
    v_sub_f32 v20, 0, v89
    v_sub_f32 v21, 0, v89
    v_sub_f32 v22, 0, v89
    v_sub_f32 v23, 0, v89
    v_sub_f32 v24, 0, v90
    v_sub_f32 v25, 0, v90
    v_sub_f32 v26, 0, v90
    v_sub_f32 v27, 0, v90
    v_sub_f32 v28, 0, v91
    v_sub_f32 v29, 0, v91
    v_sub_f32 v30, 0, v91
    v_sub_f32 v31, 0, v91
    v_mfma_f32_16x16x32_bf16 v[128:131], a[64:67], a[0:3], v[16:19]
    v_mfma_f32_16x16x32_bf16 v[128:131], a[68:71], a[4:7], v[128:131]
    v_mfma_f32_16x16x32_bf16 v[128:131], a[72:75], a[8:11], v[128:131]
    v_mfma_f32_16x16x32_bf16 v[128:131], a[76:79], a[12:15], v[128:131]
    v_mfma_f32_16x16x32_bf16 v[144:147], a[92:95], a[12:15], v[16:19]
    v_mfma_f32_16x16x32_bf16 v[144:147], a[88:91], a[8:11], v[144:147]
    v_mfma_f32_16x16x32_bf16 v[144:147], a[84:87], a[4:7], v[144:147]
    v_mfma_f32_16x16x32_bf16 v[144:147], a[80:83], a[0:3], v[144:147]
    v_mfma_f32_16x16x32_bf16 v[160:163], a[96:99], a[0:3], v[16:19]
    v_mfma_f32_16x16x32_bf16 v[160:163], a[100:103], a[4:7], v[160:163]
    v_mfma_f32_16x16x32_bf16 v[160:163], a[104:107], a[8:11], v[160:163]
    v_mfma_f32_16x16x32_bf16 v[160:163], a[108:111], a[12:15], v[160:163]
    v_mfma_f32_16x16x32_bf16 v[176:179], a[124:127], a[12:15], v[16:19]
    v_mfma_f32_16x16x32_bf16 v[176:179], a[120:123], a[8:11], v[176:179]
    v_mfma_f32_16x16x32_bf16 v[176:179], a[116:119], a[4:7], v[176:179]
    v_mfma_f32_16x16x32_bf16 v[176:179], a[112:115], a[0:3], v[176:179]
    v_mfma_f32_16x16x32_bf16 v[132:135], a[64:67], a[16:19], v[20:23]
    v_mfma_f32_16x16x32_bf16 v[132:135], a[68:71], a[20:23], v[132:135]
    v_mfma_f32_16x16x32_bf16 v[132:135], a[72:75], a[24:27], v[132:135]
    v_mfma_f32_16x16x32_bf16 v[132:135], a[76:79], a[28:31], v[132:135]
    v_mfma_f32_16x16x32_bf16 v[148:151], a[92:95], a[28:31], v[20:23]
    v_mfma_f32_16x16x32_bf16 v[148:151], a[88:91], a[24:27], v[148:151]
    v_mfma_f32_16x16x32_bf16 v[148:151], a[84:87], a[20:23], v[148:151]
    v_mfma_f32_16x16x32_bf16 v[148:151], a[80:83], a[16:19], v[148:151]
    v_mfma_f32_16x16x32_bf16 v[164:167], a[96:99], a[16:19], v[20:23]
    v_mfma_f32_16x16x32_bf16 v[164:167], a[100:103], a[20:23], v[164:167]
    v_mfma_f32_16x16x32_bf16 v[164:167], a[104:107], a[24:27], v[164:167]
    v_mfma_f32_16x16x32_bf16 v[164:167], a[108:111], a[28:31], v[164:167]
    v_mfma_f32_16x16x32_bf16 v[180:183], a[124:127], a[28:31], v[20:23]
    v_mfma_f32_16x16x32_bf16 v[180:183], a[120:123], a[24:27], v[180:183]
    v_mfma_f32_16x16x32_bf16 v[180:183], a[116:119], a[20:23], v[180:183]
    v_mfma_f32_16x16x32_bf16 v[180:183], a[112:115], a[16:19], v[180:183]
    v_mfma_f32_16x16x32_bf16 v[136:139], a[64:67], a[32:35], v[24:27]
    v_mfma_f32_16x16x32_bf16 v[136:139], a[68:71], a[36:39], v[136:139]
    v_mfma_f32_16x16x32_bf16 v[136:139], a[72:75], a[40:43], v[136:139]
    v_mfma_f32_16x16x32_bf16 v[136:139], a[76:79], a[44:47], v[136:139]
    v_mfma_f32_16x16x32_bf16 v[152:155], a[92:95], a[44:47], v[24:27]
    v_mfma_f32_16x16x32_bf16 v[152:155], a[88:91], a[40:43], v[152:155]
    v_mfma_f32_16x16x32_bf16 v[152:155], a[84:87], a[36:39], v[152:155]
    v_mfma_f32_16x16x32_bf16 v[152:155], a[80:83], a[32:35], v[152:155]
    v_mfma_f32_16x16x32_bf16 v[168:171], a[96:99], a[32:35], v[24:27]
    v_mfma_f32_16x16x32_bf16 v[168:171], a[100:103], a[36:39], v[168:171]
    v_mfma_f32_16x16x32_bf16 v[168:171], a[104:107], a[40:43], v[168:171]
    v_mfma_f32_16x16x32_bf16 v[168:171], a[108:111], a[44:47], v[168:171]
    v_mfma_f32_16x16x32_bf16 v[184:187], a[124:127], a[44:47], v[24:27]
    v_mfma_f32_16x16x32_bf16 v[184:187], a[120:123], a[40:43], v[184:187]
    v_mfma_f32_16x16x32_bf16 v[184:187], a[116:119], a[36:39], v[184:187]
    v_mfma_f32_16x16x32_bf16 v[184:187], a[112:115], a[32:35], v[184:187]
    v_mfma_f32_16x16x32_bf16 v[140:143], a[64:67], a[48:51], v[28:31]
    v_mfma_f32_16x16x32_bf16 v[140:143], a[68:71], a[52:55], v[140:143]
    v_mfma_f32_16x16x32_bf16 v[140:143], a[72:75], a[56:59], v[140:143]
    v_mfma_f32_16x16x32_bf16 v[140:143], a[76:79], a[60:63], v[140:143]
    v_mfma_f32_16x16x32_bf16 v[156:159], a[92:95], a[60:63], v[28:31]
    v_mfma_f32_16x16x32_bf16 v[156:159], a[88:91], a[56:59], v[156:159]
    v_mfma_f32_16x16x32_bf16 v[156:159], a[84:87], a[52:55], v[156:159]
    v_mfma_f32_16x16x32_bf16 v[156:159], a[80:83], a[48:51], v[156:159]
    v_mfma_f32_16x16x32_bf16 v[172:175], a[96:99], a[48:51], v[28:31]
    v_mfma_f32_16x16x32_bf16 v[172:175], a[100:103], a[52:55], v[172:175]
    v_mfma_f32_16x16x32_bf16 v[172:175], a[104:107], a[56:59], v[172:175]
    v_mfma_f32_16x16x32_bf16 v[172:175], a[108:111], a[60:63], v[172:175]
    v_mfma_f32_16x16x32_bf16 v[188:191], a[124:127], a[60:63], v[28:31]
    v_mfma_f32_16x16x32_bf16 v[188:191], a[120:123], a[56:59], v[188:191]
    v_mfma_f32_16x16x32_bf16 v[188:191], a[116:119], a[52:55], v[188:191]
    v_mfma_f32_16x16x32_bf16 v[188:191], a[112:115], a[48:51], v[188:191]
    v_exp_f32 v128, v128
    v_exp_f32 v129, v129
    s_nop 0
    v_cvt_pk_bf16_f32 v48, v128, v129
    v_exp_f32 v130, v130
    v_exp_f32 v131, v131
    s_nop 0
    v_cvt_pk_bf16_f32 v49, v130, v131
    v_exp_f32 v144, v144
    v_exp_f32 v145, v145
    s_nop 0
    v_cvt_pk_bf16_f32 v50, v144, v145
    v_exp_f32 v146, v146
    v_exp_f32 v147, v147
    s_nop 0
    v_cvt_pk_bf16_f32 v51, v146, v147
    v_exp_f32 v160, v160
    v_exp_f32 v161, v161
    s_nop 0
    v_cvt_pk_bf16_f32 v52, v160, v161
    v_exp_f32 v162, v162
    v_exp_f32 v163, v163
    s_nop 0
    v_cvt_pk_bf16_f32 v53, v162, v163
    v_exp_f32 v176, v176
    v_exp_f32 v177, v177
    s_nop 0
    v_cvt_pk_bf16_f32 v54, v176, v177
    v_exp_f32 v178, v178
    v_exp_f32_e64 v179, v179
    s_nop 0
    v_cvt_pk_bf16_f32 v55, v178, v179
    s_nop 1
    v_smfmac_f32_16x16x64_bf16 a[192:195], v[8:11], v[48:55], v5
    v_mfma_f32_16x16x32_bf16 v[128:131], a[128:131], v[48:51], 0
    v_mfma_f32_16x16x32_bf16 v[128:131], a[160:163], v[52:55], v[128:131]
    v_mfma_f32_16x16x32_bf16 v[144:147], a[164:167], v[52:55], 0
    v_mfma_f32_16x16x32_bf16 v[144:147], a[132:135], v[48:51], v[144:147]
    v_mfma_f32_16x16x32_bf16 v[160:163], a[136:139], v[48:51], 0
    v_mfma_f32_16x16x32_bf16 v[160:163], a[168:171], v[52:55], v[160:163]
    v_mfma_f32_16x16x32_bf16 v[176:179], a[172:175], v[52:55], 0
    v_mfma_f32_16x16x32_bf16 v[176:179], a[140:143], v[48:51], v[176:179]
    v_mfma_f32_16x16x32_bf16 v[192:195], a[144:147], v[48:51], 0
    v_mfma_f32_16x16x32_bf16 v[192:195], a[176:179], v[52:55], v[192:195]
    v_mfma_f32_16x16x32_bf16 v[208:211], a[180:183], v[52:55], 0
    v_mfma_f32_16x16x32_bf16 v[208:211], a[148:151], v[48:51], v[208:211]
    v_mfma_f32_16x16x32_bf16 v[224:227], a[152:155], v[48:51], 0
    v_mfma_f32_16x16x32_bf16 v[224:227], a[184:187], v[52:55], v[224:227]
    v_mfma_f32_16x16x32_bf16 v[240:243], a[188:191], v[52:55], 0
    v_mfma_f32_16x16x32_bf16 v[240:243], a[156:159], v[48:51], v[240:243]
    v_exp_f32 v132, v132
    v_exp_f32 v133, v133
    s_nop 0
    v_cvt_pk_bf16_f32 v56, v132, v133
    v_exp_f32 v134, v134
    v_exp_f32 v135, v135
    s_nop 0
    v_cvt_pk_bf16_f32 v57, v134, v135
    v_exp_f32 v148, v148
    v_exp_f32 v149, v149
    s_nop 0
    v_cvt_pk_bf16_f32 v58, v148, v149
    v_exp_f32 v150, v150
    v_exp_f32 v151, v151
    s_nop 0
    v_cvt_pk_bf16_f32 v59, v150, v151
    v_exp_f32 v164, v164
    v_exp_f32 v165, v165
    s_nop 0
    v_cvt_pk_bf16_f32 v60, v164, v165
    v_exp_f32 v166, v166
    v_exp_f32 v167, v167
    s_nop 0
    v_cvt_pk_bf16_f32 v61, v166, v167
    v_exp_f32 v180, v180
    v_exp_f32 v181, v181
    s_nop 0
    v_cvt_pk_bf16_f32 v62, v180, v181
    v_exp_f32 v182, v182
    v_exp_f32_e64 v183, v183
    s_nop 0
    v_cvt_pk_bf16_f32 v63, v182, v183
    s_nop 1
    v_smfmac_f32_16x16x64_bf16 a[196:199], v[8:11], v[56:63], v5
    v_mfma_f32_16x16x32_bf16 v[132:135], a[128:131], v[56:59], 0
    v_mfma_f32_16x16x32_bf16 v[132:135], a[160:163], v[60:63], v[132:135]
    v_mfma_f32_16x16x32_bf16 v[148:151], a[164:167], v[60:63], 0
    v_mfma_f32_16x16x32_bf16 v[148:151], a[132:135], v[56:59], v[148:151]
    v_mfma_f32_16x16x32_bf16 v[164:167], a[136:139], v[56:59], 0
    v_mfma_f32_16x16x32_bf16 v[164:167], a[168:171], v[60:63], v[164:167]
    v_mfma_f32_16x16x32_bf16 v[180:183], a[172:175], v[60:63], 0
    v_mfma_f32_16x16x32_bf16 v[180:183], a[140:143], v[56:59], v[180:183]
    v_mfma_f32_16x16x32_bf16 v[196:199], a[144:147], v[56:59], 0
    v_mfma_f32_16x16x32_bf16 v[196:199], a[176:179], v[60:63], v[196:199]
    v_mfma_f32_16x16x32_bf16 v[212:215], a[180:183], v[60:63], 0
    v_mfma_f32_16x16x32_bf16 v[212:215], a[148:151], v[56:59], v[212:215]
    v_mfma_f32_16x16x32_bf16 v[228:231], a[152:155], v[56:59], 0
    v_mfma_f32_16x16x32_bf16 v[228:231], a[184:187], v[60:63], v[228:231]
    v_mfma_f32_16x16x32_bf16 v[244:247], a[188:191], v[60:63], 0
    v_mfma_f32_16x16x32_bf16 v[244:247], a[156:159], v[56:59], v[244:247]
    v_exp_f32 v136, v136
    v_exp_f32 v137, v137
    s_nop 0
    v_cvt_pk_bf16_f32 v48, v136, v137
    v_exp_f32 v138, v138
    v_exp_f32 v139, v139
    s_nop 0
    v_cvt_pk_bf16_f32 v49, v138, v139
    v_exp_f32 v152, v152
    v_exp_f32 v153, v153
    s_nop 0
    v_cvt_pk_bf16_f32 v50, v152, v153
    v_exp_f32 v154, v154
    v_exp_f32 v155, v155
    s_nop 0
    v_cvt_pk_bf16_f32 v51, v154, v155
    v_exp_f32 v168, v168
    v_exp_f32 v169, v169
    s_nop 0
    v_cvt_pk_bf16_f32 v52, v168, v169
    v_exp_f32 v170, v170
    v_exp_f32 v171, v171
    s_nop 0
    v_cvt_pk_bf16_f32 v53, v170, v171
    v_exp_f32 v184, v184
    v_exp_f32 v185, v185
    s_nop 0
    v_cvt_pk_bf16_f32 v54, v184, v185
    v_exp_f32 v186, v186
    v_exp_f32_e64 v187, v187
    s_nop 0
    v_cvt_pk_bf16_f32 v55, v186, v187
    s_nop 1
    v_smfmac_f32_16x16x64_bf16 a[200:203], v[8:11], v[48:55], v5
    v_mfma_f32_16x16x32_bf16 v[136:139], a[128:131], v[48:51], 0
    v_mfma_f32_16x16x32_bf16 v[136:139], a[160:163], v[52:55], v[136:139]
    v_mfma_f32_16x16x32_bf16 v[152:155], a[164:167], v[52:55], 0
    v_mfma_f32_16x16x32_bf16 v[152:155], a[132:135], v[48:51], v[152:155]
    v_mfma_f32_16x16x32_bf16 v[168:171], a[136:139], v[48:51], 0
    v_mfma_f32_16x16x32_bf16 v[168:171], a[168:171], v[52:55], v[168:171]
    v_mfma_f32_16x16x32_bf16 v[184:187], a[172:175], v[52:55], 0
    v_mfma_f32_16x16x32_bf16 v[184:187], a[140:143], v[48:51], v[184:187]
    v_mfma_f32_16x16x32_bf16 v[200:203], a[144:147], v[48:51], 0
    v_mfma_f32_16x16x32_bf16 v[200:203], a[176:179], v[52:55], v[200:203]
    v_mfma_f32_16x16x32_bf16 v[216:219], a[180:183], v[52:55], 0
    v_mfma_f32_16x16x32_bf16 v[216:219], a[148:151], v[48:51], v[216:219]
    v_mfma_f32_16x16x32_bf16 v[232:235], a[152:155], v[48:51], 0
    v_mfma_f32_16x16x32_bf16 v[232:235], a[184:187], v[52:55], v[232:235]
    v_mfma_f32_16x16x32_bf16 v[248:251], a[188:191], v[52:55], 0
    v_mfma_f32_16x16x32_bf16 v[248:251], a[156:159], v[48:51], v[248:251]
    v_exp_f32 v140, v140
    v_exp_f32 v141, v141
    s_nop 0
    v_cvt_pk_bf16_f32 v56, v140, v141
    v_exp_f32 v142, v142
    v_exp_f32 v143, v143
    s_nop 0
    v_cvt_pk_bf16_f32 v57, v142, v143
    v_exp_f32 v156, v156
    v_exp_f32 v157, v157
    s_nop 0
    v_cvt_pk_bf16_f32 v58, v156, v157
    v_exp_f32 v158, v158
    v_exp_f32 v159, v159
    s_nop 0
    v_cvt_pk_bf16_f32 v59, v158, v159
    v_exp_f32 v172, v172
    v_exp_f32 v173, v173
    s_nop 0
    v_cvt_pk_bf16_f32 v60, v172, v173
    v_exp_f32 v174, v174
    v_exp_f32_e64 v175, v175
    s_nop 0
    v_cvt_pk_bf16_f32 v61, v174, v175
    s_barrier
    ds_read_b64_tr_b16 v[96:97], v3 offset:16512
    ds_read_b64_tr_b16 v[98:99], v3 offset:17536
    ds_read_b64_tr_b16 v[104:105], v3 offset:18560
    ds_read_b64_tr_b16 v[106:107], v3 offset:19584
    ds_read_b64_tr_b16 v[108:109], v3 offset:18592
    ds_read_b128 a[64:67], v2 offset:16416
    ds_read_b128 a[68:71], v2 offset:16672
    ds_read_b128 a[72:75], v2 offset:16928
    s_waitcnt lgkmcnt(0)
    ds_read_b128 a[76:79], v2 offset:17184
    ds_read_b128 a[92:95], v2 offset:18208
    ds_read_b128 a[88:91], v2 offset:17952
    ds_read_b128 a[84:87], v2 offset:17696
    ds_read_b128 a[80:83], v2 offset:17440
    ds_read_b128 a[96:99], v2 offset:18464
    ds_read_b128 a[100:103], v2 offset:18720
    ds_read_b128 a[104:107], v2 offset:18976
    s_waitcnt lgkmcnt(0)
    ds_read_b128 a[108:111], v2 offset:19232
    ds_read_b128 a[124:127], v2 offset:20256
    ds_read_b128 a[120:123], v2 offset:20000
    ds_read_b128 a[116:119], v2 offset:19744
    ds_read_b128 a[112:115], v2 offset:19488
    ds_read_b64_tr_b16 v[110:111], v3 offset:19616
    s_waitcnt lgkmcnt(0)
    s_nop 7
    s_branch L_attn
L_last:
    s_endpgm
.section .rodata,"a"
.p2align 6
.amdhsa_kernel recurrent_scan__gqa_block_cached__dense_activation_gelu__prompt_kernel
.amdhsa_next_free_vgpr 512
.amdhsa_next_free_sgpr 102
.amdhsa_accum_offset 256
.amdhsa_group_segment_fixed_size 0
.amdhsa_kernarg_size 104
.amdhsa_user_sgpr_count 2
.amdhsa_user_sgpr_kernarg_segment_ptr 1
.amdhsa_system_sgpr_workgroup_id_x 1
.amdhsa_float_denorm_mode_32 3
.end_amdhsa_kernel
```
